```python
import torch

def _softmax(x, axis=-1):
    return torch.softmax(x, dim=axis)
def _gelu(x):
    return torch.nn.functional.gelu(x, approximate="tanh")
def _silu(x):
    return torch.nn.functional.silu(x)
def _sigmoid(x):
    return torch.sigmoid(x)
def _layernorm(x, axis=-1, eps=1e-5):
    m = x.mean(dim=axis, keepdim=True)
    v = x.var(dim=axis, keepdim=True, unbiased=False)
    return (x - m) / torch.sqrt(v + eps)
def _scatter_add(tgt, idx, src, axis=0):
    return tgt.clone().index_add_(axis, idx, src)
def _segment_sum(src, seg, n):
    out = torch.zeros((n,) + src.shape[1:], dtype=src.dtype)
    return out.index_add_(0, seg, src)
def _pad(x, pw):
    flat = tuple(v for pair in reversed(pw) for v in pair)
    return torch.nn.functional.pad(x, flat)

kernel_name = 'parallel_sum__ssm_conv_h3__swiglu_ffn__prompt'

def setup_inputs():

    _w = (lambda a: (lambda t: t.to(torch.bfloat16) if t.is_floating_point() else t)(torch.as_tensor(a)))
    def _A_setup():
        B, S, D = 1, 2048, 640
        ks = 4
        return {
            "q": _w((lambda *s: torch.randn(*s, dtype=torch.bfloat16) * 0.05)(B, S, D)),
            "k": _w((lambda *s: torch.randn(*s, dtype=torch.bfloat16) * 0.8)(B, S, D)),
            "v": _w((lambda *s: torch.randn(*s, dtype=torch.bfloat16) * 0.4)(B, S, D)),
            "shift_k": _w((lambda *s: torch.randn(*s, dtype=torch.bfloat16) * 0.8)(D, ks) * 0.5),
            "ssm_k": _w((lambda *s: torch.randn(*s, dtype=torch.bfloat16) * 0.8)(D, S) * (1.0 / S ** 0.5)),
            "ssm_D": _w((lambda *s: torch.randn(*s, dtype=torch.bfloat16) * 0.4)(D)),
        }
    _A_in = _A_setup()

    def _B_setup():
        B, S, D, F = 1, 2048, 640, 1728
        return {
            "x": _w((lambda *s: torch.randn(*s, dtype=torch.bfloat16) * 0.05)(B, S, D)),
            "w_gate": _w((lambda *s: torch.randn(*s, dtype=torch.bfloat16) * 0.05)(D, F)),
            "w_up": _w((lambda *s: torch.randn(*s, dtype=torch.bfloat16) * 0.05)(D, F)),
            "w_down": _w((lambda *s: torch.randn(*s, dtype=torch.bfloat16) * 0.05)(F, D)),
        }
    _B_in = _B_setup()

    return {
        "A_q": _A_in["q"],
        "A_k": _A_in["k"],
        "A_v": _A_in["v"],
        "A_shift_k": _A_in["shift_k"],
        "A_ssm_k": _A_in["ssm_k"],
        "A_ssm_D": _A_in["ssm_D"],
        "B_x": _B_in["x"],
        "B_w_gate": _B_in["w_gate"],
        "B_w_up": _B_in["w_up"],
        "B_w_down": _B_in["w_down"],
    }

def reference(A_q, A_k, A_v, A_shift_k, A_ssm_k, A_ssm_D, B_x, B_w_gate, B_w_up, B_w_down):
    def _A_ref(q, k, v, shift_k, ssm_k, ssm_D):
        B, S, D = q.shape
        ks = shift_k.shape[-1]
        k_pad = _pad(k, ((0, 0), (ks - 1, 0), (0, 0)))
        k_shift = torch.zeros_like(k)
        for t in range(ks):
            k_shift = k_shift + k_pad[:, t:t + S, :] * shift_k[:, ks - 1 - t][None, None, :]
        kv = k_shift * v
        L = 2 * S
        kv_pad = _pad(kv, ((0, 0), (0, S), (0, 0)))
        kf_pad = _pad(ssm_k, ((0, 0), (0, S)))
        kv_f = (lambda x, axes=(-2,-1): torch.fft.rfft2(x.float(), dim=axes))(kv_pad[:, None, :, :], axes=(1, 2))
        kf_f = (lambda x, axes=(-2,-1): torch.fft.rfft2(x.float(), dim=axes))(kf_pad[:, None, :], axes=(1, 2))
        kf_f = (lambda x, *d: x.permute(*d))(kf_f, 1, 2, 0)
        y_f = kv_f * kf_f[None, :, :, :]
        y = (lambda x, s, axes=(-2,-1): torch.fft.irfft2(x, s=s, dim=axes).to(torch.bfloat16))(y_f, (1, L), axes=(1, 2))[:, 0, :S, :]
        y = y + kv * ssm_D[None, None, :]
        return q * y

    def _B_ref(x, w_gate, w_up, w_down):
        g = _silu(x @ w_gate)
        u = x @ w_up
        return (g * u) @ w_down

    x = A_q
    xn = _layernorm(x, axis=-1)
    return x + _A_ref(xn, A_k, A_v, A_shift_k, A_ssm_k, A_ssm_D) + _B_ref(xn, B_w_gate, B_w_up, B_w_down)
```

```asm
; @launch grid=(256,1,1) block=(256,1,1) lds=163840
.amdgcn_target "amdgcn-amd-amdhsa--gfx950"
.text
.globl parallel_sum__ssm_conv_h3__swiglu_ffn__prompt_kernel
.p2align 8
.type parallel_sum__ssm_conv_h3__swiglu_ffn__prompt_kernel,@function
parallel_sum__ssm_conv_h3__swiglu_ffn__prompt_kernel:
    s_cmp_ge_u32 s2, 256
    s_cbranch_scc1 END
    s_load_dwordx16 s[4:19], s[0:1], 0
    s_load_dwordx8 s[20:27], s[0:1], 64
    s_load_dwordx2 s[28:29], s[0:1], 96
    s_memrealtime s[72:73]
    s_and_b32 s52, s2, 0xf0
    s_cmp_lg_u32 s52, 0x80
    s_cbranch_scc1 NOCPF
    s_getpc_b64 s[74:75]
    s_and_b32 s52, s2, 8
    s_lshl_b32 s52, s52, 5
    v_add_u32 v2, s52, v0
    v_min_u32 v2, CODE_LINES, v2
    v_lshlrev_b32 v2, 7, v2
    global_load_dword v255, v2, s[74:75]
NOCPF:
    v_lshrrev_b32 v1, 6, v0
    s_nop 0
    v_readfirstlane_b32 s30, v1
    v_and_b32 v0, 63, v0
    s_and_b32 s34, s2, 7
    s_lshr_b32 s35, s2, 3
    s_and_b32 s52, s34, 1
    s_lshl_b32 s52, s52, 2
    s_and_b32 s53, s35, 3
    s_add_u32 s32, s52, s53
    s_lshr_b32 s52, s34, 1
    s_mul_i32 s52, s52, 7
    s_lshr_b32 s54, s35, 2
    s_add_u32 s33, s52, s54
    s_mov_b32 s60, 0xffff0000
    s_cmp_eq_u32 s54, 7
    s_cbranch_scc1 AUX
    s_cmp_eq_u32 s33, 27
    s_cbranch_scc1 AUX
    s_lshl_b32 s52, s32, 8
    s_and_b32 s53, s34, 6
    s_lshl_b32 s53, s53, 5
    s_add_u32 s52, s52, s53
    s_and_b32 s53, s35, 12
    s_add_u32 s53, s53, s30
    s_lshl_b32 s53, s53, 2
    s_add_u32 s52, s52, s53
    v_lshrrev_b32 v76, 4, v0
    v_add_u32 v43, s52, v76
    v_mul_u32_u24 v76, 1280, v43
    v_and_b32 v77, 15, v0
    v_lshl_add_u32 v76, v77, 4, v76
    s_cmp_lt_u32 s35, 16
    s_cselect_b32 s52, 0, 0x40000000
    v_add_u32 v76, s52, v76
    s_and_b32 s52, s35, 3
    s_lshl_b32 s52, s52, 2
    s_lshr_b32 s52, 29488, s52
    s_and_b32 s52, s52, 15
    s_and_b32 s53, s35, 28
    s_lshr_b32 s53, 7538480, s53
    s_and_b32 s53, s53, 15
    s_add_u32 s52, s52, s53
    s_sub_u32 s53, s52, 10
    s_cselect_b32 s52, s52, s53
    s_lshl_b32 s62, s52, 7
    s_lshl_b32 s57, s30, 13
    v_lshrrev_b32 v1, 3, v0
    v_and_b32 v2, 7, v0
    v_bfe_u32 v3, v0, 4, 1
    v_lshlrev_b32 v3, 1, v3
    v_xor_b32 v3, v3, v2
    v_lshlrev_b32 v3, 4, v3
    v_mul_u32_u24 v4, 3456, v1
    s_mul_i32 s52, s30, 55296
    s_lshl_b32 s53, s33, 7
    s_add_u32 s52, s52, s53
    v_add_u32 v4, s52, v4
    v_xor_b32 v5, 64, v3
    v_add_u32 v3, v3, v4
    v_add_u32 v5, v5, v4
    v_add_u32 v10, 3072, v3
    v_add_u32 v11, 29696, v3
    v_add_u32 v12, 1024, v5
    v_add_u32 v13, 27648, v5
    v_lshrrev_b32 v3, 4, v0
    v_xor_b32 v3, v3, v2
    v_lshlrev_b32 v3, 4, v3
    v_mul_u32_u24 v4, 1280, v1
    v_add_u32 v3, v3, v4
    v_xor_b32 v5, 64, v3
    s_mul_i32 s52, s32, 327680
    s_mul_i32 s53, s30, 40960
    s_add_u32 s53, s53, s52
    s_add_u32 s54, s53, 3072
    v_add_u32 v14, s54, v3
    s_add_u32 s54, s53, 12288
    v_add_u32 v15, s54, v5
    s_add_u32 s54, s53, 21504
    v_add_u32 v16, s54, v3
    s_add_u32 s54, s53, 30720
    v_add_u32 v17, s54, v5
    s_movk_i32 s54, 1024
    s_add_u32 s52, s62, 128
    s_cmp_eq_u32 s52, 1280
    s_cselect_b32 s63, 0, s52
    s_mov_b32 s38, 2624512
    s_mov_b32 s39, 0x20000
    s_mov_b32 s42, 2214912
    s_mov_b32 s43, 0x20000
    s_mov_b32 s50, 2214912
    s_mov_b32 s51, 0x20000
    s_mov_b32 s46, 16777216
    s_mov_b32 s47, 0x20000
    s_add_u32 m0, s57, 0
    s_mul_i32 s55, s62, 1728
    s_waitcnt lgkmcnt(0)
    s_sub_u32 s36, s4, 3072
    s_subb_u32 s37, s5, 0
    buffer_load_dwordx4 v[96:99], v76, s[36:39], s54 offen offset:2048
    buffer_load_dwordx4 v[100:103], v76, s[36:39], s54 offen offset:2304
    buffer_load_dwordx4 v[104:107], v76, s[36:39], s54 offen offset:2560
    buffer_load_dwordx4 v[108:111], v76, s[36:39], s54 offen offset:2816
    buffer_load_dwordx4 v[112:115], v76, s[36:39], s54 offen offset:3072
    s_sub_u32 s40, s18, 3072
    s_subb_u32 s41, s19, 0
    s_sub_u32 s48, s20, 3072
    s_subb_u32 s49, s21, 0
    s_lshl_b32 s52, s30, 5
    s_or_b32 s52, s35, s52
    s_cmp_lg_u32 s52, 18
    s_cbranch_scc1 NOTAG
    s_or_b32 s72, s72, 1
    v_mov_b32 v6, s72
    v_mov_b32 v7, 0
    s_mov_b64 exec, 1
    global_atomic_cmpswap v7, v[6:7], s[26:27] sc1
    s_mov_b64 exec, -1
NOTAG:
    buffer_load_dwordx4 v10, s[40:43], s55 offen offset:0  lds
    buffer_load_dwordx4 v11, s[40:43], s55 offen offset:1024  lds
    buffer_load_dwordx4 v12, s[48:51], s55 offen offset:2048  lds
    buffer_load_dwordx4 v13, s[48:51], s55 offen offset:3072  lds
    s_add_u32 m0, s57, 4096
    s_nop 0
    buffer_load_dwordx4 v14, s[36:39], s62 offen offset:0  lds
    buffer_load_dwordx4 v15, s[36:39], s62 offen offset:1024  lds
    buffer_load_dwordx4 v16, s[36:39], s62 offen offset:2048  lds
    buffer_load_dwordx4 v17, s[36:39], s62 offen offset:3072  lds
    s_add_u32 m0, s57, 32768
    s_mul_i32 s55, s63, 1728
    v_mov_b32 v1, 0
    global_load_dword v8, v1, s[26:27] sc1
    s_branch GPRO2
AUX:
    s_and_b32 s52, s34, 1
    s_add_u32 s52, s52, 8
    s_cmp_eq_u32 s54, 7
    s_cselect_b32 s32, s34, s52
    s_mov_b32 s33, s53
    s_mul_i32 s57, s30, 36864
    s_lshl_b32 s58, s33, 7
    s_lshl_b32 s52, s30, 5
    s_add_u32 s58, s58, s52
    v_lshrrev_b32 v1, 3, v0
    v_and_b32 v2, 7, v0
    v_bfe_u32 v3, v0, 4, 1
    v_xor_b32 v2, v2, v3
    v_mul_u32_u24 v1, 1280, v1
    v_lshl_add_u32 v170, v2, 4, v1
    v_xor_b32 v171, 32, v170
    v_xor_b32 v172, 64, v170
    v_xor_b32 v173, 96, v170
    s_mul_i32 s66, s58, 1280
    s_lshl_b32 s54, s32, 7
    s_sub_u32 s55, s66, 10240
    v_add_u32 v174, s55, v170
    s_add_u32 s66, s66, s54
    v_lshrrev_b32 v1, 4, v0
    v_and_b32 v2, 3, v0
    v_lshl_add_u32 v1, v1, 2, v2
    v_lshlrev_b32 v1, 3, v1
    s_lshl_b32 s55, s32, 9
    v_add_u32 v175, s55, v1
    s_waitcnt lgkmcnt(0)
    s_mov_b32 s0, 0
    s_mov_b32 s36, s6
    s_mov_b32 s37, s7
    s_mov_b32 s38, 2621440
    s_mov_b32 s39, 0x20000
    s_mov_b32 s40, s8
    s_mov_b32 s41, s9
    s_mov_b32 s42, 2621440
    s_mov_b32 s43, 0x20000
    s_mov_b32 s44, s28
    s_mov_b32 s45, s29
    s_mov_b32 s46, 16777216
    s_mov_b32 s47, 0x20000
    s_mov_b32 s48, s12
    s_mov_b32 s49, s13
    s_mov_b32 s50, 2621440
    s_mov_b32 s51, 0x20000
    global_load_dwordx2 v[216:217], v175, s[10:11] offset:0
    global_load_dwordx2 v[218:219], v175, s[10:11] offset:128
    global_load_dwordx2 v[220:221], v175, s[10:11] offset:256
    global_load_dwordx2 v[222:223], v175, s[10:11] offset:384
    s_add_u32 m0, s57, 0
    s_nop 0
    buffer_load_dwordx4 v174, s[36:39], s54 offen nt lds
    s_add_u32 m0, s57, 1024
    s_add_u32 s67, s66, 0
    buffer_load_dwordx4 v171, s[36:39], s67 offen nt lds
    s_add_u32 m0, s57, 2048
    s_add_u32 s67, s66, 10240
    buffer_load_dwordx4 v172, s[36:39], s67 offen nt lds
    s_add_u32 m0, s57, 3072
    s_add_u32 s67, s66, 20480
    buffer_load_dwordx4 v173, s[36:39], s67 offen nt lds
    s_add_u32 m0, s57, 4096
    s_add_u32 s67, s66, 30720
    buffer_load_dwordx4 v170, s[36:39], s67 offen nt lds
    s_add_u32 m0, s57, 5120
    s_add_u32 s67, s66, 0
    buffer_load_dwordx4 v170, s[40:43], s67 offen nt lds
    s_add_u32 m0, s57, 6144
    s_add_u32 s67, s66, 10240
    buffer_load_dwordx4 v171, s[40:43], s67 offen nt lds
    s_add_u32 m0, s57, 7168
    s_add_u32 s67, s66, 20480
    buffer_load_dwordx4 v172, s[40:43], s67 offen nt lds
    s_add_u32 m0, s57, 8192
    s_add_u32 s67, s66, 30720
    buffer_load_dwordx4 v173, s[40:43], s67 offen nt lds
    s_branch AUX2
GPRO2:
    s_mov_b32 s0, 0
    s_mov_b32 s44, s28
    s_mov_b32 s45, s29
    s_add_u32 s52, s63, 128
    s_cmp_eq_u32 s52, 1280
    s_cselect_b32 s64, 0, s52
    s_add_u32 s52, s64, 128
    s_cmp_eq_u32 s52, 1280
    s_cselect_b32 s65, 0, s52
    s_add_u32 s52, s65, 128
    s_cmp_eq_u32 s52, 1280
    s_cselect_b32 s66, 0, s52
    s_add_u32 s52, s66, 128
    s_cmp_eq_u32 s52, 1280
    s_cselect_b32 s67, 0, s52
    s_add_u32 s52, s67, 128
    s_cmp_eq_u32 s52, 1280
    s_cselect_b32 s68, 0, s52
    s_add_u32 s52, s68, 128
    s_cmp_eq_u32 s52, 1280
    s_cselect_b32 s69, 0, s52
    s_add_u32 s52, s69, 128
    s_cmp_eq_u32 s52, 1280
    s_cselect_b32 s70, 0, s52
    s_add_u32 s52, s70, 128
    s_cmp_eq_u32 s52, 1280
    s_cselect_b32 s71, 0, s52
    s_and_b32 s54, s30, 1
    s_lshl_b32 s54, s54, 6
    v_xor_b32 v3, s54, v14
    s_mul_i32 s53, s30, -30720
    s_add_u32 s54, s53, 163840
    v_add_u32 v18, s54, v3
    s_add_u32 s54, s53, 162816
    v_add_u32 v19, s54, v3
    s_add_u32 s54, s53, 161792
    v_add_u32 v20, s54, v3
    s_add_u32 s54, s53, 160768
    v_add_u32 v21, s54, v3
    v_bfe_u32 v1, v0, 4, 1
    v_lshrrev_b32 v2, 5, v0
    v_bfe_u32 v3, v0, 2, 2
    v_and_b32 v4, 3, v0
    v_bfe_u32 v5, v0, 3, 2
    v_xor_b32 v5, s30, v5
    v_lshlrev_b32 v5, 5, v5
    v_lshl_add_u32 v5, v4, 3, v5
    v_lshl_add_u32 v5, v3, 7, v5
    v_lshl_add_u32 v5, v2, 10, v5
    v_lshl_add_u32 v22, v1, 11, v5
    v_add_u32 v23, 0x10000, v22
    v_and_b32 v1, 31, v0
    v_bfe_u32 v3, v0, 1, 3
    v_xor_b32 v3, v3, v2
    v_lshlrev_b32 v3, 4, v3
    v_lshl_add_u32 v4, v1, 7, v3
    v_add_u32 v25, 4096, v4
    v_add_u32 v29, 0x10000, v25
    v_xor_b32 v26, 32, v25
    v_add_u32 v30, 0x10000, v26
    v_xor_b32 v27, 64, v25
    v_add_u32 v31, 0x10000, v27
    v_xor_b32 v28, 96, v25
    v_add_u32 v32, 0x10000, v28
    v_bfe_u32 v4, v0, 3, 2
    v_and_b32 v5, 7, v0
    v_lshl_add_u32 v3, v5, 7, v3
    v_lshl_add_u32 v37, v4, 13, v3
    v_xor_b32 v38, 32, v37
    v_xor_b32 v39, 64, v37
    v_xor_b32 v40, 96, v37
    v_add_u32 v33, 0x10000, v37
    v_add_u32 v34, 0x10000, v38
    v_add_u32 v35, 0x10000, v39
    v_add_u32 v36, 0x10000, v40
    v_lshlrev_b32 v41, 4, v0
    s_mul_i32 s52, s32, 864
    s_lshl_b32 s53, s33, 2
    s_add_u32 s52, s52, s53
    s_add_u32 s52, s52, s30
    s_lshl_b32 s52, s52, 10
    s_add_u32 s58, s52, 5242880
    s_lshl_b32 s52, s32, 12
    s_add_u32 s52, s52, 12582912
    v_add_u32 v42, s52, v41
    v_bfe_u32 v4, v0, 2, 2
    v_bfe_u32 v5, v0, 4, 1
    v_cmp_eq_u32 vcc, v4, v5
    v_mov_b32 v4, 0x3f803f80
    s_nop 0
    v_cndmask_b32 v44, 0, v4, vcc
    v_mov_b32 v45, v44
    v_mov_b32 v46, v44
    v_mov_b32 v47, v44
    v_mov_b32 v53, 0
    v_mov_b32 v54, 0
    v_mov_b32 v55, 0
    s_mov_b32 s59, 0x01000100
    s_lshl_b32 s52, s33, 2
    s_add_u32 s52, s52, s30
    s_lshl_b32 s52, s52, 6
    s_lshl_b32 s53, s32, 15
    s_add_u32 s53, s53, s52
    s_add_u32 s78, s53, 12713984
    v_cmp_gt_u32 vcc, 16, v0
    v_mov_b32 v1, 0x80000000
    v_lshlrev_b32 v2, 2, v0
    v_cndmask_b32 v9, v1, v2, vcc
    buffer_load_dwordx4 v10, s[40:43], s55 offen offset:0  lds
    buffer_load_dwordx4 v11, s[40:43], s55 offen offset:1024  lds
    s_waitcnt vmcnt(11)
    s_cmp_ge_u32 s35, 16
    s_cbranch_scc1 NOSTAT
    v_mov_b32 v2, 0x3f803f80
    v_dot2_f32_bf16 v4, v96, v2, 0
    v_dot2_f32_bf16 v5, v97, v2, 0
    v_dot2_f32_bf16 v4, v98, v2, v4
    v_dot2_f32_bf16 v5, v99, v2, v5
    v_dot2_f32_bf16 v4, v100, v2, v4
    v_dot2_f32_bf16 v5, v101, v2, v5
    v_dot2_f32_bf16 v4, v102, v2, v4
    v_dot2_f32_bf16 v5, v103, v2, v5
    v_dot2_f32_bf16 v4, v104, v2, v4
    v_dot2_f32_bf16 v5, v105, v2, v5
    v_dot2_f32_bf16 v4, v106, v2, v4
    v_dot2_f32_bf16 v5, v107, v2, v5
    v_dot2_f32_bf16 v4, v108, v2, v4
    v_dot2_f32_bf16 v5, v109, v2, v5
    v_dot2_f32_bf16 v4, v110, v2, v4
    v_dot2_f32_bf16 v5, v111, v2, v5
    v_dot2_f32_bf16 v4, v112, v2, v4
    v_dot2_f32_bf16 v5, v113, v2, v5
    v_dot2_f32_bf16 v4, v114, v2, v4
    v_dot2_f32_bf16 v5, v115, v2, v5
    v_lshlrev_b32 v128, 16, v96
    v_and_b32 v129, s60, v96
    v_lshlrev_b32 v130, 16, v97
    v_and_b32 v131, s60, v97
    v_lshlrev_b32 v132, 16, v98
    v_and_b32 v133, s60, v98
    v_lshlrev_b32 v134, 16, v99
    v_and_b32 v135, s60, v99
    v_lshlrev_b32 v136, 16, v100
    v_and_b32 v137, s60, v100
    v_lshlrev_b32 v138, 16, v101
    v_and_b32 v139, s60, v101
    v_lshlrev_b32 v140, 16, v102
    v_and_b32 v141, s60, v102
    v_lshlrev_b32 v142, 16, v103
    v_and_b32 v143, s60, v103
    v_lshlrev_b32 v144, 16, v104
    v_and_b32 v145, s60, v104
    v_lshlrev_b32 v146, 16, v105
    v_and_b32 v147, s60, v105
    v_lshlrev_b32 v148, 16, v106
    v_and_b32 v149, s60, v106
    v_lshlrev_b32 v150, 16, v107
    v_and_b32 v151, s60, v107
    v_lshlrev_b32 v152, 16, v108
    v_and_b32 v153, s60, v108
    v_lshlrev_b32 v154, 16, v109
    v_and_b32 v155, s60, v109
    v_lshlrev_b32 v156, 16, v110
    v_and_b32 v157, s60, v110
    v_lshlrev_b32 v158, 16, v111
    v_and_b32 v159, s60, v111
    v_lshlrev_b32 v160, 16, v112
    v_and_b32 v161, s60, v112
    v_lshlrev_b32 v162, 16, v113
    v_and_b32 v163, s60, v113
    v_lshlrev_b32 v164, 16, v114
    v_and_b32 v165, s60, v114
    v_lshlrev_b32 v166, 16, v115
    v_and_b32 v167, s60, v115
    v_add_f32 v4, v4, v5
    s_nop 1
    v_add_f32_dpp v4, v4, v4 row_ror:8 row_mask:0xf bank_mask:0xf
    s_nop 1
    v_add_f32_dpp v4, v4, v4 row_ror:4 row_mask:0xf bank_mask:0xf
    s_nop 1
    v_add_f32_dpp v4, v4, v4 row_ror:2 row_mask:0xf bank_mask:0xf
    s_nop 1
    v_add_f32_dpp v4, v4, v4 row_ror:1 row_mask:0xf bank_mask:0xf
    v_mul_f32 v4, 0xbacccccd, v4
    v_mov_b32 v5, v4
    v_pk_add_f32 v[128:129], v[128:129], v[4:5]
    v_pk_add_f32 v[130:131], v[130:131], v[4:5]
    v_pk_add_f32 v[132:133], v[132:133], v[4:5]
    v_pk_add_f32 v[134:135], v[134:135], v[4:5]
    v_pk_add_f32 v[136:137], v[136:137], v[4:5]
    v_pk_add_f32 v[138:139], v[138:139], v[4:5]
    v_pk_add_f32 v[140:141], v[140:141], v[4:5]
    v_pk_add_f32 v[142:143], v[142:143], v[4:5]
    v_pk_add_f32 v[144:145], v[144:145], v[4:5]
    v_pk_add_f32 v[146:147], v[146:147], v[4:5]
    v_pk_add_f32 v[148:149], v[148:149], v[4:5]
    v_pk_add_f32 v[150:151], v[150:151], v[4:5]
    v_pk_add_f32 v[152:153], v[152:153], v[4:5]
    v_pk_add_f32 v[154:155], v[154:155], v[4:5]
    v_pk_add_f32 v[156:157], v[156:157], v[4:5]
    v_pk_add_f32 v[158:159], v[158:159], v[4:5]
    v_pk_add_f32 v[160:161], v[160:161], v[4:5]
    v_pk_add_f32 v[162:163], v[162:163], v[4:5]
    v_pk_add_f32 v[164:165], v[164:165], v[4:5]
    v_pk_add_f32 v[166:167], v[166:167], v[4:5]
    v_pk_mul_f32 v[168:169], v[128:129], v[128:129]
    v_pk_mul_f32 v[170:171], v[130:131], v[130:131]
    v_pk_fma_f32 v[168:169], v[132:133], v[132:133], v[168:169]
    v_pk_fma_f32 v[170:171], v[134:135], v[134:135], v[170:171]
    v_pk_fma_f32 v[168:169], v[136:137], v[136:137], v[168:169]
    v_pk_fma_f32 v[170:171], v[138:139], v[138:139], v[170:171]
    v_pk_fma_f32 v[168:169], v[140:141], v[140:141], v[168:169]
    v_pk_fma_f32 v[170:171], v[142:143], v[142:143], v[170:171]
    v_pk_fma_f32 v[168:169], v[144:145], v[144:145], v[168:169]
    v_pk_fma_f32 v[170:171], v[146:147], v[146:147], v[170:171]
    v_pk_fma_f32 v[168:169], v[148:149], v[148:149], v[168:169]
    v_pk_fma_f32 v[170:171], v[150:151], v[150:151], v[170:171]
    v_pk_fma_f32 v[168:169], v[152:153], v[152:153], v[168:169]
    v_pk_fma_f32 v[170:171], v[154:155], v[154:155], v[170:171]
    v_pk_fma_f32 v[168:169], v[156:157], v[156:157], v[168:169]
    v_pk_fma_f32 v[170:171], v[158:159], v[158:159], v[170:171]
    v_pk_fma_f32 v[168:169], v[160:161], v[160:161], v[168:169]
    v_pk_fma_f32 v[170:171], v[162:163], v[162:163], v[170:171]
    v_pk_fma_f32 v[168:169], v[164:165], v[164:165], v[168:169]
    v_pk_fma_f32 v[170:171], v[166:167], v[166:167], v[170:171]
    v_pk_add_f32 v[168:169], v[168:169], v[170:171]
    v_add_f32 v6, v168, v169
    s_nop 1
    v_add_f32_dpp v6, v6, v6 row_ror:8 row_mask:0xf bank_mask:0xf
    s_nop 1
    v_add_f32_dpp v6, v6, v6 row_ror:4 row_mask:0xf bank_mask:0xf
    s_nop 1
    v_add_f32_dpp v6, v6, v6 row_ror:2 row_mask:0xf bank_mask:0xf
    s_nop 1
    v_add_f32_dpp v6, v6, v6 row_ror:1 row_mask:0xf bank_mask:0xf
    v_mul_f32 v6, 0x3acccccd, v6
    v_cvt_pk_bf16_f32 v6, v6, v6
    v_lshlrev_b32 v6, 16, v6
    v_add_f32 v6, 0x3727c5ac, v6
    v_cvt_pk_bf16_f32 v6, v6, v6
    v_lshlrev_b32 v6, 16, v6
    v_sqrt_f32 v6, v6
    s_nop 0
    v_cvt_pk_bf16_f32 v4, v4, v6
    v_lshlrev_b32 v2, 6, v0
    ds_bpermute_b32 v4, v2, v4
    v_readfirstlane_b32 s52, v43
    s_nop 0
    s_lshl_b32 s52, s52, 4
    v_cmp_gt_u32 vcc, 4, v0
    v_mov_b32 v5, 0x40000000
    s_nop 0
    v_cndmask_b32 v5, v5, v41, vcc
    v_add_u32 v43, s52, v5
    s_waitcnt lgkmcnt(0)
    s_branch STAT
NOSTAT:
    v_mov_b32 v43, 0x80000000
STAT:
    buffer_load_dwordx4 v12, s[48:51], s55 offen offset:2048  lds
    buffer_load_dwordx4 v13, s[48:51], s55 offen offset:3072  lds
    s_add_u32 m0, s57, 36864
    s_nop 0
    buffer_load_dwordx4 v14, s[36:39], s63 offen offset:0  lds
    buffer_load_dwordx4 v15, s[36:39], s63 offen offset:1024  lds
    buffer_load_dwordx4 v16, s[36:39], s63 offen offset:2048  lds
    buffer_load_dwordx4 v17, s[36:39], s63 offen offset:3072  lds
    s_add_u32 m0, s57, 65536
    s_mul_i32 s55, s64, 1728
    s_branch PAGE0
.p2align 12
PAGE0:
    s_waitcnt vmcnt(9)
    s_barrier
    ds_read_b64_tr_b16 a[0:1], v22 offset:0
    ds_read_b64_tr_b16 a[2:3], v22 offset:512
    ds_read_b128 v[96:99], v25 offset:0
    ds_read_b128 v[100:103], v25 offset:8192
    ds_read_b128 v[104:107], v25 offset:16384
    ds_read_b128 v[108:111], v25 offset:24576
    s_waitcnt lgkmcnt(0)
    v_mfma_f32_32x32x16_bf16 v[128:143], a[0:3], v[96:99], 0
    ds_read_b64_tr_b16 a[4:5], v22 offset:8192
    ds_read_b128 v[112:115], v26 offset:0
    ds_read_b128 v[116:119], v26 offset:8192
    s_waitcnt vmcnt(8)
    v_readfirstlane_b32 s3, v8
    s_nop 0
    s_cmp_eq_u32 s3, 0
    s_cbranch_scc1 SLOW0
BACK0:
    v_mfma_f32_32x32x16_bf16 v[144:159], a[0:3], v[100:103], 0
    ds_read_b64_tr_b16 a[6:7], v22 offset:8704
    ds_read_b128 v[120:123], v26 offset:16384
    buffer_load_dwordx4 v10, s[40:43], s55 offen offset:0  lds
    v_mov_b32 v5, s3
    v_mfma_f32_32x32x16_bf16 v[160:175], a[0:3], v[104:107], 0
    ds_read_b128 v[124:127], v26 offset:24576
    buffer_load_dwordx4 v11, s[40:43], s55 offen offset:1024  lds
    v_mfma_f32_32x32x16_bf16 v[176:191], a[0:3], v[108:111], 0
    buffer_load_dwordx4 v12, s[48:51], s55 offen offset:2048  lds
    s_mov_b32 s56, 12582912
    buffer_store_dwordx4 v[4:7], v43, s[44:47], s56 offen sc1
    v_mfma_f32_16x16x32_bf16 v[48:51], v[44:47], a[0:3], 0
    s_waitcnt lgkmcnt(0)
    v_mfma_f32_32x32x16_bf16 v[128:143], a[4:7], v[112:115], v[128:143]
    ds_read_b64_tr_b16 a[8:9], v22 offset:16384
    ds_read_b128 v[96:99], v27 offset:0
    ds_read_b128 v[100:103], v27 offset:8192
    v_mfma_f32_32x32x16_bf16 v[144:159], a[4:7], v[116:119], v[144:159]
    ds_read_b64_tr_b16 a[10:11], v22 offset:16896
    ds_read_b128 v[104:107], v27 offset:16384
    buffer_load_dwordx4 v13, s[48:51], s55 offen offset:3072  lds
    s_add_u32 m0, s57, 69632
    v_mfma_f32_32x32x16_bf16 v[160:175], a[4:7], v[120:123], v[160:175]
    ds_read_b128 v[108:111], v27 offset:24576
    buffer_load_dwordx4 v14, s[36:39], s64 offen offset:0  lds
    v_mfma_f32_32x32x16_bf16 v[176:191], a[4:7], v[124:127], v[176:191]
    buffer_load_dwordx4 v15, s[36:39], s64 offen offset:1024  lds
    v_mfma_f32_16x16x32_bf16 v[48:51], v[44:47], a[4:7], v[48:51]
    s_waitcnt lgkmcnt(0)
    v_mfma_f32_32x32x16_bf16 v[128:143], a[8:11], v[96:99], v[128:143]
    ds_read_b64_tr_b16 a[12:13], v22 offset:24576
    ds_read_b128 v[112:115], v28 offset:0
    ds_read_b128 v[116:119], v28 offset:8192
    v_mfma_f32_32x32x16_bf16 v[144:159], a[8:11], v[100:103], v[144:159]
    ds_read_b64_tr_b16 a[14:15], v22 offset:25088
    ds_read_b128 v[120:123], v28 offset:16384
    buffer_load_dwordx4 v16, s[36:39], s64 offen offset:2048  lds
    v_mfma_f32_32x32x16_bf16 v[160:175], a[8:11], v[104:107], v[160:175]
    ds_read_b128 v[124:127], v28 offset:24576
    v_mfma_f32_32x32x16_bf16 v[176:191], a[8:11], v[108:111], v[176:191]
    buffer_load_dwordx4 v17, s[36:39], s64 offen offset:3072  lds
    s_add_u32 m0, s57, 0
    s_mul_i32 s55, s65, 1728
    v_mfma_f32_16x16x32_bf16 v[48:51], v[44:47], a[8:11], v[48:51]
    s_waitcnt lgkmcnt(0)
    s_mov_b64 exec, 0
    s_cmp_eq_u32 s30, 0
    s_cbranch_scc1 CHG0
    s_cmp_eq_u32 s30, 1
    s_cbranch_scc1 CHG1
    s_cmp_eq_u32 s30, 2
    s_cbranch_scc1 CHG2
    s_branch CHG3
WRETG:
    s_mov_b64 exec, -1
    s_waitcnt vmcnt(9)
    s_barrier
    v_mfma_f32_32x32x16_bf16 v[128:143], a[12:15], v[112:115], v[128:143]
    ds_read_b64_tr_b16 a[16:17], v22 offset:32768
    ds_read_b128 v[96:99], v25 offset:32768
    ds_read_b128 v[100:103], v25 offset:40960
    v_mfma_f32_32x32x16_bf16 v[144:159], a[12:15], v[116:119], v[144:159]
    ds_read_b64_tr_b16 a[18:19], v22 offset:33280
    ds_read_b128 v[104:107], v25 offset:49152
    buffer_load_dwordx4 v10, s[40:43], s55 offen offset:0  lds
    v_mfma_f32_32x32x16_bf16 v[160:175], a[12:15], v[120:123], v[160:175]
    ds_read_b128 v[108:111], v25 offset:57344
    v_mfma_f32_32x32x16_bf16 v[176:191], a[12:15], v[124:127], v[176:191]
    buffer_load_dwordx4 v11, s[40:43], s55 offen offset:1024  lds
    v_mfma_f32_16x16x32_bf16 v[48:51], v[44:47], a[12:15], v[48:51]
    s_waitcnt lgkmcnt(0)
    v_mfma_f32_32x32x16_bf16 v[128:143], a[16:19], v[96:99], v[128:143]
    ds_read_b64_tr_b16 a[20:21], v22 offset:40960
    ds_read_b128 v[112:115], v26 offset:32768
    ds_read_b128 v[116:119], v26 offset:40960
    v_mfma_f32_32x32x16_bf16 v[144:159], a[16:19], v[100:103], v[144:159]
    ds_read_b64_tr_b16 a[22:23], v22 offset:41472
    ds_read_b128 v[120:123], v26 offset:49152
    buffer_load_dwordx4 v12, s[48:51], s55 offen offset:2048  lds
    v_mfma_f32_32x32x16_bf16 v[160:175], a[16:19], v[104:107], v[160:175]
    ds_read_b128 v[124:127], v26 offset:57344
    v_mfma_f32_32x32x16_bf16 v[176:191], a[16:19], v[108:111], v[176:191]
    buffer_load_dwordx4 v13, s[48:51], s55 offen offset:3072  lds
    s_add_u32 m0, s57, 4096
    v_mfma_f32_16x16x32_bf16 v[48:51], v[44:47], a[16:19], v[48:51]
    s_waitcnt lgkmcnt(0)
    v_mfma_f32_32x32x16_bf16 v[128:143], a[20:23], v[112:115], v[128:143]
    ds_read_b64_tr_b16 a[24:25], v22 offset:49152
    ds_read_b128 v[96:99], v27 offset:32768
    ds_read_b128 v[100:103], v27 offset:40960
    v_mfma_f32_32x32x16_bf16 v[144:159], a[20:23], v[116:119], v[144:159]
    ds_read_b64_tr_b16 a[26:27], v22 offset:49664
    ds_read_b128 v[104:107], v27 offset:49152
    buffer_load_dwordx4 v14, s[36:39], s65 offen offset:0  lds
    v_mfma_f32_32x32x16_bf16 v[160:175], a[20:23], v[120:123], v[160:175]
    ds_read_b128 v[108:111], v27 offset:57344
    v_mfma_f32_32x32x16_bf16 v[176:191], a[20:23], v[124:127], v[176:191]
    buffer_load_dwordx4 v15, s[36:39], s65 offen offset:1024  lds
    v_mfma_f32_16x16x32_bf16 v[48:51], v[44:47], a[20:23], v[48:51]
    s_waitcnt lgkmcnt(0)
    v_mfma_f32_32x32x16_bf16 v[128:143], a[24:27], v[96:99], v[128:143]
    ds_read_b64_tr_b16 a[28:29], v22 offset:57344
    ds_read_b128 v[112:115], v28 offset:32768
    ds_read_b128 v[116:119], v28 offset:40960
    v_mfma_f32_32x32x16_bf16 v[144:159], a[24:27], v[100:103], v[144:159]
    ds_read_b64_tr_b16 a[30:31], v22 offset:57856
    ds_read_b128 v[120:123], v28 offset:49152
    buffer_load_dwordx4 v16, s[36:39], s65 offen offset:2048  lds
    v_mfma_f32_32x32x16_bf16 v[160:175], a[24:27], v[104:107], v[160:175]
    ds_read_b128 v[124:127], v28 offset:57344
    v_mfma_f32_32x32x16_bf16 v[176:191], a[24:27], v[108:111], v[176:191]
    buffer_load_dwordx4 v17, s[36:39], s65 offen offset:3072  lds
    s_add_u32 m0, s57, 32768
    s_mul_i32 s55, s66, 1728
    v_mfma_f32_16x16x32_bf16 v[48:51], v[44:47], a[24:27], v[48:51]
    s_waitcnt lgkmcnt(0)
    s_waitcnt vmcnt(8)
    s_barrier
    v_mfma_f32_32x32x16_bf16 v[128:143], a[28:31], v[112:115], v[128:143]
    ds_read_b64_tr_b16 a[32:33], v23 offset:0
    ds_read_b128 v[96:99], v29 offset:0
    ds_read_b128 v[100:103], v29 offset:8192
    v_mfma_f32_32x32x16_bf16 v[144:159], a[28:31], v[116:119], v[144:159]
    ds_read_b64_tr_b16 a[34:35], v23 offset:512
    ds_read_b128 v[104:107], v29 offset:16384
    buffer_load_dwordx4 v10, s[40:43], s55 offen offset:0  lds
    v_mfma_f32_32x32x16_bf16 v[160:175], a[28:31], v[120:123], v[160:175]
    ds_read_b128 v[108:111], v29 offset:24576
    v_mfma_f32_32x32x16_bf16 v[176:191], a[28:31], v[124:127], v[176:191]
    buffer_load_dwordx4 v11, s[40:43], s55 offen offset:1024  lds
    v_mfma_f32_16x16x32_bf16 v[48:51], v[44:47], a[28:31], v[48:51]
    s_waitcnt lgkmcnt(0)
    v_mfma_f32_32x32x16_bf16 v[128:143], a[32:35], v[96:99], v[128:143]
    ds_read_b64_tr_b16 a[36:37], v23 offset:8192
    ds_read_b128 v[112:115], v30 offset:0
    ds_read_b128 v[116:119], v30 offset:8192
    s_mul_i32 s52, s35, 52
    s_lshr_b32 s52, s52, 8
    s_mul_i32 s53, s52, 5
    v_mfma_f32_32x32x16_bf16 v[144:159], a[32:35], v[100:103], v[144:159]
    ds_read_b64_tr_b16 a[38:39], v23 offset:8704
    ds_read_b128 v[120:123], v30 offset:16384
    buffer_load_dwordx4 v12, s[48:51], s55 offen offset:2048  lds
    s_sub_u32 s53, s35, s53
    s_and_b32 s31, s34, 1
    v_mfma_f32_32x32x16_bf16 v[160:175], a[32:35], v[104:107], v[160:175]
    ds_read_b128 v[124:127], v30 offset:24576
    s_mul_i32 s31, s31, 5
    s_add_u32 s31, s31, s53
    s_and_b32 s61, s52, 1
    s_lshr_b32 s79, s52, 1
    s_and_b32 s54, s34, 6
    v_mfma_f32_32x32x16_bf16 v[176:191], a[32:35], v[108:111], v[176:191]
    buffer_load_dwordx4 v13, s[48:51], s55 offen offset:3072  lds
    s_add_u32 m0, s57, 36864
    s_add_u32 s79, s79, s54
    s_mul_i32 s76, s30, 27
    v_lshlrev_b32 v24, 4, v0
    v_mfma_f32_16x16x32_bf16 v[48:51], v[44:47], a[32:35], v[48:51]
    s_lshl_b32 s52, s79, 3
    s_waitcnt lgkmcnt(0)
    v_mfma_f32_32x32x16_bf16 v[128:143], a[36:39], v[112:115], v[128:143]
    ds_read_b64_tr_b16 a[40:41], v23 offset:16384
    ds_read_b128 v[96:99], v31 offset:0
    ds_read_b128 v[100:103], v31 offset:8192
    s_add_u32 s52, s52, s61
    s_mul_i32 s53, s52, 108
    s_add_u32 s53, s53, s76
    v_mfma_f32_32x32x16_bf16 v[144:159], a[36:39], v[116:119], v[144:159]
    ds_read_b64_tr_b16 a[42:43], v23 offset:16896
    ds_read_b128 v[104:107], v31 offset:16384
    buffer_load_dwordx4 v14, s[36:39], s66 offen offset:0  lds
    s_lshl_b32 s53, s53, 10
    v_add_u32 v43, s53, v24
    v_mfma_f32_32x32x16_bf16 v[160:175], a[36:39], v[120:123], v[160:175]
    ds_read_b128 v[108:111], v31 offset:24576
    v_min_u32 v1, 26, v0
    v_lshlrev_b32 v1, 6, v1
    s_lshl_b32 s52, s79, 15
    s_lshl_b32 s53, s76, 6
    s_add_u32 s52, s52, s53
    v_mfma_f32_32x32x16_bf16 v[176:191], a[36:39], v[124:127], v[176:191]
    buffer_load_dwordx4 v15, s[36:39], s66 offen offset:1024  lds
    s_add_u32 s52, s52, 12713984
    v_add_u32 v95, s52, v1
    s_add_u32 s52, s30, 1
    s_and_b32 s52, s52, 3
    v_mfma_f32_16x16x32_bf16 v[48:51], v[44:47], a[36:39], v[48:51]
    s_mul_i32 s52, s52, 6144
    s_waitcnt lgkmcnt(0)
    v_mfma_f32_32x32x16_bf16 v[128:143], a[40:43], v[96:99], v[128:143]
    ds_read_b64_tr_b16 a[44:45], v23 offset:24576
    ds_read_b128 v[112:115], v32 offset:0
    ds_read_b128 v[116:119], v32 offset:8192
    s_add_u32 s6, s52, 16384
    s_add_u32 s52, s30, 2
    s_and_b32 s52, s52, 3
    v_mfma_f32_32x32x16_bf16 v[144:159], a[40:43], v[100:103], v[144:159]
    ds_read_b64_tr_b16 a[46:47], v23 offset:25088
    ds_read_b128 v[120:123], v32 offset:16384
    buffer_load_dwordx4 v16, s[36:39], s66 offen offset:2048  lds
    s_mul_i32 s52, s52, 6144
    s_add_u32 s7, s52, 18432
    v_mfma_f32_32x32x16_bf16 v[160:175], a[40:43], v[104:107], v[160:175]
    ds_read_b128 v[124:127], v32 offset:24576
    s_add_u32 s52, s30, 3
    s_and_b32 s52, s52, 3
    s_mul_i32 s52, s52, 6144
    s_add_u32 s8, s52, 20480
    s_mul_i32 s53, s30, 6144
    v_mfma_f32_32x32x16_bf16 v[176:191], a[40:43], v[108:111], v[176:191]
    buffer_load_dwordx4 v17, s[36:39], s66 offen offset:3072  lds
    s_add_u32 m0, s57, 65536
    s_mul_i32 s55, s67, 1728
    s_add_u32 s9, s53, 16384
    s_lshl_b32 s10, s30, 10
    v_mfma_f32_16x16x32_bf16 v[48:51], v[44:47], a[40:43], v[48:51]
    s_waitcnt lgkmcnt(0)
    s_waitcnt vmcnt(8)
    s_barrier
    v_mfma_f32_32x32x16_bf16 v[128:143], a[44:47], v[112:115], v[128:143]
    ds_read_b64_tr_b16 a[48:49], v22 offset:0
    ds_read_b128 v[96:99], v25 offset:0
    ds_read_b128 v[100:103], v25 offset:8192
    v_lshrrev_b32 v1, 3, v0
    v_and_b32 v2, 7, v0
    v_lshrrev_b32 v3, 4, v0
    v_mfma_f32_32x32x16_bf16 v[144:159], a[44:47], v[116:119], v[144:159]
    ds_read_b64_tr_b16 a[50:51], v22 offset:512
    ds_read_b128 v[104:107], v25 offset:16384
    buffer_load_dwordx4 v10, s[40:43], s55 offen offset:0  lds
    v_mul_u32_u24 v7, 1280, v1
    v_xor_b32 v6, v3, v2
    v_mfma_f32_32x32x16_bf16 v[160:175], a[44:47], v[120:123], v[160:175]
    ds_read_b128 v[108:111], v25 offset:24576
    v_lshl_add_u32 v6, v6, 4, v7
    s_lshl_b32 s52, s79, 8
    s_lshl_b32 s53, s61, 5
    s_add_u32 s52, s52, s53
    s_and_b32 s53, s30, 1
    v_mfma_f32_32x32x16_bf16 v[176:191], a[44:47], v[124:127], v[176:191]
    buffer_load_dwordx4 v11, s[40:43], s55 offen offset:1024  lds
    s_lshl_b32 s53, s53, 6
    v_xor_b32 v6, s53, v6
    s_lshl_b32 s53, s30, 3
    s_add_u32 s53, s53, s52
    v_mfma_f32_16x16x32_bf16 v[48:51], v[44:47], a[44:47], v[48:51]
    s_mul_i32 s53, s53, 1280
    s_waitcnt lgkmcnt(0)
    v_mfma_f32_32x32x16_bf16 v[128:143], a[48:51], v[96:99], v[128:143]
    ds_read_b64_tr_b16 a[52:53], v22 offset:8192
    ds_read_b128 v[112:115], v26 offset:0
    ds_read_b128 v[116:119], v26 offset:8192
    s_lshl_b32 s54, s31, 7
    s_add_u32 s53, s53, s54
    v_add_u32 v57, s53, v6
    v_mfma_f32_32x32x16_bf16 v[144:159], a[48:51], v[100:103], v[144:159]
    ds_read_b64_tr_b16 a[54:55], v22 offset:8704
    ds_read_b128 v[120:123], v26 offset:16384
    buffer_load_dwordx4 v12, s[48:51], s55 offen offset:2048  lds
    v_and_b32 v1, 31, v0
    v_lshlrev_b32 v93, 2, v1
    v_mfma_f32_32x32x16_bf16 v[160:175], a[48:51], v[104:107], v[160:175]
    ds_read_b128 v[124:127], v26 offset:24576
    v_and_b32 v7, 32, v0
    v_add_u32 v7, v7, v0
    v_add_u32 v7, s52, v7
    v_lshlrev_b32 v7, 4, v7
    v_add_u32 v58, 12582912, v7
    v_mfma_f32_32x32x16_bf16 v[176:191], a[48:51], v[108:111], v[176:191]
    buffer_load_dwordx4 v13, s[48:51], s55 offen offset:3072  lds
    s_add_u32 m0, s57, 69632
    v_lshrrev_b32 v3, 5, v0
    s_lshl_b32 s53, s30, 1
    v_add_u32 v2, s53, v3
    v_mfma_f32_16x16x32_bf16 v[48:51], v[44:47], a[48:51], v[48:51]
    v_bfe_u32 v6, v0, 1, 3
    s_waitcnt lgkmcnt(0)
    v_mfma_f32_32x32x16_bf16 v[128:143], a[52:55], v[112:115], v[128:143]
    ds_read_b64_tr_b16 a[56:57], v22 offset:16384
    ds_read_b128 v[96:99], v27 offset:0
    ds_read_b128 v[100:103], v27 offset:8192
    v_xor_b32 v2, v2, v6
    v_lshlrev_b32 v2, 4, v2
    v_lshl_add_u32 v56, v1, 7, v2
    v_mfma_f32_32x32x16_bf16 v[144:159], a[52:55], v[116:119], v[144:159]
    ds_read_b64_tr_b16 a[58:59], v22 offset:16896
    ds_read_b128 v[104:107], v27 offset:16384
    buffer_load_dwordx4 v14, s[36:39], s67 offen offset:0  lds
    s_lshl_b32 s52, s79, 11
    s_lshl_b32 s53, s61, 9
    v_mfma_f32_32x32x16_bf16 v[160:175], a[52:55], v[120:123], v[160:175]
    ds_read_b128 v[108:111], v27 offset:24576
    s_add_u32 s52, s52, s53
    s_lshl_b32 s53, s31, 2
    s_add_u32 s53, s53, s30
    s_lshl_b32 s54, s53, 16
    s_add_u32 s52, s52, s54
    v_mfma_f32_32x32x16_bf16 v[176:191], a[52:55], v[124:127], v[176:191]
    buffer_load_dwordx4 v15, s[36:39], s67 offen offset:1024  lds
    s_add_u32 s52, s52, 2621440
    v_lshlrev_b32 v7, 4, v1
    v_lshl_add_u32 v7, v3, 15, v7
    v_add_u32 v59, s52, v7
    v_mfma_f32_16x16x32_bf16 v[48:51], v[44:47], a[52:55], v[48:51]
    s_lshl_b32 s53, s53, 8
    s_waitcnt lgkmcnt(0)
    v_mfma_f32_32x32x16_bf16 v[128:143], a[56:59], v[96:99], v[128:143]
    ds_read_b64_tr_b16 a[60:61], v22 offset:24576
    ds_read_b128 v[112:115], v28 offset:0
    ds_read_b128 v[116:119], v28 offset:8192
    s_lshr_b32 s54, s79, 1
    s_lshl_b32 s54, s54, 14
    s_add_u32 s53, s53, s54
    v_mfma_f32_32x32x16_bf16 v[144:159], a[56:59], v[100:103], v[144:159]
    ds_read_b64_tr_b16 a[62:63], v22 offset:25088
    ds_read_b128 v[120:123], v28 offset:16384
    buffer_load_dwordx4 v16, s[36:39], s67 offen offset:2048  lds
    s_add_u32 s53, s53, 12976128
    v_min_u32 v1, 3, v0
    v_mfma_f32_32x32x16_bf16 v[160:175], a[56:59], v[104:107], v[160:175]
    ds_read_b128 v[124:127], v28 offset:24576
    v_lshlrev_b32 v1, 6, v1
    v_add_u32 v92, s53, v1
    s_mov_b32 s52, s61
    s_and_b32 s52, s52, 1
    s_mul_i32 s61, s52, 266240
    v_mfma_f32_32x32x16_bf16 v[176:191], a[56:59], v[108:111], v[176:191]
    buffer_load_dwordx4 v17, s[36:39], s67 offen offset:3072  lds
    s_add_u32 m0, s57, 0
    s_mul_i32 s55, s68, 1728
    s_mul_i32 s79, s52, -286720
    s_mul_i32 s53, s52, 13312
    v_mfma_f32_16x16x32_bf16 v[48:51], v[44:47], a[56:59], v[48:51]
    s_waitcnt lgkmcnt(0)
    s_waitcnt vmcnt(8)
    s_barrier
    v_mfma_f32_32x32x16_bf16 v[128:143], a[60:63], v[112:115], v[128:143]
    ds_read_b64_tr_b16 a[64:65], v22 offset:32768
    ds_read_b128 v[96:99], v25 offset:32768
    ds_read_b128 v[100:103], v25 offset:40960
    s_add_u32 s53, s53, 5246976
    s_add_u32 s16, s28, s53
    s_addc_u32 s17, s29, 0
    v_mfma_f32_32x32x16_bf16 v[144:159], a[60:63], v[116:119], v[144:159]
    ds_read_b64_tr_b16 a[66:67], v22 offset:33280
    ds_read_b128 v[104:107], v25 offset:49152
    buffer_load_dwordx4 v10, s[40:43], s55 offen offset:0  lds
    s_mul_i32 s53, s52, 13312
    s_add_u32 s53, s53, 5255168
    v_mfma_f32_32x32x16_bf16 v[160:175], a[60:63], v[120:123], v[160:175]
    ds_read_b128 v[108:111], v25 offset:57344
    s_add_u32 s18, s28, s53
    s_addc_u32 s19, s29, 0
    s_mul_i32 s53, s52, -14336
    s_add_u32 s53, s53, 5261312
    v_mfma_f32_32x32x16_bf16 v[176:191], a[60:63], v[124:127], v[176:191]
    buffer_load_dwordx4 v11, s[40:43], s55 offen offset:1024  lds
    s_add_u32 s20, s28, s53
    s_addc_u32 s21, s29, 0
    s_mul_i32 s53, s52, -14336
    s_add_u32 s53, s53, 5269504
    v_mfma_f32_16x16x32_bf16 v[48:51], v[44:47], a[60:63], v[48:51]
    s_add_u32 s26, s28, s53
    s_addc_u32 s27, s29, 0
    s_waitcnt lgkmcnt(0)
    v_mfma_f32_32x32x16_bf16 v[128:143], a[64:67], v[96:99], v[128:143]
    ds_read_b64_tr_b16 a[68:69], v22 offset:40960
    ds_read_b128 v[112:115], v26 offset:32768
    ds_read_b128 v[116:119], v26 offset:40960
    buffer_load_dwordx2 v[60:61], v42, s[44:47], 0 offen offset:0 sc1
    v_mfma_f32_32x32x16_bf16 v[144:159], a[64:67], v[100:103], v[144:159]
    ds_read_b64_tr_b16 a[70:71], v22 offset:41472
    ds_read_b128 v[120:123], v26 offset:49152
    buffer_load_dwordx4 v12, s[48:51], s55 offen offset:2048  lds
    buffer_load_dwordx2 v[64:65], v42, s[44:47], 0 offen offset:1024 sc1
    v_mfma_f32_32x32x16_bf16 v[160:175], a[64:67], v[104:107], v[160:175]
    ds_read_b128 v[124:127], v26 offset:57344
    buffer_load_dwordx2 v[68:69], v42, s[44:47], 0 offen offset:2048 sc1
    buffer_load_dwordx2 v[72:73], v42, s[44:47], 0 offen offset:3072 sc1
    v_mfma_f32_32x32x16_bf16 v[176:191], a[64:67], v[108:111], v[176:191]
    buffer_load_dwordx4 v13, s[48:51], s55 offen offset:3072  lds
    s_add_u32 m0, s57, 4096
    v_mfma_f32_16x16x32_bf16 v[48:51], v[44:47], a[64:67], v[48:51]
    s_waitcnt lgkmcnt(0)
    v_mfma_f32_32x32x16_bf16 v[128:143], a[68:71], v[112:115], v[128:143]
    ds_read_b64_tr_b16 a[72:73], v22 offset:49152
    ds_read_b128 v[96:99], v27 offset:32768
    ds_read_b128 v[100:103], v27 offset:40960
    v_mfma_f32_32x32x16_bf16 v[144:159], a[68:71], v[116:119], v[144:159]
    ds_read_b64_tr_b16 a[74:75], v22 offset:49664
    ds_read_b128 v[104:107], v27 offset:49152
    buffer_load_dwordx4 v14, s[36:39], s68 offen offset:0  lds
    v_mfma_f32_32x32x16_bf16 v[160:175], a[68:71], v[120:123], v[160:175]
    ds_read_b128 v[108:111], v27 offset:57344
    v_mfma_f32_32x32x16_bf16 v[176:191], a[68:71], v[124:127], v[176:191]
    buffer_load_dwordx4 v15, s[36:39], s68 offen offset:1024  lds
    v_mfma_f32_16x16x32_bf16 v[48:51], v[44:47], a[68:71], v[48:51]
    s_waitcnt lgkmcnt(0)
    v_mfma_f32_32x32x16_bf16 v[128:143], a[72:75], v[96:99], v[128:143]
    ds_read_b64_tr_b16 a[76:77], v22 offset:57344
    ds_read_b128 v[112:115], v28 offset:32768
    ds_read_b128 v[116:119], v28 offset:40960
    v_mfma_f32_32x32x16_bf16 v[144:159], a[72:75], v[100:103], v[144:159]
    ds_read_b64_tr_b16 a[78:79], v22 offset:57856
    ds_read_b128 v[120:123], v28 offset:49152
    buffer_load_dwordx4 v16, s[36:39], s68 offen offset:2048  lds
    v_mfma_f32_32x32x16_bf16 v[160:175], a[72:75], v[104:107], v[160:175]
    ds_read_b128 v[124:127], v28 offset:57344
    v_mfma_f32_32x32x16_bf16 v[176:191], a[72:75], v[108:111], v[176:191]
    buffer_load_dwordx4 v17, s[36:39], s68 offen offset:3072  lds
    s_add_u32 m0, s57, 32768
    s_mul_i32 s55, s69, 1728
    v_mfma_f32_16x16x32_bf16 v[48:51], v[44:47], a[72:75], v[48:51]
    s_waitcnt lgkmcnt(0)
    s_waitcnt vmcnt(12)
    s_barrier
    v_mfma_f32_32x32x16_bf16 v[128:143], a[76:79], v[112:115], v[128:143]
    ds_read_b64_tr_b16 a[80:81], v23 offset:0
    ds_read_b128 v[96:99], v29 offset:0
    ds_read_b128 v[100:103], v29 offset:8192
    v_mfma_f32_32x32x16_bf16 v[144:159], a[76:79], v[116:119], v[144:159]
    ds_read_b64_tr_b16 a[82:83], v23 offset:512
    ds_read_b128 v[104:107], v29 offset:16384
    buffer_load_dwordx4 v10, s[40:43], s55 offen offset:0  lds
    v_mfma_f32_32x32x16_bf16 v[160:175], a[76:79], v[120:123], v[160:175]
    ds_read_b128 v[108:111], v29 offset:24576
    v_mfma_f32_32x32x16_bf16 v[176:191], a[76:79], v[124:127], v[176:191]
    buffer_load_dwordx4 v11, s[40:43], s55 offen offset:1024  lds
    v_mfma_f32_16x16x32_bf16 v[48:51], v[44:47], a[76:79], v[48:51]
    s_waitcnt lgkmcnt(0)
    v_mfma_f32_32x32x16_bf16 v[128:143], a[80:83], v[96:99], v[128:143]
    ds_read_b64_tr_b16 a[84:85], v23 offset:8192
    ds_read_b128 v[112:115], v30 offset:0
    ds_read_b128 v[116:119], v30 offset:8192
    v_mfma_f32_32x32x16_bf16 v[144:159], a[80:83], v[100:103], v[144:159]
    ds_read_b64_tr_b16 a[86:87], v23 offset:8704
    ds_read_b128 v[120:123], v30 offset:16384
    buffer_load_dwordx4 v12, s[48:51], s55 offen offset:2048  lds
    v_mfma_f32_32x32x16_bf16 v[160:175], a[80:83], v[104:107], v[160:175]
    ds_read_b128 v[124:127], v30 offset:24576
    v_mfma_f32_32x32x16_bf16 v[176:191], a[80:83], v[108:111], v[176:191]
    buffer_load_dwordx4 v13, s[48:51], s55 offen offset:3072  lds
    s_add_u32 m0, s57, 36864
    v_mfma_f32_16x16x32_bf16 v[48:51], v[44:47], a[80:83], v[48:51]
    s_waitcnt lgkmcnt(0)
    v_mfma_f32_32x32x16_bf16 v[128:143], a[84:87], v[112:115], v[128:143]
    ds_read_b64_tr_b16 a[88:89], v23 offset:16384
    ds_read_b128 v[96:99], v31 offset:0
    ds_read_b128 v[100:103], v31 offset:8192
    v_mfma_f32_32x32x16_bf16 v[144:159], a[84:87], v[116:119], v[144:159]
    ds_read_b64_tr_b16 a[90:91], v23 offset:16896
    ds_read_b128 v[104:107], v31 offset:16384
    buffer_load_dwordx4 v14, s[36:39], s69 offen offset:0  lds
    v_mfma_f32_32x32x16_bf16 v[160:175], a[84:87], v[120:123], v[160:175]
    ds_read_b128 v[108:111], v31 offset:24576
    v_mfma_f32_32x32x16_bf16 v[176:191], a[84:87], v[124:127], v[176:191]
    buffer_load_dwordx4 v15, s[36:39], s69 offen offset:1024  lds
    v_mfma_f32_16x16x32_bf16 v[48:51], v[44:47], a[84:87], v[48:51]
    s_waitcnt lgkmcnt(0)
    v_mfma_f32_32x32x16_bf16 v[128:143], a[88:91], v[96:99], v[128:143]
    ds_read_b64_tr_b16 a[92:93], v23 offset:24576
    ds_read_b128 v[112:115], v32 offset:0
    ds_read_b128 v[116:119], v32 offset:8192
    s_sub_u32 s72, s22, 3072
    s_subb_u32 s73, s23, 0
    s_mov_b32 s74, 2214912
    v_mfma_f32_32x32x16_bf16 v[144:159], a[88:91], v[100:103], v[144:159]
    ds_read_b64_tr_b16 a[94:95], v23 offset:25088
    ds_read_b128 v[120:123], v32 offset:16384
    buffer_load_dwordx4 v16, s[36:39], s69 offen offset:2048  lds
    s_mov_b32 s75, 0x20000
    s_sub_u32 s52, s35, 22
    v_mfma_f32_32x32x16_bf16 v[160:175], a[88:91], v[104:107], v[160:175]
    ds_read_b128 v[124:127], v32 offset:24576
    s_lshl_b32 s53, s52, 3
    s_add_u32 s53, s53, s34
    s_mul_i32 s52, s52, 6
    s_add_u32 s52, s52, s34
    s_add_u32 s52, s52, 4
    v_mfma_f32_32x32x16_bf16 v[176:191], a[88:91], v[108:111], v[176:191]
    buffer_load_dwordx4 v17, s[36:39], s69 offen offset:3072  lds
    s_add_u32 m0, s57, 65536
    s_mul_i32 s55, s70, 1728
    s_cmp_lt_u32 s35, 24
    s_cselect_b32 s77, s53, s52
    v_mfma_f32_16x16x32_bf16 v[48:51], v[44:47], a[88:91], v[48:51]
    s_waitcnt lgkmcnt(0)
    s_waitcnt vmcnt(8)
    s_barrier
    v_mfma_f32_32x32x16_bf16 v[128:143], a[92:95], v[112:115], v[128:143]
    ds_read_b64_tr_b16 a[96:97], v22 offset:0
    ds_read_b128 v[96:99], v25 offset:0
    ds_read_b128 v[100:103], v25 offset:8192
    s_add_u32 s52, s77, 16
    s_lshl_b32 s52, s52, 2
    s_add_u32 s52, s52, s30
    v_mfma_f32_32x32x16_bf16 v[144:159], a[92:95], v[116:119], v[144:159]
    ds_read_b64_tr_b16 a[98:99], v22 offset:512
    ds_read_b128 v[104:107], v25 offset:16384
    buffer_load_dwordx4 v10, s[40:43], s55 offen offset:0  lds
    s_mul_i32 s52, s52, 9984
    v_mfma_f32_32x32x16_bf16 v[160:175], a[92:95], v[120:123], v[160:175]
    ds_read_b128 v[108:111], v25 offset:24576
    s_cmp_lt_u32 s35, 20
    s_cselect_b32 s52, 0x40000000, s52
    s_add_u32 s1, s52, 4992
    v_lshlrev_b32 v7, 7, v0
    v_mov_b32 v6, 0x40000000
    v_mfma_f32_32x32x16_bf16 v[176:191], a[92:95], v[124:127], v[176:191]
    buffer_load_dwordx4 v11, s[40:43], s55 offen offset:1024  lds
    v_cmp_gt_u32 vcc, 39, v0
    s_nop 1
    v_cndmask_b32 v7, v6, v7, vcc
    v_mfma_f32_16x16x32_bf16 v[48:51], v[44:47], a[92:95], v[48:51]
    buffer_load_dword v254, v7, s[72:75], s52 offen offset:3072
    s_waitcnt lgkmcnt(0)
    v_mfma_f32_32x32x16_bf16 v[128:143], a[96:99], v[96:99], v[128:143]
    ds_read_b64_tr_b16 a[100:101], v22 offset:8192
    ds_read_b128 v[112:115], v26 offset:0
    ds_read_b128 v[116:119], v26 offset:8192
    buffer_load_dword v255, v7, s[72:75], s1 offen offset:3072
    v_mfma_f32_32x32x16_bf16 v[144:159], a[96:99], v[100:103], v[144:159]
    ds_read_b64_tr_b16 a[102:103], v22 offset:8704
    ds_read_b128 v[120:123], v26 offset:16384
    buffer_load_dwordx4 v12, s[48:51], s55 offen offset:2048  lds
    v_mfma_f32_32x32x16_bf16 v[160:175], a[96:99], v[104:107], v[160:175]
    ds_read_b128 v[124:127], v26 offset:24576
    v_mfma_f32_32x32x16_bf16 v[176:191], a[96:99], v[108:111], v[176:191]
    buffer_load_dwordx4 v13, s[48:51], s55 offen offset:3072  lds
    s_add_u32 m0, s57, 69632
    v_mfma_f32_16x16x32_bf16 v[48:51], v[44:47], a[96:99], v[48:51]
    s_waitcnt lgkmcnt(0)
    v_mfma_f32_32x32x16_bf16 v[128:143], a[100:103], v[112:115], v[128:143]
    ds_read_b64_tr_b16 a[104:105], v22 offset:16384
    ds_read_b128 v[96:99], v27 offset:0
    ds_read_b128 v[100:103], v27 offset:8192
    v_mfma_f32_32x32x16_bf16 v[144:159], a[100:103], v[116:119], v[144:159]
    ds_read_b64_tr_b16 a[106:107], v22 offset:16896
    ds_read_b128 v[104:107], v27 offset:16384
    buffer_load_dwordx4 v14, s[36:39], s70 offen offset:0  lds
    v_mfma_f32_32x32x16_bf16 v[160:175], a[100:103], v[120:123], v[160:175]
    ds_read_b128 v[108:111], v27 offset:24576
    v_mfma_f32_32x32x16_bf16 v[176:191], a[100:103], v[124:127], v[176:191]
    buffer_load_dwordx4 v15, s[36:39], s70 offen offset:1024  lds
    v_mfma_f32_16x16x32_bf16 v[48:51], v[44:47], a[100:103], v[48:51]
    s_waitcnt lgkmcnt(0)
    v_mfma_f32_32x32x16_bf16 v[128:143], a[104:107], v[96:99], v[128:143]
    ds_read_b64_tr_b16 a[108:109], v22 offset:24576
    ds_read_b128 v[112:115], v28 offset:0
    ds_read_b128 v[116:119], v28 offset:8192
    v_mfma_f32_32x32x16_bf16 v[144:159], a[104:107], v[100:103], v[144:159]
    ds_read_b64_tr_b16 a[110:111], v22 offset:25088
    ds_read_b128 v[120:123], v28 offset:16384
    buffer_load_dwordx4 v16, s[36:39], s70 offen offset:2048  lds
    v_mfma_f32_32x32x16_bf16 v[160:175], a[104:107], v[104:107], v[160:175]
    ds_read_b128 v[124:127], v28 offset:24576
    v_mfma_f32_32x32x16_bf16 v[176:191], a[104:107], v[108:111], v[176:191]
    buffer_load_dwordx4 v17, s[36:39], s70 offen offset:3072  lds
    s_add_u32 m0, s57, 0
    s_mul_i32 s55, s71, 1728
    v_mfma_f32_16x16x32_bf16 v[48:51], v[44:47], a[104:107], v[48:51]
    s_waitcnt lgkmcnt(0)
    s_waitcnt vmcnt(10)
    s_barrier
    v_mfma_f32_32x32x16_bf16 v[128:143], a[108:111], v[112:115], v[128:143]
    ds_read_b64_tr_b16 a[112:113], v22 offset:32768
    ds_read_b128 v[96:99], v25 offset:32768
    ds_read_b128 v[100:103], v25 offset:40960
    v_mfma_f32_32x32x16_bf16 v[144:159], a[108:111], v[116:119], v[144:159]
    ds_read_b64_tr_b16 a[114:115], v22 offset:33280
    ds_read_b128 v[104:107], v25 offset:49152
    buffer_load_dwordx4 v10, s[40:43], s55 offen offset:0  lds
    v_mfma_f32_32x32x16_bf16 v[160:175], a[108:111], v[120:123], v[160:175]
    ds_read_b128 v[108:111], v25 offset:57344
    v_mfma_f32_32x32x16_bf16 v[176:191], a[108:111], v[124:127], v[176:191]
CHG0:
PAD0:
    s_cbranch_execz PAD1
    buffer_load_dwordx4 v11, s[40:43], s55 offen offset:1024  lds
    v_mfma_f32_16x16x32_bf16 v[48:51], v[44:47], a[108:111], v[48:51]
    s_waitcnt lgkmcnt(0)
    v_mfma_f32_32x32x16_bf16 v[128:143], a[112:115], v[96:99], v[128:143]
    ds_read_b64_tr_b16 a[116:117], v22 offset:40960
    ds_read_b128 v[112:115], v26 offset:32768
    ds_read_b128 v[116:119], v26 offset:40960
    v_xor_b32 v61, s3, v61
    v_xor_b32 v65, s3, v65
    v_xor_b32 v69, s3, v69
    v_mfma_f32_32x32x16_bf16 v[144:159], a[112:115], v[100:103], v[144:159]
    ds_read_b64_tr_b16 a[118:119], v22 offset:41472
    ds_read_b128 v[120:123], v26 offset:49152
    buffer_load_dwordx4 v12, s[48:51], s55 offen offset:2048  lds
    v_xor_b32 v73, s3, v73
    v_or3_b32 v61, v61, v65, v69
    v_mfma_f32_32x32x16_bf16 v[160:175], a[112:115], v[104:107], v[160:175]
    ds_read_b128 v[124:127], v26 offset:57344
    v_or_b32 v61, v61, v73
    v_cmp_ne_u32 vcc, 0, v61
    s_nop 0
    s_cbranch_vccnz SLOW1
BACK1:
    v_and_b32 v61, s60, v60
    v_mfma_f32_32x32x16_bf16 v[176:191], a[112:115], v[108:111], v[176:191]
    buffer_load_dwordx4 v13, s[48:51], s55 offen offset:3072  lds
    s_add_u32 m0, s57, 4096
    v_and_b32 v65, s60, v64
    v_and_b32 v69, s60, v68
    v_and_b32 v73, s60, v72
    v_mfma_f32_16x16x32_bf16 v[48:51], v[44:47], a[112:115], v[48:51]
    v_rcp_f32 v61, v61
    s_waitcnt lgkmcnt(0)
    v_mfma_f32_32x32x16_bf16 v[128:143], a[116:119], v[112:115], v[128:143]
    ds_read_b64_tr_b16 a[120:121], v22 offset:49152
    ds_read_b128 v[96:99], v27 offset:32768
    ds_read_b128 v[100:103], v27 offset:40960
    v_rcp_f32 v65, v65
    v_mfma_f32_32x32x16_bf16 v[144:159], a[116:119], v[116:119], v[144:159]
    ds_read_b64_tr_b16 a[122:123], v22 offset:49664
    ds_read_b128 v[104:107], v27 offset:49152
    buffer_load_dwordx4 v14, s[36:39], s71 offen offset:0  lds
    v_rcp_f32 v69, v69
    v_mfma_f32_32x32x16_bf16 v[160:175], a[116:119], v[120:123], v[160:175]
    ds_read_b128 v[108:111], v27 offset:57344
    v_rcp_f32 v73, v73
    v_mov_b32 v62, v60
    v_mov_b32 v66, v64
    v_mov_b32 v70, v68
    v_mfma_f32_32x32x16_bf16 v[176:191], a[116:119], v[124:127], v[176:191]
    buffer_load_dwordx4 v15, s[36:39], s71 offen offset:1024  lds
    v_mov_b32 v74, v72
    v_mul_f32 v61, 0xbfb8aa3b, v61
    v_mul_f32 v65, 0xbfb8aa3b, v65
    v_mul_f32 v69, 0xbfb8aa3b, v69
    v_mfma_f32_16x16x32_bf16 v[48:51], v[44:47], a[116:119], v[48:51]
    v_mul_f32 v73, 0xbfb8aa3b, v73
    s_waitcnt lgkmcnt(0)
    v_mfma_f32_32x32x16_bf16 v[128:143], a[120:123], v[96:99], v[128:143]
    ds_read_b64_tr_b16 a[124:125], v22 offset:57344
    ds_read_b128 v[112:115], v28 offset:32768
    ds_read_b128 v[116:119], v28 offset:40960
    v_mov_b32 v63, v61
    v_mov_b32 v67, v65
    v_mov_b32 v71, v69
    v_mfma_f32_32x32x16_bf16 v[144:159], a[120:123], v[100:103], v[144:159]
    ds_read_b64_tr_b16 a[126:127], v22 offset:57856
    ds_read_b128 v[120:123], v28 offset:49152
    buffer_load_dwordx4 v16, s[36:39], s71 offen offset:2048  lds
    v_mov_b32 v75, v73
    v_permlane32_swap_b32 v60, v62
    v_mfma_f32_32x32x16_bf16 v[160:175], a[120:123], v[104:107], v[160:175]
    ds_read_b128 v[124:127], v28 offset:57344
    v_permlane32_swap_b32 v64, v66
    v_permlane32_swap_b32 v68, v70
    v_permlane32_swap_b32 v72, v74
    v_permlane32_swap_b32 v61, v63
    v_permlane32_swap_b32 v65, v67
    v_mfma_f32_32x32x16_bf16 v[176:191], a[120:123], v[108:111], v[176:191]
    buffer_load_dwordx4 v17, s[36:39], s71 offen offset:3072  lds
    s_add_u32 m0, s57, 32768
    v_permlane32_swap_b32 v69, v71
    v_permlane32_swap_b32 v73, v75
    v_mfma_f32_16x16x32_bf16 v[48:51], v[44:47], a[120:123], v[48:51]
    s_waitcnt lgkmcnt(0)
    s_waitcnt vmcnt(8)
    s_barrier
    v_mfma_f32_32x32x16_bf16 v[128:143], a[124:127], v[112:115], v[128:143]
    ds_read_b64_tr_b16 a[128:129], v23 offset:0
    ds_read_b128 v[96:99], v29 offset:0
    ds_read_b128 v[100:103], v29 offset:8192
    v_mfma_f32_32x32x16_bf16 v[144:159], a[124:127], v[116:119], v[144:159]
    ds_read_b64_tr_b16 a[130:131], v23 offset:512
    ds_read_b128 v[104:107], v29 offset:16384
    buffer_load_dwordx4 v18, s[36:39], s62 offen offset:0  lds
    v_mfma_f32_32x32x16_bf16 v[160:175], a[124:127], v[120:123], v[160:175]
    ds_read_b128 v[108:111], v29 offset:24576
    v_mfma_f32_32x32x16_bf16 v[176:191], a[124:127], v[124:127], v[176:191]
    buffer_load_dwordx4 v19, s[36:39], s63 offen offset:1024  lds
    v_mfma_f32_16x16x32_bf16 v[48:51], v[44:47], a[124:127], v[48:51]
    s_waitcnt lgkmcnt(0)
    v_mfma_f32_32x32x16_bf16 v[128:143], a[128:131], v[96:99], v[128:143]
    ds_read_b64_tr_b16 a[132:133], v23 offset:8192
    ds_read_b128 v[112:115], v30 offset:0
    ds_read_b128 v[116:119], v30 offset:8192
    v_lshrrev_b32 v1, 3, v0
    v_and_b32 v2, 7, v0
    v_bfe_u32 v3, v0, 4, 1
    v_mfma_f32_32x32x16_bf16 v[144:159], a[128:131], v[100:103], v[144:159]
    ds_read_b64_tr_b16 a[134:135], v23 offset:8704
    ds_read_b128 v[120:123], v30 offset:16384
    buffer_load_dwordx4 v20, s[36:39], s64 offen offset:2048  lds
    v_lshlrev_b32 v6, 2, v3
    v_xor_b32 v6, v6, v2
    v_mfma_f32_32x32x16_bf16 v[160:175], a[128:131], v[104:107], v[160:175]
    ds_read_b128 v[124:127], v30 offset:24576
    v_mul_u32_u24 v7, 1280, v1
    v_lshl_add_u32 v6, v6, 4, v7
    s_mul_i32 s52, s76, 20480
    s_lshl_b32 s53, s31, 7
    s_add_u32 s52, s52, s53
    v_mfma_f32_32x32x16_bf16 v[176:191], a[128:131], v[108:111], v[176:191]
    buffer_load_dwordx4 v21, s[36:39], s65 offen offset:3072  lds
    s_add_u32 m0, s57, 36864
    s_add_u32 s53, s52, 3072
    v_add_u32 v10, s53, v6
    s_add_u32 s53, s52, 12288
    v_mfma_f32_16x16x32_bf16 v[48:51], v[44:47], a[128:131], v[48:51]
    v_add_u32 v11, s53, v6
    s_waitcnt lgkmcnt(0)
    v_mfma_f32_32x32x16_bf16 v[128:143], a[132:135], v[112:115], v[128:143]
    ds_read_b64_tr_b16 a[136:137], v23 offset:16384
    ds_read_b128 v[96:99], v31 offset:0
    ds_read_b128 v[100:103], v31 offset:8192
    s_add_u32 s53, s52, 21504
    v_add_u32 v12, s53, v6
    s_add_u32 s53, s52, 30720
    v_mfma_f32_32x32x16_bf16 v[144:159], a[132:135], v[116:119], v[144:159]
    ds_read_b64_tr_b16 a[138:139], v23 offset:16896
    ds_read_b128 v[104:107], v31 offset:16384
    buffer_load_dwordx4 v18, s[36:39], s66 offen offset:0  lds
    v_add_u32 v13, s53, v6
    v_lshrrev_b32 v1, 5, v0
    v_mfma_f32_32x32x16_bf16 v[160:175], a[132:135], v[120:123], v[160:175]
    ds_read_b128 v[108:111], v31 offset:24576
    v_bfe_u32 v2, v0, 2, 2
    v_lshl_add_u32 v1, v1, 2, v2
    v_lshlrev_b32 v1, 7, v1
    v_and_b32 v2, 1, v0
    v_lshl_add_u32 v1, v2, 4, v1
    v_mfma_f32_32x32x16_bf16 v[176:191], a[132:135], v[124:127], v[176:191]
    buffer_load_dwordx4 v19, s[36:39], s67 offen offset:1024  lds
    v_bfe_u32 v2, v0, 1, 1
    v_lshl_add_u32 v1, v2, 3, v1
    s_add_u32 s53, s57, 98304
    v_add_u32 v1, s53, v1
    v_mfma_f32_16x16x32_bf16 v[48:51], v[44:47], a[132:135], v[48:51]
    s_add_u32 s53, s30, 1
    s_waitcnt lgkmcnt(0)
    v_mfma_f32_32x32x16_bf16 v[128:143], a[136:139], v[96:99], v[128:143]
    ds_read_b64_tr_b16 a[140:141], v23 offset:24576
    ds_read_b128 v[112:115], v32 offset:0
    ds_read_b128 v[116:119], v32 offset:8192
    v_add_u32 v3, s53, v3
    v_lshrrev_b32 v2, 2, v0
    v_and_b32 v2, 2, v2
    v_mfma_f32_32x32x16_bf16 v[144:159], a[136:139], v[100:103], v[144:159]
    ds_read_b64_tr_b16 a[142:143], v23 offset:25088
    ds_read_b128 v[120:123], v32 offset:16384
    buffer_load_dwordx4 v20, s[36:39], s68 offen offset:2048  lds
    v_xor_b32 v3, v3, v2
    v_and_b32 v3, 3, v3
    v_mfma_f32_32x32x16_bf16 v[160:175], a[136:139], v[104:107], v[160:175]
    ds_read_b128 v[124:127], v32 offset:24576
    v_lshl_add_u32 v14, v3, 5, v1
    v_xor_b32 v15, 64, v14
    s_mov_b32 s40, s4
    s_mov_b32 s41, s5
    s_mov_b32 s42, 2621440
    v_mfma_f32_32x32x16_bf16 v[176:191], a[136:139], v[108:111], v[176:191]
    buffer_load_dwordx4 v21, s[36:39], s69 offen offset:3072  lds
    s_add_u32 m0, s57, 65536
    s_mov_b32 s43, 0x20000
    s_mov_b32 s48, s24
    s_mov_b32 s49, s25
    v_mfma_f32_16x16x32_bf16 v[48:51], v[44:47], a[136:139], v[48:51]
    s_waitcnt lgkmcnt(0)
    s_waitcnt vmcnt(8)
    s_barrier
    v_mfma_f32_32x32x16_bf16 v[128:143], a[140:143], v[112:115], v[128:143]
    ds_read_b64_tr_b16 a[144:145], v22 offset:0
    ds_read_b128 v[96:99], v25 offset:0
    ds_read_b128 v[100:103], v25 offset:8192
    s_mov_b32 s50, 2621440
    s_mov_b32 s51, 0x20000
    v_mfma_f32_32x32x16_bf16 v[144:159], a[140:143], v[116:119], v[144:159]
    ds_read_b64_tr_b16 a[146:147], v22 offset:512
    ds_read_b128 v[104:107], v25 offset:16384
    s_add_u32 s55, s70, 0
    buffer_load_dwordx4 v18, s[36:39], s55 offen offset:0  lds
    v_mfma_f32_32x32x16_bf16 v[160:175], a[140:143], v[120:123], v[160:175]
    ds_read_b128 v[108:111], v25 offset:24576
    v_mfma_f32_32x32x16_bf16 v[176:191], a[140:143], v[124:127], v[176:191]
    s_add_u32 s55, s71, 0
    buffer_load_dwordx4 v19, s[36:39], s55 offen offset:1024  lds
    v_mfma_f32_16x16x32_bf16 v[48:51], v[44:47], a[140:143], v[48:51]
    s_waitcnt lgkmcnt(0)
    v_mfma_f32_32x32x16_bf16 v[128:143], a[144:147], v[96:99], v[128:143]
    ds_read_b64_tr_b16 a[148:149], v22 offset:8192
    ds_read_b128 v[112:115], v26 offset:0
    ds_read_b128 v[116:119], v26 offset:8192
    v_mfma_f32_32x32x16_bf16 v[144:159], a[144:147], v[100:103], v[144:159]
    ds_read_b64_tr_b16 a[150:151], v22 offset:8704
    ds_read_b128 v[120:123], v26 offset:16384
    s_add_u32 s55, s70, 40960
    buffer_load_dwordx4 v20, s[36:39], s55 offen offset:2048  lds
    v_mfma_f32_32x32x16_bf16 v[160:175], a[144:147], v[104:107], v[160:175]
    ds_read_b128 v[124:127], v26 offset:24576
    v_mfma_f32_32x32x16_bf16 v[176:191], a[144:147], v[108:111], v[176:191]
    s_add_u32 s55, s71, 40960
    buffer_load_dwordx4 v21, s[36:39], s55 offen offset:3072  lds
    s_add_u32 m0, s57, 69632
    v_mfma_f32_16x16x32_bf16 v[48:51], v[44:47], a[144:147], v[48:51]
    s_waitcnt lgkmcnt(0)
    v_mfma_f32_32x32x16_bf16 v[128:143], a[148:151], v[112:115], v[128:143]
    ds_read_b64_tr_b16 a[152:153], v22 offset:16384
    ds_read_b128 v[96:99], v27 offset:0
    ds_read_b128 v[100:103], v27 offset:8192
    v_mfma_f32_32x32x16_bf16 v[144:159], a[148:151], v[116:119], v[144:159]
    ds_read_b64_tr_b16 a[154:155], v22 offset:16896
    ds_read_b128 v[104:107], v27 offset:16384
    s_add_u32 s55, s70, 81920
    buffer_load_dwordx4 v18, s[36:39], s55 offen offset:0  lds
    v_mfma_f32_32x32x16_bf16 v[160:175], a[148:151], v[120:123], v[160:175]
    ds_read_b128 v[108:111], v27 offset:24576
    v_mfma_f32_32x32x16_bf16 v[176:191], a[148:151], v[124:127], v[176:191]
    s_add_u32 s55, s71, 81920
    buffer_load_dwordx4 v19, s[36:39], s55 offen offset:1024  lds
    v_mfma_f32_16x16x32_bf16 v[48:51], v[44:47], a[148:151], v[48:51]
    s_waitcnt lgkmcnt(0)
    v_mfma_f32_32x32x16_bf16 v[128:143], a[152:155], v[96:99], v[128:143]
    ds_read_b64_tr_b16 a[156:157], v22 offset:24576
    ds_read_b128 v[112:115], v28 offset:0
    ds_read_b128 v[116:119], v28 offset:8192
    v_mfma_f32_32x32x16_bf16 v[144:159], a[152:155], v[100:103], v[144:159]
    ds_read_b64_tr_b16 a[158:159], v22 offset:25088
    ds_read_b128 v[120:123], v28 offset:16384
    s_add_u32 s55, s70, 122880
    buffer_load_dwordx4 v20, s[36:39], s55 offen offset:2048  lds
    v_mfma_f32_32x32x16_bf16 v[160:175], a[152:155], v[104:107], v[160:175]
    ds_read_b128 v[124:127], v28 offset:24576
    v_mfma_f32_32x32x16_bf16 v[176:191], a[152:155], v[108:111], v[176:191]
    s_add_u32 s55, s71, 122880
    buffer_load_dwordx4 v21, s[36:39], s55 offen offset:3072  lds
    v_mfma_f32_16x16x32_bf16 v[48:51], v[44:47], a[152:155], v[48:51]
    s_waitcnt lgkmcnt(0)
    s_waitcnt vmcnt(8)
    s_barrier
    v_mfma_f32_32x32x16_bf16 v[128:143], a[156:159], v[112:115], v[128:143]
    ds_read_b128 v[96:99], v37 offset:32768
    ds_read_b128 v[100:103], v38 offset:32768
    ds_read_b128 v[104:107], v39 offset:32768
    v_mfma_f32_32x32x16_bf16 v[144:159], a[156:159], v[116:119], v[144:159]
    ds_read_b128 v[108:111], v40 offset:32768
    v_mfma_f32_32x32x16_bf16 v[160:175], a[156:159], v[120:123], v[160:175]
    v_mfma_f32_32x32x16_bf16 v[176:191], a[156:159], v[124:127], v[176:191]
    v_mfma_f32_16x16x32_bf16 v[48:51], v[44:47], a[156:159], v[48:51]
    s_cmp_ge_u32 s35, 20
    s_cbranch_scc1 ROLEB
    s_waitcnt lgkmcnt(1)
    v_mfma_f32_32x32x16_bf16 v[192:207], a[0:3], v[96:99], 0
    ds_read_b128 v[112:115], v37 offset:33792
    ds_read_b128 v[116:119], v38 offset:33792
    ds_read_b128 v[120:123], v39 offset:33792
    s_add_u32 m0, s57, 0
    v_add_u32 v18, 40960, v18
    v_add_u32 v19, 40960, v19
    v_add_u32 v20, 40960, v20
    v_mfma_f32_32x32x16_bf16 v[192:207], a[4:7], v[100:103], v[192:207]
    ds_read_b128 v[124:127], v40 offset:33792
    v_cvt_pk_bf16_f32 v52, v48, v48
    v_lshlrev_b32 v52, 16, v52
    v_sub_f32 v52, v48, v52
    v_cvt_pk_bf16_f32 v52, v48, v52
    v_mov_b32 v51, 0
    v_add_u32 v21, 40960, v21
    v_mfma_f32_32x32x16_bf16 v[192:207], a[8:11], v[104:107], v[192:207]
    ds_read_b128 v[96:99], v37 offset:34816
    buffer_load_dwordx4 v18, s[36:39], s62 offen offset:0  lds
    buffer_load_dwordx4 v19, s[36:39], s63 offen offset:1024  lds
    s_waitcnt lgkmcnt(3)
    v_mfma_f32_32x32x16_bf16 v[192:207], a[12:15], v[108:111], v[192:207]
    ds_read_b128 v[100:103], v38 offset:34816
    buffer_load_dwordx4 v20, s[36:39], s64 offen offset:2048  lds
    v_perm_b32 v50, v60, v60, s59
    v_mfma_f32_32x32x16_bf16 v[192:207], a[16:19], v[112:115], v[192:207]
    ds_read_b128 v[104:107], v39 offset:34816
    v_mfma_f32_32x32x16_bf16 v[128:143], v[52:55], v[50:53], v[128:143]
    buffer_load_dwordx4 v21, s[36:39], s65 offen offset:3072  lds
    s_add_u32 m0, s57, 4096
    v_perm_b32 v50, v62, v62, s59
    v_mfma_f32_32x32x16_bf16 v[192:207], a[20:23], v[116:119], v[192:207]
    ds_read_b128 v[108:111], v40 offset:34816
    v_mfma_f32_32x32x16_bf16 v[144:159], v[52:55], v[50:53], v[144:159]
    buffer_load_dwordx4 v18, s[36:39], s66 offen offset:0  lds
    v_perm_b32 v50, v64, v64, s59
    s_waitcnt lgkmcnt(3)
    v_mfma_f32_32x32x16_bf16 v[192:207], a[24:27], v[120:123], v[192:207]
    ds_read_b128 v[112:115], v37 offset:35840
    v_mfma_f32_32x32x16_bf16 v[160:175], v[52:55], v[50:53], v[160:175]
    buffer_load_dwordx4 v19, s[36:39], s67 offen offset:1024  lds
    v_perm_b32 v50, v66, v66, s59
    v_mul_f32 v76, v128, v61
    v_mul_f32 v77, v129, v61
    v_mul_f32 v78, v130, v61
    v_mul_f32 v79, v131, v61
    v_mfma_f32_32x32x16_bf16 v[192:207], a[28:31], v[124:127], v[192:207]
    ds_read_b128 v[116:119], v38 offset:35840
    buffer_load_dwordx4 v20, s[36:39], s68 offen offset:2048  lds
    v_exp_f32 v76, v76
    v_exp_f32 v77, v77
    v_mfma_f32_32x32x16_bf16 v[176:191], v[52:55], v[50:53], v[176:191]
    v_exp_f32 v78, v78
    v_exp_f32 v79, v79
    v_mul_f32 v136, v128, v136
    v_mul_f32 v137, v129, v137
    v_mul_f32 v138, v130, v138
    v_mfma_f32_32x32x16_bf16 v[192:207], a[32:35], v[96:99], v[192:207]
    ds_read_b128 v[120:123], v39 offset:35840
    buffer_load_dwordx4 v21, s[36:39], s69 offen offset:3072  lds
    s_add_u32 m0, s57, 98304
    s_add_u32 s1, s61, 0
    v_mul_f32 v139, v131, v139
    v_add_f32 v76, 1.0, v76
    s_waitcnt lgkmcnt(3)
    v_mfma_f32_32x32x16_bf16 v[192:207], a[36:39], v[100:103], v[192:207]
    ds_read_b128 v[124:127], v40 offset:35840
    v_add_f32 v77, 1.0, v77
    v_add_f32 v78, 1.0, v78
    v_add_f32 v79, 1.0, v79
    v_rcp_f32 v76, v76
    v_mfma_f32_32x32x16_bf16 v[192:207], a[40:43], v[104:107], v[192:207]
    ds_read_b128 v[96:99], v37 offset:36864
    buffer_load_dwordx4 v10, s[72:75], s1 offen offset:0  lds
    v_rcp_f32 v77, v77
    v_rcp_f32 v78, v78
    v_mfma_f32_32x32x16_bf16 v[192:207], a[44:47], v[108:111], v[192:207]
    ds_read_b128 v[100:103], v38 offset:36864
    buffer_load_dwordx4 v11, s[72:75], s1 offen offset:1024  lds
    v_rcp_f32 v79, v79
    v_mul_f32 v136, v136, v76
    s_waitcnt lgkmcnt(3)
    v_mfma_f32_32x32x16_bf16 v[192:207], a[48:51], v[112:115], v[192:207]
    ds_read_b128 v[104:107], v39 offset:36864
    v_mul_f32 v137, v137, v77
    v_mul_f32 v138, v138, v78
    v_mul_f32 v139, v139, v79
    v_cvt_pk_bf16_f32 v84, v136, v137
    v_cvt_pk_bf16_f32 v85, v138, v139
    v_mul_f32 v80, v132, v61
    v_mfma_f32_32x32x16_bf16 v[192:207], a[52:55], v[116:119], v[192:207]
    ds_read_b128 v[108:111], v40 offset:36864
    buffer_load_dwordx4 v12, s[72:75], s1 offen offset:2048  lds
    v_mul_f32 v81, v133, v61
    v_mul_f32 v82, v134, v61
    v_mul_f32 v83, v135, v61
    v_exp_f32 v80, v80
    v_mfma_f32_32x32x16_bf16 v[192:207], a[56:59], v[120:123], v[192:207]
    ds_read_b128 v[112:115], v37 offset:37888
    buffer_load_dwordx4 v13, s[72:75], s1 offen offset:3072  lds
    s_add_u32 m0, s57, 102400
    s_add_u32 s1, s61, 40960
    s_waitcnt lgkmcnt(3)
    v_mfma_f32_32x32x16_bf16 v[192:207], a[60:63], v[124:127], v[192:207]
    ds_read_b128 v[116:119], v38 offset:37888
    v_exp_f32 v81, v81
    v_exp_f32 v82, v82
    v_exp_f32 v83, v83
    v_mul_f32 v140, v132, v140
    v_mfma_f32_32x32x16_bf16 v[192:207], a[64:67], v[96:99], v[192:207]
    ds_read_b128 v[120:123], v39 offset:37888
    buffer_load_dwordx4 v10, s[72:75], s1 offen offset:0  lds
    v_mul_f32 v141, v133, v141
    v_mul_f32 v142, v134, v142
    v_mul_f32 v143, v135, v143
    v_add_f32 v80, 1.0, v80
    v_mfma_f32_32x32x16_bf16 v[192:207], a[68:71], v[100:103], v[192:207]
    ds_read_b128 v[124:127], v40 offset:37888
    v_add_f32 v81, 1.0, v81
    v_add_f32 v82, 1.0, v82
    v_add_f32 v83, 1.0, v83
    v_rcp_f32 v80, v80
    s_waitcnt lgkmcnt(3)
    v_mfma_f32_32x32x16_bf16 v[192:207], a[72:75], v[104:107], v[192:207]
    ds_read_b128 v[96:99], v37 offset:38912
    buffer_load_dwordx4 v11, s[72:75], s1 offen offset:1024  lds
    v_rcp_f32 v81, v81
    v_rcp_f32 v82, v82
    v_mfma_f32_32x32x16_bf16 v[192:207], a[76:79], v[108:111], v[192:207]
    ds_read_b128 v[100:103], v38 offset:38912
    buffer_load_dwordx4 v12, s[72:75], s1 offen offset:2048  lds
    v_rcp_f32 v83, v83
    v_mul_f32 v140, v140, v80
    v_mul_f32 v141, v141, v81
    v_mfma_f32_32x32x16_bf16 v[192:207], a[80:83], v[112:115], v[192:207]
    ds_read_b128 v[104:107], v39 offset:38912
    v_mul_f32 v142, v142, v82
    v_mul_f32 v143, v143, v83
    v_cvt_pk_bf16_f32 v86, v140, v141
    v_cvt_pk_bf16_f32 v87, v142, v143
    v_mul_f32 v76, v144, v63
    v_mul_f32 v77, v145, v63
    s_waitcnt lgkmcnt(3)
    v_mfma_f32_32x32x16_bf16 v[192:207], a[84:87], v[116:119], v[192:207]
    ds_read_b128 v[108:111], v40 offset:38912
    buffer_load_dwordx4 v13, s[72:75], s1 offen offset:3072  lds
    s_add_u32 m0, s57, 131072
    s_add_u32 s1, s61, 81920
    v_mul_f32 v78, v146, v63
    v_mul_f32 v79, v147, v63
    v_mfma_f32_32x32x16_bf16 v[192:207], a[88:91], v[120:123], v[192:207]
    ds_read_b128 v[112:115], v37 offset:39936
    buffer_load_dwordx4 v10, s[72:75], s1 offen offset:0  lds
    v_exp_f32 v76, v76
    v_exp_f32 v77, v77
    v_mfma_f32_32x32x16_bf16 v[192:207], a[92:95], v[124:127], v[192:207]
    ds_read_b128 v[116:119], v38 offset:39936
    v_exp_f32 v78, v78
    v_exp_f32 v79, v79
    v_mul_f32 v152, v144, v152
    v_mul_f32 v153, v145, v153
    s_waitcnt lgkmcnt(3)
    v_mfma_f32_32x32x16_bf16 v[192:207], a[96:99], v[96:99], v[192:207]
    ds_read_b128 v[120:123], v39 offset:39936
    buffer_load_dwordx4 v11, s[72:75], s1 offen offset:1024  lds
    v_mul_f32 v154, v146, v154
    v_mul_f32 v155, v147, v155
    v_add_f32 v76, 1.0, v76
    v_add_f32 v77, 1.0, v77
    v_mfma_f32_32x32x16_bf16 v[192:207], a[100:103], v[100:103], v[192:207]
    ds_read_b128 v[124:127], v40 offset:39936
    buffer_load_dwordx4 v12, s[72:75], s1 offen offset:2048  lds
    v_add_f32 v78, 1.0, v78
    v_add_f32 v79, 1.0, v79
    v_rcp_f32 v76, v76
    v_mfma_f32_32x32x16_bf16 v[192:207], a[104:107], v[104:107], v[192:207]
    s_waitcnt vmcnt(19)
    s_barrier
    ds_read_b128 v[96:99], v33 offset:0
    s_waitcnt lgkmcnt(3)
    v_mfma_f32_32x32x16_bf16 v[192:207], a[108:111], v[108:111], v[192:207]
    ds_read_b128 v[100:103], v34 offset:0
    buffer_load_dwordx4 v13, s[72:75], s1 offen offset:3072  lds
    s_add_u32 m0, s57, 135168
    s_add_u32 s1, s61, 122880
    v_rcp_f32 v77, v77
    v_mfma_f32_32x32x16_bf16 v[192:207], a[112:115], v[112:115], v[192:207]
    ds_read_b128 v[104:107], v35 offset:0
    v_rcp_f32 v78, v78
    v_rcp_f32 v79, v79
    v_mul_f32 v152, v152, v76
    v_mul_f32 v153, v153, v77
    v_mul_f32 v154, v154, v78
    v_mfma_f32_32x32x16_bf16 v[192:207], a[116:119], v[116:119], v[192:207]
    ds_read_b128 v[108:111], v36 offset:0
    buffer_load_dwordx4 v10, s[72:75], s1 offen offset:0  lds
    v_mul_f32 v155, v155, v79
    v_cvt_pk_bf16_f32 v88, v152, v153
    v_cvt_pk_bf16_f32 v89, v154, v155
    s_waitcnt lgkmcnt(3)
    v_mfma_f32_32x32x16_bf16 v[192:207], a[120:123], v[120:123], v[192:207]
    ds_read_b128 v[112:115], v33 offset:1024
    buffer_load_dwordx4 v11, s[72:75], s1 offen offset:1024  lds
    v_mul_f32 v80, v148, v63
    v_mul_f32 v81, v149, v63
    v_mul_f32 v82, v150, v63
    v_mul_f32 v83, v151, v63
    v_mfma_f32_32x32x16_bf16 v[192:207], a[124:127], v[124:127], v[192:207]
    ds_read_b128 v[116:119], v34 offset:1024
    v_exp_f32 v80, v80
    v_exp_f32 v81, v81
    v_exp_f32 v82, v82
    v_mfma_f32_32x32x16_bf16 v[192:207], a[128:131], v[96:99], v[192:207]
    ds_read_b128 v[120:123], v35 offset:1024
    buffer_load_dwordx4 v12, s[72:75], s1 offen offset:2048  lds
    v_exp_f32 v83, v83
    v_mul_f32 v156, v148, v156
    s_waitcnt lgkmcnt(3)
    v_mfma_f32_32x32x16_bf16 v[192:207], a[132:135], v[100:103], v[192:207]
    ds_read_b128 v[124:127], v36 offset:1024
    v_mul_f32 v157, v149, v157
    v_mul_f32 v158, v150, v158
    v_mul_f32 v159, v151, v159
    v_add_f32 v80, 1.0, v80
    v_add_f32 v81, 1.0, v81
    v_add_f32 v82, 1.0, v82
    v_add_f32 v83, 1.0, v83
    v_mfma_f32_32x32x16_bf16 v[192:207], a[136:139], v[104:107], v[192:207]
    s_waitcnt vmcnt(15)
    s_barrier
    ds_read_b128 v[96:99], v37 offset:0
    v_rcp_f32 v80, v80
    v_mfma_f32_32x32x16_bf16 v[192:207], a[140:143], v[108:111], v[192:207]
    ds_read_b128 v[100:103], v38 offset:0
    buffer_load_dwordx4 v13, s[72:75], s1 offen offset:3072  lds
    s_add_u32 m0, s57, 32768
    v_add_u32 v18, 40960, v18
    v_add_u32 v19, 40960, v19
    v_add_u32 v20, 40960, v20
    s_waitcnt lgkmcnt(3)
    v_mfma_f32_32x32x16_bf16 v[192:207], a[144:147], v[112:115], v[192:207]
    ds_read_b128 v[104:107], v39 offset:0
    s_waitcnt vmcnt(12)
    ds_read_b64_tr_b16 a[160:161], v14 offset:0
    ds_read_b64_tr_b16 a[162:163], v14 offset:1024
    v_add_u32 v21, 40960, v21
    v_mfma_f32_32x32x16_bf16 v[192:207], a[148:151], v[116:119], v[192:207]
    ds_read_b128 v[108:111], v40 offset:0
    buffer_load_dwordx4 v18, s[36:39], s62 offen offset:0  lds
    buffer_load_dwordx4 v19, s[36:39], s63 offen offset:1024  lds
    v_rcp_f32 v81, v81
    v_mfma_f32_32x32x16_bf16 v[192:207], a[152:155], v[120:123], v[192:207]
    ds_read_b128 v[112:115], v37 offset:1024
    buffer_load_dwordx4 v20, s[36:39], s64 offen offset:2048  lds
    ds_read_b64_tr_b16 a[164:165], v15 offset:0
    ds_read_b64_tr_b16 a[166:167], v15 offset:1024
    v_perm_b32 v50, v68, v68, s59
    s_waitcnt lgkmcnt(7)
    v_mfma_f32_32x32x16_bf16 v[192:207], a[156:159], v[124:127], v[192:207]
    ds_read_b128 v[116:119], v38 offset:1024
    ds_read_b64_tr_b16 a[168:169], v14 offset:2048
    ds_read_b64_tr_b16 a[170:171], v14 offset:3072
    buffer_load_dwordx4 v21, s[36:39], s65 offen offset:3072  lds
    s_add_u32 m0, s57, 36864
    v_mfma_f32_32x32x16_bf16 v[192:207], v[52:55], v[50:53], v[192:207]
    ds_read_b64_tr_b16 a[172:173], v15 offset:2048
    ds_read_b64_tr_b16 a[174:175], v15 offset:3072
    v_rcp_f32 v82, v82
    v_rcp_f32 v83, v83
    v_mul_f32 v156, v156, v80
    v_mfma_f32_32x32x16_bf16 v[208:223], a[0:3], v[96:99], 0
    ds_read_b128 v[120:123], v39 offset:1024
    buffer_load_dwordx4 v18, s[36:39], s66 offen offset:0  lds
    s_waitcnt vmcnt(13)
    ds_read_b64_tr_b16 a[176:177], v14 offset:4096
    ds_read_b64_tr_b16 a[178:179], v14 offset:5120
    v_mfma_f32_32x32x16_bf16 v[208:223], a[4:7], v[100:103], v[208:223]
    ds_read_b128 v[124:127], v40 offset:1024
    ds_read_b64_tr_b16 a[180:181], v15 offset:4096
    ds_read_b64_tr_b16 a[182:183], v15 offset:5120
    v_mul_f32 v157, v157, v81
    v_mul_f32 v158, v158, v82
    s_waitcnt lgkmcnt(13)
    v_mfma_f32_32x32x16_bf16 v[208:223], a[8:11], v[104:107], v[208:223]
    ds_read_b128 v[96:99], v37 offset:2048
    buffer_load_dwordx4 v19, s[36:39], s67 offen offset:1024  lds
    ds_read_b64_tr_b16 a[184:185], v14 offset:6144
    ds_read_b64_tr_b16 a[186:187], v14 offset:7168
    v_mul_f32 v159, v159, v83
    v_cvt_pk_bf16_f32 v90, v156, v157
    v_mfma_f32_32x32x16_bf16 v[208:223], a[12:15], v[108:111], v[208:223]
    ds_read_b128 v[100:103], v38 offset:2048
    buffer_load_dwordx4 v20, s[36:39], s68 offen offset:2048  lds
    ds_read_b64_tr_b16 a[188:189], v15 offset:6144
    ds_read_b64_tr_b16 a[190:191], v15 offset:7168
    v_cvt_pk_bf16_f32 v91, v158, v159
    v_mfma_f32_32x32x16_bf16 v[208:223], a[16:19], v[112:115], v[208:223]
    ds_read_b128 v[104:107], v39 offset:2048
    s_add_u32 s54, s58, 0
    buffer_store_dwordx4 v[84:87], v41, s[44:47], s54 offen sc1
    s_waitcnt lgkmcnt(9)
    v_mfma_f32_32x32x16_bf16 v[208:223], a[20:23], v[116:119], v[208:223]
    ds_read_b128 v[108:111], v40 offset:2048
    s_waitcnt vmcnt(12)
    ds_read_b64_tr_b16 a[192:193], v14 offset:32768
    ds_read_b64_tr_b16 a[194:195], v14 offset:33792
    v_mfma_f32_32x32x16_bf16 v[208:223], a[24:27], v[120:123], v[208:223]
    ds_read_b128 v[112:115], v37 offset:3072
    buffer_load_dwordx4 v21, s[36:39], s69 offen offset:3072  lds
    s_add_u32 m0, s57, 98304
    s_add_u32 s1, s61, 163840
    v_mfma_f32_32x32x16_bf16 v[208:223], a[28:31], v[124:127], v[208:223]
    ds_read_b128 v[116:119], v38 offset:3072
    ds_read_b64_tr_b16 a[196:197], v15 offset:32768
    ds_read_b64_tr_b16 a[198:199], v15 offset:33792
    s_waitcnt lgkmcnt(7)
    v_mfma_f32_32x32x16_bf16 v[208:223], a[32:35], v[96:99], v[208:223]
    ds_read_b128 v[120:123], v39 offset:3072
    buffer_load_dwordx4 v10, s[72:75], s1 offen offset:0  lds
    ds_read_b64_tr_b16 a[200:201], v14 offset:34816
    ds_read_b64_tr_b16 a[202:203], v14 offset:35840
    v_mfma_f32_32x32x16_bf16 v[208:223], a[36:39], v[100:103], v[208:223]
    ds_read_b128 v[124:127], v40 offset:3072
    ds_read_b64_tr_b16 a[204:205], v15 offset:34816
    ds_read_b64_tr_b16 a[206:207], v15 offset:35840
    v_mfma_f32_32x32x16_bf16 v[208:223], a[40:43], v[104:107], v[208:223]
    ds_read_b128 v[96:99], v37 offset:4096
    buffer_load_dwordx4 v11, s[72:75], s1 offen offset:1024  lds
    s_waitcnt lgkmcnt(9)
    v_mfma_f32_32x32x16_bf16 v[208:223], a[44:47], v[108:111], v[208:223]
    ds_read_b128 v[100:103], v38 offset:4096
    s_add_u32 s54, s58, 110592
    buffer_store_dwordx4 v[88:91], v41, s[44:47], s54 offen sc1
    v_mfma_f32_32x32x16_bf16 v[208:223], a[48:51], v[112:115], v[208:223]
    ds_read_b128 v[104:107], v39 offset:4096
    v_mul_f32 v76, v160, v65
    v_mul_f32 v77, v161, v65
    v_mul_f32 v78, v162, v65
    v_mul_f32 v79, v163, v65
    v_exp_f32 v76, v76
    v_mfma_f32_32x32x16_bf16 v[208:223], a[52:55], v[116:119], v[208:223]
    ds_read_b128 v[108:111], v40 offset:4096
    buffer_load_dwordx4 v12, s[72:75], s1 offen offset:2048  lds
    v_exp_f32 v77, v77
    s_waitcnt lgkmcnt(3)
    v_mfma_f32_32x32x16_bf16 v[208:223], a[56:59], v[120:123], v[208:223]
    ds_read_b128 v[112:115], v37 offset:5120
    s_waitcnt vmcnt(13)
    ds_read_b64_tr_b16 a[208:209], v14 offset:36864
    ds_read_b64_tr_b16 a[210:211], v14 offset:37888
PAD1:
    s_cbranch_execz WRETG
    v_exp_f32 v78, v78
    v_mfma_f32_32x32x16_bf16 v[208:223], a[60:63], v[124:127], v[208:223]
    ds_read_b128 v[116:119], v38 offset:5120
    buffer_load_dwordx4 v13, s[72:75], s1 offen offset:3072  lds
    s_add_u32 m0, s57, 102400
    s_add_u32 s1, s61, 204800
    v_exp_f32 v79, v79
    v_mfma_f32_32x32x16_bf16 v[208:223], a[64:67], v[96:99], v[208:223]
    ds_read_b128 v[120:123], v39 offset:5120
    ds_read_b64_tr_b16 a[212:213], v15 offset:36864
    ds_read_b64_tr_b16 a[214:215], v15 offset:37888
    v_mul_f32 v168, v160, v168
    v_mul_f32 v169, v161, v169
    s_waitcnt lgkmcnt(7)
    v_mfma_f32_32x32x16_bf16 v[208:223], a[68:71], v[100:103], v[208:223]
    ds_read_b128 v[124:127], v40 offset:5120
    buffer_load_dwordx4 v10, s[72:75], s1 offen offset:0  lds
    ds_read_b64_tr_b16 a[216:217], v14 offset:38912
    ds_read_b64_tr_b16 a[218:219], v14 offset:39936
    v_mul_f32 v170, v162, v170
    v_mul_f32 v171, v163, v171
    v_mfma_f32_32x32x16_bf16 v[208:223], a[72:75], v[104:107], v[208:223]
    ds_read_b128 v[96:99], v37 offset:6144
    buffer_load_dwordx4 v11, s[72:75], s1 offen offset:1024  lds
    ds_read_b64_tr_b16 a[220:221], v15 offset:38912
    ds_read_b64_tr_b16 a[222:223], v15 offset:39936
    v_add_f32 v76, 1.0, v76
    v_mfma_f32_32x32x16_bf16 v[208:223], a[76:79], v[108:111], v[208:223]
    ds_read_b128 v[100:103], v38 offset:6144
    v_add_f32 v77, 1.0, v77
    v_add_f32 v78, 1.0, v78
    v_add_f32 v79, 1.0, v79
    v_rcp_f32 v76, v76
    s_waitcnt lgkmcnt(9)
    v_mfma_f32_32x32x16_bf16 v[208:223], a[80:83], v[112:115], v[208:223]
    ds_read_b128 v[104:107], v39 offset:6144
    buffer_load_dwordx4 v12, s[72:75], s1 offen offset:2048  lds
    v_rcp_f32 v77, v77
    v_rcp_f32 v78, v78
    v_mfma_f32_32x32x16_bf16 v[208:223], a[84:87], v[116:119], v[208:223]
    ds_read_b128 v[108:111], v40 offset:6144
    buffer_load_dwordx4 v13, s[72:75], s1 offen offset:3072  lds
    s_add_u32 m0, s57, 131072
    s_add_u32 s1, s61, 245760
    v_rcp_f32 v79, v79
    v_mfma_f32_32x32x16_bf16 v[208:223], a[88:91], v[120:123], v[208:223]
    ds_read_b128 v[112:115], v37 offset:7168
    v_mul_f32 v168, v168, v76
    v_mul_f32 v169, v169, v77
    v_mul_f32 v170, v170, v78
    v_mul_f32 v171, v171, v79
    v_cvt_pk_bf16_f32 v84, v168, v169
    v_cvt_pk_bf16_f32 v85, v170, v171
    s_waitcnt lgkmcnt(3)
    v_mfma_f32_32x32x16_bf16 v[208:223], a[92:95], v[124:127], v[208:223]
    ds_read_b128 v[116:119], v38 offset:7168
    buffer_load_dwordx4 v10, s[72:75], s1 offen offset:0  lds
    v_mul_f32 v80, v164, v65
    v_mul_f32 v81, v165, v65
    v_mul_f32 v82, v166, v65
    v_mul_f32 v83, v167, v65
    v_mfma_f32_32x32x16_bf16 v[208:223], a[96:99], v[96:99], v[208:223]
    ds_read_b128 v[120:123], v39 offset:7168
    v_exp_f32 v80, v80
    v_exp_f32 v81, v81
    v_exp_f32 v82, v82
    v_mfma_f32_32x32x16_bf16 v[208:223], a[100:103], v[100:103], v[208:223]
    ds_read_b128 v[124:127], v40 offset:7168
    buffer_load_dwordx4 v11, s[72:75], s1 offen offset:1024  lds
    v_exp_f32 v83, v83
    v_mul_f32 v172, v164, v172
    s_waitcnt lgkmcnt(3)
    v_mfma_f32_32x32x16_bf16 v[208:223], a[104:107], v[104:107], v[208:223]
    ds_read_b128 v[96:99], v33 offset:2048
    buffer_load_dwordx4 v12, s[72:75], s1 offen offset:2048  lds
    v_mul_f32 v173, v165, v173
    v_mul_f32 v174, v166, v174
    v_mul_f32 v175, v167, v175
    v_add_f32 v80, 1.0, v80
    v_mfma_f32_32x32x16_bf16 v[208:223], a[108:111], v[108:111], v[208:223]
    ds_read_b128 v[100:103], v34 offset:2048
    v_add_f32 v81, 1.0, v81
    v_add_f32 v82, 1.0, v82
    v_add_f32 v83, 1.0, v83
    v_rcp_f32 v80, v80
    v_rcp_f32 v81, v81
    v_mfma_f32_32x32x16_bf16 v[208:223], a[112:115], v[112:115], v[208:223]
    ds_read_b128 v[104:107], v35 offset:2048
    buffer_load_dwordx4 v13, s[72:75], s1 offen offset:3072  lds
    s_add_u32 m0, s57, 0
    v_rcp_f32 v82, v82
    s_waitcnt lgkmcnt(3)
    v_mfma_f32_32x32x16_bf16 v[208:223], a[116:119], v[116:119], v[208:223]
    ds_read_b128 v[108:111], v36 offset:2048
    v_add_u32 v18, 40960, v18
    v_add_u32 v19, 40960, v19
    v_add_u32 v20, 40960, v20
    v_add_u32 v21, 40960, v21
    v_rcp_f32 v83, v83
    v_mul_f32 v172, v172, v80
    v_mfma_f32_32x32x16_bf16 v[208:223], a[120:123], v[120:123], v[208:223]
    ds_read_b128 v[112:115], v33 offset:3072
    v_mul_f32 v173, v173, v81
    v_mul_f32 v174, v174, v82
    v_mul_f32 v175, v175, v83
    v_cvt_pk_bf16_f32 v86, v172, v173
    v_cvt_pk_bf16_f32 v87, v174, v175
    v_mul_f32 v76, v176, v67
    v_mfma_f32_32x32x16_bf16 v[208:223], a[124:127], v[124:127], v[208:223]
    ds_read_b128 v[116:119], v34 offset:3072
    v_mul_f32 v77, v177, v67
    v_mul_f32 v78, v178, v67
    v_mul_f32 v79, v179, v67
    v_exp_f32 v76, v76
    s_waitcnt lgkmcnt(3)
    v_mfma_f32_32x32x16_bf16 v[208:223], a[128:131], v[96:99], v[208:223]
    ds_read_b128 v[120:123], v35 offset:3072
    v_exp_f32 v77, v77
    v_exp_f32 v78, v78
    v_exp_f32 v79, v79
    v_mul_f32 v184, v176, v184
    v_mfma_f32_32x32x16_bf16 v[208:223], a[132:135], v[100:103], v[208:223]
    ds_read_b128 v[124:127], v36 offset:3072
    v_mul_f32 v185, v177, v185
    v_mul_f32 v186, v178, v186
    v_mul_f32 v187, v179, v187
    v_add_f32 v76, 1.0, v76
    v_add_f32 v77, 1.0, v77
    v_add_f32 v78, 1.0, v78
    v_mfma_f32_32x32x16_bf16 v[208:223], a[136:139], v[104:107], v[208:223]
    s_waitcnt vmcnt(13)
    s_barrier
    ds_read_b128 v[96:99], v37 offset:32768
    v_add_f32 v79, 1.0, v79
    s_waitcnt lgkmcnt(3)
    v_mfma_f32_32x32x16_bf16 v[208:223], a[140:143], v[108:111], v[208:223]
    ds_read_b128 v[100:103], v38 offset:32768
    buffer_load_dwordx4 v18, s[36:39], s62 offen offset:0  lds
    buffer_load_dwordx4 v19, s[36:39], s63 offen offset:1024  lds
    buffer_load_dwordx4 v20, s[36:39], s64 offen offset:2048  lds
    v_mfma_f32_32x32x16_bf16 v[208:223], a[144:147], v[112:115], v[208:223]
    ds_read_b128 v[104:107], v39 offset:32768
    s_waitcnt vmcnt(13)
    buffer_store_dword v8, v9, s[44:47], s78 offen offset:0 sc1
    s_add_u32 s78, s78, 8192
    v_mfma_f32_32x32x16_bf16 v[208:223], a[148:151], v[116:119], v[208:223]
    ds_read_b128 v[108:111], v40 offset:32768
    buffer_load_dwordx4 v21, s[36:39], s65 offen offset:3072  lds
    s_add_u32 m0, s57, 4096
    v_rcp_f32 v76, v76
    s_waitcnt lgkmcnt(3)
    v_mfma_f32_32x32x16_bf16 v[208:223], a[152:155], v[120:123], v[208:223]
    ds_read_b128 v[112:115], v37 offset:33792
    s_waitcnt vmcnt(13)
    ds_read_b64_tr_b16 a[224:225], v14 offset:0
    ds_read_b64_tr_b16 a[226:227], v14 offset:1024
    v_perm_b32 v50, v70, v70, s59
    v_mfma_f32_32x32x16_bf16 v[208:223], a[156:159], v[124:127], v[208:223]
    ds_read_b128 v[116:119], v38 offset:33792
    buffer_load_dwordx4 v18, s[36:39], s66 offen offset:0  lds
    ds_read_b64_tr_b16 a[228:229], v15 offset:0
    ds_read_b64_tr_b16 a[230:231], v15 offset:1024
    v_rcp_f32 v77, v77
    v_mfma_f32_32x32x16_bf16 v[208:223], v[52:55], v[50:53], v[208:223]
    ds_read_b64_tr_b16 a[232:233], v14 offset:2048
    ds_read_b64_tr_b16 a[234:235], v14 offset:3072
    buffer_load_dwordx4 v19, s[36:39], s67 offen offset:1024  lds
    v_rcp_f32 v78, v78
    v_mfma_f32_32x32x16_bf16 v[128:143], a[0:3], v[96:99], 0
    ds_read_b128 v[120:123], v39 offset:33792
    ds_read_b64_tr_b16 a[236:237], v15 offset:2048
    ds_read_b64_tr_b16 a[238:239], v15 offset:3072
    v_rcp_f32 v79, v79
    s_waitcnt lgkmcnt(11)
    v_mfma_f32_32x32x16_bf16 v[128:143], a[4:7], v[100:103], v[128:143]
    ds_read_b128 v[124:127], v40 offset:33792
    buffer_load_dwordx4 v20, s[36:39], s68 offen offset:2048  lds
    s_waitcnt vmcnt(12)
    ds_read_b64_tr_b16 a[240:241], v14 offset:4096
    ds_read_b64_tr_b16 a[242:243], v14 offset:5120
    v_mul_f32 v184, v184, v76
    v_mfma_f32_32x32x16_bf16 v[128:143], a[8:11], v[104:107], v[128:143]
    ds_read_b128 v[96:99], v37 offset:34816
    ds_read_b64_tr_b16 a[244:245], v15 offset:4096
    ds_read_b64_tr_b16 a[246:247], v15 offset:5120
    v_mul_f32 v185, v185, v77
    v_mul_f32 v186, v186, v78
    v_mul_f32 v187, v187, v79
    v_mfma_f32_32x32x16_bf16 v[128:143], a[12:15], v[108:111], v[128:143]
    ds_read_b128 v[100:103], v38 offset:34816
    buffer_load_dwordx4 v21, s[36:39], s69 offen offset:3072  lds
    s_add_u32 m0, s57, 135168
    s_add_u32 s1, s79, 286720
    v_cvt_pk_bf16_f32 v88, v184, v185
    v_cvt_pk_bf16_f32 v89, v186, v187
    s_waitcnt lgkmcnt(9)
    v_mfma_f32_32x32x16_bf16 v[128:143], a[16:19], v[112:115], v[128:143]
    ds_read_b128 v[104:107], v39 offset:34816
    buffer_load_dwordx4 v10, s[72:75], s1 offen offset:0  lds
    ds_read_b64_tr_b16 a[248:249], v14 offset:6144
    ds_read_b64_tr_b16 a[250:251], v14 offset:7168
    v_mul_f32 v80, v180, v67
    v_mfma_f32_32x32x16_bf16 v[128:143], a[20:23], v[116:119], v[128:143]
    ds_read_b128 v[108:111], v40 offset:34816
    ds_read_b64_tr_b16 a[252:253], v15 offset:6144
    ds_read_b64_tr_b16 a[254:255], v15 offset:7168
    v_mul_f32 v81, v181, v67
    v_mul_f32 v82, v182, v67
    v_mul_f32 v83, v183, v67
    v_mfma_f32_32x32x16_bf16 v[128:143], a[24:27], v[120:123], v[128:143]
    ds_read_b128 v[112:115], v37 offset:35840
    buffer_load_dwordx4 v11, s[72:75], s1 offen offset:1024  lds
    v_exp_f32 v80, v80
    v_exp_f32 v81, v81
    s_waitcnt lgkmcnt(7)
    v_mfma_f32_32x32x16_bf16 v[128:143], a[28:31], v[124:127], v[128:143]
    ds_read_b128 v[116:119], v38 offset:35840
    buffer_load_dwordx4 v12, s[72:75], s1 offen offset:2048  lds
    s_waitcnt vmcnt(12)
    ds_read_b64_tr_b16 v[224:225], v14 offset:32768
    ds_read_b64_tr_b16 v[226:227], v14 offset:33792
    v_mfma_f32_32x32x16_bf16 v[128:143], a[32:35], v[96:99], v[128:143]
    ds_read_b128 v[120:123], v39 offset:35840
    ds_read_b64_tr_b16 v[228:229], v15 offset:32768
    ds_read_b64_tr_b16 v[230:231], v15 offset:33792
    v_exp_f32 v82, v82
    v_exp_f32 v83, v83
    v_mfma_f32_32x32x16_bf16 v[128:143], a[36:39], v[100:103], v[128:143]
    ds_read_b128 v[124:127], v40 offset:35840
    buffer_load_dwordx4 v13, s[72:75], s1 offen offset:3072  lds
    s_add_u32 m0, s57, 98304
    s_add_u32 s1, s79, 327680
    v_mul_f32 v188, v180, v188
    s_waitcnt lgkmcnt(7)
    v_mfma_f32_32x32x16_bf16 v[128:143], a[40:43], v[104:107], v[128:143]
    ds_read_b128 v[96:99], v37 offset:36864
    buffer_load_dwordx4 v10, s[72:75], s1 offen offset:0  lds
    ds_read_b64_tr_b16 v[232:233], v14 offset:34816
    ds_read_b64_tr_b16 v[234:235], v14 offset:35840
    v_mul_f32 v189, v181, v189
    v_mfma_f32_32x32x16_bf16 v[128:143], a[44:47], v[108:111], v[128:143]
    ds_read_b128 v[100:103], v38 offset:36864
    ds_read_b64_tr_b16 v[236:237], v15 offset:34816
    ds_read_b64_tr_b16 v[238:239], v15 offset:35840
    v_mul_f32 v190, v182, v190
    v_mul_f32 v191, v183, v191
    v_add_f32 v80, 1.0, v80
    v_add_f32 v81, 1.0, v81
    v_mfma_f32_32x32x16_bf16 v[128:143], a[48:51], v[112:115], v[128:143]
    ds_read_b128 v[104:107], v39 offset:36864
    buffer_load_dwordx4 v11, s[72:75], s1 offen offset:1024  lds
    v_add_f32 v82, 1.0, v82
    v_add_f32 v83, 1.0, v83
    v_add_u32 v19, s6, v24
    s_waitcnt lgkmcnt(7)
    v_mfma_f32_32x32x16_bf16 v[128:143], a[52:55], v[116:119], v[128:143]
    ds_read_b128 v[108:111], v40 offset:36864
    v_rcp_f32 v80, v80
    v_rcp_f32 v81, v81
    v_rcp_f32 v82, v82
    v_add_u32 v20, s7, v24
    v_mfma_f32_32x32x16_bf16 v[128:143], a[56:59], v[120:123], v[128:143]
    ds_read_b128 v[112:115], v37 offset:37888
    buffer_load_dwordx4 v12, s[72:75], s1 offen offset:2048  lds
    v_rcp_f32 v83, v83
    v_mul_f32 v188, v188, v80
    v_mul_f32 v189, v189, v81
    v_mfma_f32_32x32x16_bf16 v[128:143], a[60:63], v[124:127], v[128:143]
    ds_read_b128 v[116:119], v38 offset:37888
    buffer_load_dwordx4 v13, s[72:75], s1 offen offset:3072  lds
    s_add_u32 m0, s57, 102400
    s_add_u32 s1, s79, 368640
    v_mul_f32 v190, v190, v82
    s_waitcnt lgkmcnt(3)
    v_mfma_f32_32x32x16_bf16 v[128:143], a[64:67], v[96:99], v[128:143]
    ds_read_b128 v[120:123], v39 offset:37888
    v_mul_f32 v191, v191, v83
    v_cvt_pk_bf16_f32 v90, v188, v189
    v_cvt_pk_bf16_f32 v91, v190, v191
    v_add_u32 v21, s8, v24
    v_add_u32 v22, s9, v24
    s_mov_b32 s69, 81920
    s_mov_b32 s70, 163840
    v_mfma_f32_32x32x16_bf16 v[128:143], a[68:71], v[100:103], v[128:143]
    ds_read_b128 v[124:127], v40 offset:37888
    buffer_load_dwordx4 v10, s[72:75], s1 offen offset:0  lds
    s_mov_b32 s71, 245760
    v_add_u32 v30, s10, v24
    v_mfma_f32_32x32x16_bf16 v[128:143], a[72:75], v[104:107], v[128:143]
    ds_read_b128 v[96:99], v37 offset:38912
    buffer_load_dwordx4 v11, s[72:75], s1 offen offset:1024  lds
    s_waitcnt lgkmcnt(3)
    v_mfma_f32_32x32x16_bf16 v[128:143], a[76:79], v[108:111], v[128:143]
    ds_read_b128 v[100:103], v38 offset:38912
    s_add_u32 s54, s58, 221184
    buffer_store_dwordx4 v[84:87], v41, s[44:47], s54 offen sc1
    v_mfma_f32_32x32x16_bf16 v[128:143], a[80:83], v[112:115], v[128:143]
    ds_read_b128 v[104:107], v39 offset:38912
    s_add_u32 s54, s58, 331776
    buffer_store_dwordx4 v[88:91], v41, s[44:47], s54 offen sc1
    v_mfma_f32_32x32x16_bf16 v[128:143], a[84:87], v[116:119], v[128:143]
    ds_read_b128 v[108:111], v40 offset:38912
    v_mul_f32 v76, v192, v69
    v_mul_f32 v77, v193, v69
    v_mul_f32 v78, v194, v69
    v_mul_f32 v79, v195, v69
    v_exp_f32 v76, v76
    s_waitcnt lgkmcnt(3)
    v_mfma_f32_32x32x16_bf16 v[128:143], a[88:91], v[120:123], v[128:143]
    ds_read_b128 v[112:115], v37 offset:39936
    v_exp_f32 v77, v77
    v_exp_f32 v78, v78
    v_exp_f32 v79, v79
    v_mfma_f32_32x32x16_bf16 v[128:143], a[92:95], v[124:127], v[128:143]
    ds_read_b128 v[116:119], v38 offset:39936
    buffer_load_dwordx4 v12, s[72:75], s1 offen offset:2048  lds
    v_mul_f32 v200, v192, v200
    v_mul_f32 v201, v193, v201
    v_mul_f32 v202, v194, v202
    v_mul_f32 v203, v195, v203
    v_add_f32 v76, 1.0, v76
    v_mfma_f32_32x32x16_bf16 v[128:143], a[96:99], v[96:99], v[128:143]
    ds_read_b128 v[120:123], v39 offset:39936
    buffer_load_dwordx4 v13, s[72:75], s1 offen offset:3072  lds
    s_add_u32 m0, s57, 131072
    s_add_u32 s1, s79, 409600
    v_add_f32 v77, 1.0, v77
    s_waitcnt lgkmcnt(3)
    v_mfma_f32_32x32x16_bf16 v[128:143], a[100:103], v[100:103], v[128:143]
    ds_read_b128 v[124:127], v40 offset:39936
    v_add_f32 v78, 1.0, v78
    v_add_f32 v79, 1.0, v79
    v_rcp_f32 v76, v76
    v_rcp_f32 v77, v77
    v_mfma_f32_32x32x16_bf16 v[128:143], a[104:107], v[104:107], v[128:143]
    ds_read_b128 v[96:99], v33 offset:4096
    buffer_load_dwordx4 v10, s[72:75], s1 offen offset:0  lds
    v_rcp_f32 v78, v78
    v_rcp_f32 v79, v79
    v_mul_f32 v200, v200, v76
    v_mfma_f32_32x32x16_bf16 v[128:143], a[108:111], v[108:111], v[128:143]
    ds_read_b128 v[100:103], v34 offset:4096
    v_mul_f32 v201, v201, v77
    v_mul_f32 v202, v202, v78
    v_mul_f32 v203, v203, v79
    v_cvt_pk_bf16_f32 v84, v200, v201
    v_cvt_pk_bf16_f32 v85, v202, v203
    s_waitcnt lgkmcnt(3)
    v_mfma_f32_32x32x16_bf16 v[128:143], a[112:115], v[112:115], v[128:143]
    ds_read_b128 v[104:107], v35 offset:4096
    buffer_load_dwordx4 v11, s[72:75], s1 offen offset:1024  lds
    s_waitcnt vmcnt(12)
    ds_read_b64_tr_b16 v[240:241], v14 offset:36864
    ds_read_b64_tr_b16 v[242:243], v14 offset:37888
    v_mul_f32 v80, v196, v69
    v_mfma_f32_32x32x16_bf16 v[128:143], a[116:119], v[116:119], v[128:143]
    ds_read_b128 v[108:111], v36 offset:4096
    buffer_load_dwordx4 v12, s[72:75], s1 offen offset:2048  lds
    ds_read_b64_tr_b16 v[244:245], v15 offset:36864
    ds_read_b64_tr_b16 v[246:247], v15 offset:37888
    v_mul_f32 v81, v197, v69
    v_mfma_f32_32x32x16_bf16 v[128:143], a[120:123], v[120:123], v[128:143]
    ds_read_b128 v[112:115], v33 offset:5120
    ds_read_b64_tr_b16 v[248:249], v14 offset:38912
    ds_read_b64_tr_b16 v[250:251], v14 offset:39936
    v_mul_f32 v82, v198, v69
    v_mul_f32 v83, v199, v69
    s_waitcnt lgkmcnt(9)
    v_mfma_f32_32x32x16_bf16 v[128:143], a[124:127], v[124:127], v[128:143]
    ds_read_b128 v[116:119], v34 offset:5120
    buffer_load_dwordx4 v13, s[72:75], s1 offen offset:3072  lds
    s_add_u32 m0, s57, 135168
    s_add_u32 s1, s79, 450560
    s_movk_i32 s64, 0
    buffer_load_dword v94, v95, s[44:47], s64 offen sc1
    v_mfma_f32_32x32x16_bf16 v[128:143], a[128:131], v[96:99], v[128:143]
    ds_read_b128 v[120:123], v35 offset:5120
    ds_read_b64_tr_b16 v[252:253], v15 offset:38912
    ds_read_b64_tr_b16 v[254:255], v15 offset:39936
    v_exp_f32 v80, v80
    v_mfma_f32_32x32x16_bf16 v[128:143], a[132:135], v[100:103], v[128:143]
    ds_read_b128 v[124:127], v36 offset:5120
    v_exp_f32 v81, v81
    v_exp_f32 v82, v82
    v_exp_f32 v83, v83
    s_waitcnt lgkmcnt(7)
    v_mfma_f32_32x32x16_bf16 v[128:143], a[136:139], v[104:107], v[128:143]
    s_barrier
    ds_read_b128 v[96:99], v37 offset:0
    v_mul_f32 v204, v196, v204
    v_mul_f32 v205, v197, v205
    v_mul_f32 v206, v198, v206
    v_mfma_f32_32x32x16_bf16 v[128:143], a[140:143], v[108:111], v[128:143]
    ds_read_b128 v[100:103], v38 offset:0
    s_waitcnt vmcnt(11)
    ds_read_b64_tr_b16 v[160:161], v14 offset:0
    ds_read_b64_tr_b16 v[162:163], v14 offset:1024
    v_mul_f32 v207, v199, v207
    v_add_f32 v80, 1.0, v80
    v_mfma_f32_32x32x16_bf16 v[128:143], a[144:147], v[112:115], v[128:143]
    ds_read_b128 v[104:107], v39 offset:0
    s_waitcnt lgkmcnt(6)
    buffer_load_dwordx4 v10, s[72:75], s1 offen offset:0  lds
    buffer_load_dwordx4 v11, s[72:75], s1 offen offset:1024  lds
    v_add_f32 v81, 1.0, v81
    s_waitcnt lgkmcnt(5)
    v_mfma_f32_32x32x16_bf16 v[128:143], a[148:151], v[116:119], v[128:143]
    ds_read_b128 v[108:111], v40 offset:0
    buffer_load_dwordx4 v12, s[72:75], s1 offen offset:2048  lds
    ds_read_b64_tr_b16 v[164:165], v15 offset:0
    ds_read_b64_tr_b16 v[166:167], v15 offset:1024
    v_add_f32 v82, 1.0, v82
    v_mfma_f32_32x32x16_bf16 v[128:143], a[152:155], v[120:123], v[128:143]
    ds_read_b128 v[112:115], v37 offset:1024
    buffer_load_dwordx4 v13, s[72:75], s1 offen offset:3072  lds
    s_add_u32 m0, s57, 98304
    s_add_u32 s1, s79, 491520
    ds_read_b64_tr_b16 v[168:169], v14 offset:2048
    ds_read_b64_tr_b16 v[170:171], v14 offset:3072
    v_perm_b32 v50, v72, v72, s59
    v_mfma_f32_32x32x16_bf16 v[128:143], a[156:159], v[124:127], v[128:143]
    ds_read_b128 v[116:119], v38 offset:1024
    ds_read_b64_tr_b16 v[172:173], v15 offset:2048
    ds_read_b64_tr_b16 v[174:175], v15 offset:3072
    v_add_f32 v83, 1.0, v83
    v_rcp_f32 v80, v80
    v_mfma_f32_32x32x16_bf16 v[128:143], v[52:55], v[50:53], v[128:143]
    v_rcp_f32 v81, v81
    v_rcp_f32 v82, v82
    v_rcp_f32 v83, v83
    s_waitcnt lgkmcnt(9)
    v_mfma_f32_32x32x16_bf16 v[144:159], a[0:3], v[96:99], 0
    ds_read_b128 v[120:123], v39 offset:1024
    v_mul_f32 v204, v204, v80
    v_mul_f32 v205, v205, v81
    v_mul_f32 v206, v206, v82
    v_mul_f32 v207, v207, v83
    v_cvt_pk_bf16_f32 v86, v204, v205
    v_cvt_pk_bf16_f32 v87, v206, v207
    v_mul_f32 v76, v208, v71
    v_mfma_f32_32x32x16_bf16 v[144:159], a[4:7], v[100:103], v[144:159]
    ds_read_b128 v[124:127], v40 offset:1024
    s_waitcnt lgkmcnt(2)
    buffer_load_dwordx4 v10, s[72:75], s1 offen offset:0  lds
    buffer_load_dwordx4 v11, s[72:75], s1 offen offset:1024  lds
    v_mul_f32 v77, v209, v71
    v_mfma_f32_32x32x16_bf16 v[144:159], a[8:11], v[104:107], v[144:159]
    ds_read_b128 v[96:99], v37 offset:2048
    buffer_load_dwordx4 v12, s[72:75], s1 offen offset:2048  lds
    s_waitcnt vmcnt(14)
    buffer_store_dword v8, v9, s[44:47], s78 offen offset:0 sc1
    s_add_u32 s78, s78, 8192
    v_mfma_f32_32x32x16_bf16 v[144:159], a[12:15], v[108:111], v[144:159]
    ds_read_b128 v[100:103], v38 offset:2048
    buffer_load_dwordx4 v13, s[72:75], s1 offen offset:3072  lds
    s_add_u32 m0, s57, 102400
    s_add_u32 s1, s79, 532480
    v_mul_f32 v78, v210, v71
    v_mul_f32 v79, v211, v71
    v_mfma_f32_32x32x16_bf16 v[144:159], a[16:19], v[112:115], v[144:159]
    ds_read_b128 v[104:107], v39 offset:2048
    s_waitcnt vmcnt(14)
    ds_read_b64_tr_b16 v[176:177], v14 offset:4096
    ds_read_b64_tr_b16 v[178:179], v14 offset:5120
    v_exp_f32 v76, v76
    v_mfma_f32_32x32x16_bf16 v[144:159], a[20:23], v[116:119], v[144:159]
    ds_read_b128 v[108:111], v40 offset:2048
    ds_read_b64_tr_b16 v[180:181], v15 offset:4096
    ds_read_b64_tr_b16 v[182:183], v15 offset:5120
    v_exp_f32 v77, v77
    s_waitcnt lgkmcnt(7)
    v_mfma_f32_32x32x16_bf16 v[144:159], a[24:27], v[120:123], v[144:159]
    ds_read_b128 v[112:115], v37 offset:3072
    ds_read_b64_tr_b16 v[184:185], v14 offset:6144
    ds_read_b64_tr_b16 v[186:187], v14 offset:7168
    v_exp_f32 v78, v78
    v_mfma_f32_32x32x16_bf16 v[144:159], a[28:31], v[124:127], v[144:159]
    ds_read_b128 v[116:119], v38 offset:3072
    ds_read_b64_tr_b16 v[188:189], v15 offset:6144
    ds_read_b64_tr_b16 v[190:191], v15 offset:7168
    v_exp_f32 v79, v79
    v_mul_f32 v216, v208, v216
    v_mul_f32 v217, v209, v217
    v_mfma_f32_32x32x16_bf16 v[144:159], a[32:35], v[96:99], v[144:159]
    ds_read_b128 v[120:123], v39 offset:3072
    v_mul_f32 v218, v210, v218
    v_mul_f32 v219, v211, v219
    v_add_f32 v76, 1.0, v76
    v_add_f32 v77, 1.0, v77
    v_add_f32 v78, 1.0, v78
    s_waitcnt lgkmcnt(9)
    v_mfma_f32_32x32x16_bf16 v[144:159], a[36:39], v[100:103], v[144:159]
    ds_read_b128 v[124:127], v40 offset:3072
    s_waitcnt vmcnt(10)
    ds_read_b64_tr_b16 a[0:1], v14 offset:32768
    ds_read_b64_tr_b16 a[2:3], v14 offset:33792
    v_add_f32 v79, 1.0, v79
    v_mfma_f32_32x32x16_bf16 v[144:159], a[40:43], v[104:107], v[144:159]
    ds_read_b128 v[96:99], v37 offset:4096
    ds_read_b64_tr_b16 a[4:5], v15 offset:32768
    ds_read_b64_tr_b16 a[6:7], v15 offset:33792
    s_waitcnt lgkmcnt(7)
    buffer_load_dwordx4 v10, s[72:75], s1 offen offset:0  lds
    v_mfma_f32_32x32x16_bf16 v[144:159], a[44:47], v[108:111], v[144:159]
    ds_read_b128 v[100:103], v38 offset:4096
    buffer_load_dwordx4 v11, s[72:75], s1 offen offset:1024  lds
    ds_read_b64_tr_b16 a[8:9], v14 offset:34816
    ds_read_b64_tr_b16 a[10:11], v14 offset:35840
    s_waitcnt lgkmcnt(9)
    v_mfma_f32_32x32x16_bf16 v[144:159], a[48:51], v[112:115], v[144:159]
    ds_read_b128 v[104:107], v39 offset:4096
    ds_read_b64_tr_b16 a[12:13], v15 offset:34816
    ds_read_b64_tr_b16 a[14:15], v15 offset:35840
    s_waitcnt vmcnt(11)
    v_cmp_ne_u32 vcc, s3, v94
    s_nop 0
    s_cbranch_vccnz SLOW2
BACK2:
    v_mfma_f32_32x32x16_bf16 v[144:159], a[52:55], v[116:119], v[144:159]
    ds_read_b128 v[108:111], v40 offset:4096
    v_rcp_f32 v76, v76
    v_rcp_f32 v77, v77
    v_rcp_f32 v78, v78
    v_mfma_f32_32x32x16_bf16 v[144:159], a[56:59], v[120:123], v[144:159]
    ds_read_b128 v[112:115], v37 offset:5120
    v_rcp_f32 v79, v79
    v_mul_f32 v216, v216, v76
    v_mul_f32 v217, v217, v77
    v_mul_f32 v218, v218, v78
    s_waitcnt lgkmcnt(7)
    v_mfma_f32_32x32x16_bf16 v[144:159], a[60:63], v[124:127], v[144:159]
    ds_read_b128 v[116:119], v38 offset:5120
    global_load_dwordx4 a[56:59], v43, s[16:17] offset:-4096 sc1
    v_mul_f32 v219, v219, v79
    v_cvt_pk_bf16_f32 v88, v216, v217
    v_cvt_pk_bf16_f32 v89, v218, v219
    v_mul_f32 v80, v212, v71
    v_mul_f32 v81, v213, v71
    v_mul_f32 v82, v214, v71
    v_mfma_f32_32x32x16_bf16 v[144:159], a[64:67], v[96:99], v[144:159]
    ds_read_b128 v[120:123], v39 offset:5120
    global_load_dwordx4 a[60:63], v43, s[16:17] offset:-3072 sc1
    s_waitcnt vmcnt(9)
    ds_read_b64_tr_b16 a[16:17], v14 offset:36864
    ds_read_b64_tr_b16 a[18:19], v14 offset:37888
    v_mul_f32 v83, v215, v71
    v_mfma_f32_32x32x16_bf16 v[144:159], a[68:71], v[100:103], v[144:159]
    ds_read_b128 v[124:127], v40 offset:5120
    global_load_dwordx4 a[64:67], v43, s[16:17] offset:-2048 sc1
    ds_read_b64_tr_b16 a[20:21], v15 offset:36864
    ds_read_b64_tr_b16 a[22:23], v15 offset:37888
    v_exp_f32 v80, v80
    s_waitcnt lgkmcnt(7)
    v_mfma_f32_32x32x16_bf16 v[144:159], a[72:75], v[104:107], v[144:159]
    ds_read_b128 v[96:99], v37 offset:6144
    global_load_dwordx4 a[68:71], v43, s[16:17] offset:-1024 sc1
    ds_read_b64_tr_b16 a[24:25], v14 offset:38912
    ds_read_b64_tr_b16 a[26:27], v14 offset:39936
    v_exp_f32 v81, v81
    v_mfma_f32_32x32x16_bf16 v[144:159], a[76:79], v[108:111], v[144:159]
    ds_read_b128 v[100:103], v38 offset:6144
    global_load_dwordx4 a[72:75], v43, s[16:17] offset:0 sc1
    ds_read_b64_tr_b16 a[28:29], v15 offset:38912
    ds_read_b64_tr_b16 a[30:31], v15 offset:39936
    v_exp_f32 v82, v82
    v_mfma_f32_32x32x16_bf16 v[144:159], a[80:83], v[112:115], v[144:159]
    ds_read_b128 v[104:107], v39 offset:6144
    global_load_dwordx4 a[76:79], v43, s[16:17] offset:1024 sc1
    v_exp_f32 v83, v83
    v_mul_f32 v220, v212, v220
    v_mul_f32 v221, v213, v221
    v_mul_f32 v222, v214, v222
    s_waitcnt lgkmcnt(9)
    v_mfma_f32_32x32x16_bf16 v[144:159], a[84:87], v[116:119], v[144:159]
    ds_read_b128 v[108:111], v40 offset:6144
    v_mul_f32 v223, v215, v223
    v_add_f32 v80, 1.0, v80
    v_add_f32 v81, 1.0, v81
    v_add_f32 v82, 1.0, v82
    v_add_f32 v83, 1.0, v83
    v_mfma_f32_32x32x16_bf16 v[144:159], a[88:91], v[120:123], v[144:159]
    ds_read_b128 v[112:115], v37 offset:7168
    global_load_dwordx4 a[80:83], v43, s[16:17] offset:2048 sc1
    v_rcp_f32 v80, v80
    v_rcp_f32 v81, v81
    v_rcp_f32 v82, v82
    v_mfma_f32_32x32x16_bf16 v[144:159], a[92:95], v[124:127], v[144:159]
    ds_read_b128 v[116:119], v38 offset:7168
    global_load_dwordx4 a[84:87], v43, s[16:17] offset:3072 sc1
    s_waitcnt vmcnt(10)
    ds_read_b64_tr_b16 a[32:33], v14 offset:0
    ds_read_b64_tr_b16 a[34:35], v14 offset:1024
    s_waitcnt lgkmcnt(5)
    v_mfma_f32_32x32x16_bf16 v[144:159], a[96:99], v[96:99], v[144:159]
    ds_read_b128 v[120:123], v39 offset:7168
    ds_read_b64_tr_b16 a[36:37], v15 offset:0
    ds_read_b64_tr_b16 a[38:39], v15 offset:1024
    v_rcp_f32 v83, v83
    v_mul_f32 v220, v220, v80
    v_mfma_f32_32x32x16_bf16 v[144:159], a[100:103], v[100:103], v[144:159]
    ds_read_b128 v[124:127], v40 offset:7168
    global_load_dwordx4 a[88:91], v43, s[18:19] offset:-4096 sc1
    ds_read_b64_tr_b16 a[40:41], v14 offset:2048
    ds_read_b64_tr_b16 a[42:43], v14 offset:3072
    v_mul_f32 v221, v221, v81
    v_mul_f32 v222, v222, v82
    v_mul_f32 v223, v223, v83
    v_mfma_f32_32x32x16_bf16 v[144:159], a[104:107], v[104:107], v[144:159]
    ds_read_b128 v[96:99], v33 offset:6144
    global_load_dwordx4 a[92:95], v43, s[18:19] offset:-3072 sc1
    ds_read_b64_tr_b16 a[44:45], v15 offset:2048
    ds_read_b64_tr_b16 a[46:47], v15 offset:3072
    v_cvt_pk_bf16_f32 v90, v220, v221
    s_waitcnt lgkmcnt(11)
    v_mfma_f32_32x32x16_bf16 v[144:159], a[108:111], v[108:111], v[144:159]
    ds_read_b128 v[100:103], v34 offset:6144
    v_cvt_pk_bf16_f32 v91, v222, v223
    v_mfma_f32_32x32x16_bf16 v[144:159], a[112:115], v[112:115], v[144:159]
    ds_read_b128 v[104:107], v35 offset:6144
    global_load_dwordx4 a[96:99], v43, s[18:19] offset:-2048 sc1
    s_add_u32 s54, s58, 442368
    buffer_store_dwordx4 v[84:87], v41, s[44:47], s54 offen sc1
    v_mfma_f32_32x32x16_bf16 v[144:159], a[116:119], v[116:119], v[144:159]
    ds_read_b128 v[108:111], v36 offset:6144
    s_add_u32 s54, s58, 552960
    buffer_store_dwordx4 v[88:91], v41, s[44:47], s54 offen sc1
    s_waitcnt lgkmcnt(5)
    v_mfma_f32_32x32x16_bf16 v[144:159], a[120:123], v[120:123], v[144:159]
    ds_read_b128 v[112:115], v33 offset:7168
    s_waitcnt vmcnt(13)
    ds_read_b64_tr_b16 a[48:49], v14 offset:4096
    ds_read_b64_tr_b16 a[50:51], v14 offset:5120
    v_mul_f32 v76, v128, v73
    v_mul_f32 v77, v129, v73
    v_mul_f32 v78, v130, v73
    v_mfma_f32_32x32x16_bf16 v[144:159], a[124:127], v[124:127], v[144:159]
    ds_read_b128 v[116:119], v34 offset:7168
CHG1:
PAD2:
    s_cbranch_execz PAD3
    ds_read_b64_tr_b16 a[52:53], v15 offset:4096
    ds_read_b64_tr_b16 a[54:55], v15 offset:5120
    v_mul_f32 v79, v131, v73
    v_exp_f32 v76, v76
    v_mfma_f32_32x32x16_bf16 v[144:159], a[128:131], v[96:99], v[144:159]
    ds_read_b128 v[120:123], v35 offset:7168
    global_load_dwordx4 a[100:103], v43, s[18:19] offset:-1024 sc1
    v_exp_f32 v77, v77
    v_exp_f32 v78, v78
    s_waitcnt lgkmcnt(7)
    v_mfma_f32_32x32x16_bf16 v[144:159], a[132:135], v[100:103], v[144:159]
    ds_read_b128 v[124:127], v36 offset:7168
    v_exp_f32 v79, v79
    v_mul_f32 v136, v128, v136
    v_mul_f32 v137, v129, v137
    v_mul_f32 v138, v130, v138
    v_mul_f32 v139, v131, v139
    v_mfma_f32_32x32x16_bf16 v[144:159], a[136:139], v[104:107], v[144:159]
    global_load_dwordx4 a[104:107], v43, s[18:19] offset:0 sc1
    v_add_f32 v76, 1.0, v76
    v_add_f32 v77, 1.0, v77
    v_add_f32 v78, 1.0, v78
    v_add_f32 v79, 1.0, v79
    v_rcp_f32 v76, v76
    v_mfma_f32_32x32x16_bf16 v[144:159], a[140:143], v[108:111], v[144:159]
    v_rcp_f32 v77, v77
    v_rcp_f32 v78, v78
    v_rcp_f32 v79, v79
    v_mul_f32 v136, v136, v76
    s_waitcnt lgkmcnt(1)
    v_mfma_f32_32x32x16_bf16 v[144:159], a[144:147], v[112:115], v[144:159]
    global_load_dwordx4 a[108:111], v43, s[18:19] offset:1024 sc1
    v_mul_f32 v137, v137, v77
    v_mul_f32 v138, v138, v78
    v_mul_f32 v139, v139, v79
    v_cvt_pk_bf16_f32 v84, v136, v137
    v_cvt_pk_bf16_f32 v85, v138, v139
    v_mul_f32 v80, v132, v73
    v_mfma_f32_32x32x16_bf16 v[144:159], a[148:151], v[116:119], v[144:159]
    global_load_dwordx4 a[112:115], v43, s[20:21] offset:-4096 sc1
    v_mul_f32 v81, v133, v73
    v_mul_f32 v82, v134, v73
    v_mul_f32 v83, v135, v73
    v_exp_f32 v80, v80
    v_exp_f32 v81, v81
    v_mfma_f32_32x32x16_bf16 v[144:159], a[152:155], v[120:123], v[144:159]
    v_perm_b32 v50, v74, v74, s59
    v_exp_f32 v82, v82
    v_exp_f32 v83, v83
    v_mul_f32 v140, v132, v140
    s_waitcnt lgkmcnt(0)
    v_mfma_f32_32x32x16_bf16 v[144:159], a[156:159], v[124:127], v[144:159]
    global_load_dwordx4 a[116:119], v43, s[20:21] offset:-3072 sc1
    v_mul_f32 v141, v133, v141
    v_mul_f32 v142, v134, v142
    v_mul_f32 v143, v135, v143
    v_add_f32 v80, 1.0, v80
    v_add_f32 v81, 1.0, v81
    v_add_f32 v82, 1.0, v82
    v_mfma_f32_32x32x16_bf16 v[144:159], v[52:55], v[50:53], v[144:159]
    v_add_f32 v83, 1.0, v83
    v_rcp_f32 v80, v80
    v_rcp_f32 v81, v81
    v_rcp_f32 v82, v82
    s_waitcnt vmcnt(17)
    v_mfma_f32_32x32x16_bf16 v[96:111], a[160:163], a[56:59], 0
    global_load_dwordx4 a[120:123], v43, s[20:21] offset:-2048 sc1
    v_rcp_f32 v83, v83
    v_mul_f32 v140, v140, v80
    v_mul_f32 v141, v141, v81
    v_mul_f32 v142, v142, v82
    v_mfma_f32_32x32x16_bf16 v[112:127], a[164:167], a[56:59], 0
    v_mul_f32 v143, v143, v83
    v_cvt_pk_bf16_f32 v86, v140, v141
    v_cvt_pk_bf16_f32 v87, v142, v143
    s_waitcnt vmcnt(17)
    v_mfma_f32_32x32x16_bf16 v[96:111], a[168:171], a[60:63], v[96:111]
    global_load_dwordx4 a[124:127], v43, s[20:21] offset:-1024 sc1
    v_mfma_f32_32x32x16_bf16 v[112:127], a[172:175], a[60:63], v[112:127]
    v_mul_f32 v76, v144, v75
    v_mul_f32 v77, v145, v75
    v_mul_f32 v78, v146, v75
    v_mul_f32 v79, v147, v75
    s_waitcnt vmcnt(17)
    v_mfma_f32_32x32x16_bf16 v[96:111], a[176:179], a[64:67], v[96:111]
    global_load_dwordx4 a[128:131], v43, s[20:21] offset:0 sc1
    s_movk_i32 s65, 8192
    buffer_load_dword v32, v95, s[44:47], s65 offen sc1
    v_exp_f32 v76, v76
    v_mfma_f32_32x32x16_bf16 v[112:127], a[180:183], a[64:67], v[112:127]
    s_barrier
    v_exp_f32 v77, v77
    s_waitcnt vmcnt(18)
    v_mfma_f32_32x32x16_bf16 v[96:111], a[184:187], a[68:71], v[96:111]
    global_load_dwordx4 a[132:135], v43, s[20:21] offset:1024 sc1
    v_exp_f32 v78, v78
    v_exp_f32 v79, v79
    v_mul_f32 v152, v144, v152
    v_mfma_f32_32x32x16_bf16 v[112:127], a[188:191], a[68:71], v[112:127]
    v_mul_f32 v153, v145, v153
    v_mul_f32 v154, v146, v154
    v_mul_f32 v155, v147, v155
    v_add_f32 v76, 1.0, v76
    v_add_f32 v77, 1.0, v77
    s_waitcnt vmcnt(18)
    v_mfma_f32_32x32x16_bf16 v[96:111], a[192:195], a[72:75], v[96:111]
    global_load_dwordx4 a[136:139], v43, s[20:21] offset:2048 sc1
    v_add_f32 v78, 1.0, v78
    v_add_f32 v79, 1.0, v79
    v_rcp_f32 v76, v76
    v_mfma_f32_32x32x16_bf16 v[112:127], a[196:199], a[72:75], v[112:127]
    v_rcp_f32 v77, v77
    v_rcp_f32 v78, v78
    s_waitcnt vmcnt(18)
    v_mfma_f32_32x32x16_bf16 v[96:111], a[200:203], a[76:79], v[96:111]
    global_load_dwordx4 a[140:143], v43, s[20:21] offset:3072 sc1
    v_rcp_f32 v79, v79
    v_mul_f32 v152, v152, v76
    v_mul_f32 v153, v153, v77
    v_mul_f32 v154, v154, v78
    v_mfma_f32_32x32x16_bf16 v[112:127], a[204:207], a[76:79], v[112:127]
    v_mul_f32 v155, v155, v79
    v_cvt_pk_bf16_f32 v88, v152, v153
    v_cvt_pk_bf16_f32 v89, v154, v155
    v_mul_f32 v80, v148, v75
    v_mul_f32 v81, v149, v75
    s_waitcnt vmcnt(18)
    v_mfma_f32_32x32x16_bf16 v[96:111], a[208:211], a[80:83], v[96:111]
    global_load_dwordx4 a[144:147], v43, s[26:27] offset:-4096 sc1
    s_waitcnt vmcnt(13)
    buffer_store_dword v8, v9, s[44:47], s78 offen offset:0 sc1
    s_add_u32 s78, s78, 8192
    v_mfma_f32_32x32x16_bf16 v[112:127], a[212:215], a[80:83], v[112:127]
    v_mul_f32 v82, v150, v75
    v_mul_f32 v83, v151, v75
    v_exp_f32 v80, v80
    v_exp_f32 v81, v81
    v_mfma_f32_32x32x16_bf16 v[96:111], a[216:219], a[84:87], v[96:111]
    global_load_dwordx4 a[148:151], v43, s[26:27] offset:-3072 sc1
    v_exp_f32 v82, v82
    v_exp_f32 v83, v83
    v_mul_f32 v156, v148, v156
    v_mfma_f32_32x32x16_bf16 v[112:127], a[220:223], a[84:87], v[112:127]
    v_mul_f32 v157, v149, v157
    v_mul_f32 v158, v150, v158
    v_mul_f32 v159, v151, v159
    v_add_f32 v80, 1.0, v80
    v_add_f32 v81, 1.0, v81
    v_add_f32 v82, 1.0, v82
    v_mfma_f32_32x32x16_bf16 v[96:111], a[224:227], a[88:91], v[96:111]
    global_load_dwordx4 a[152:155], v43, s[26:27] offset:-2048 sc1
    v_add_f32 v83, 1.0, v83
    v_rcp_f32 v80, v80
    v_rcp_f32 v81, v81
    v_mfma_f32_32x32x16_bf16 v[112:127], a[228:231], a[88:91], v[112:127]
    v_rcp_f32 v82, v82
    v_rcp_f32 v83, v83
    v_mul_f32 v156, v156, v80
    v_mul_f32 v157, v157, v81
    v_mfma_f32_32x32x16_bf16 v[96:111], a[232:235], a[92:95], v[96:111]
    global_load_dwordx4 a[156:159], v43, s[26:27] offset:-1024 sc1
    v_mul_f32 v158, v158, v82
    v_mul_f32 v159, v159, v83
    v_cvt_pk_bf16_f32 v90, v156, v157
    v_cvt_pk_bf16_f32 v91, v158, v159
    v_mfma_f32_32x32x16_bf16 v[112:127], a[236:239], a[92:95], v[112:127]
    s_add_u32 s54, s58, 663552
    buffer_store_dwordx4 v[84:87], v41, s[44:47], s54 offen sc1
    v_mfma_f32_32x32x16_bf16 v[96:111], a[240:243], a[96:99], v[96:111]
    global_load_dwordx4 a[56:59], v43, s[26:27] offset:0 sc1
    s_add_u32 s54, s58, 774144
    buffer_store_dwordx4 v[88:91], v41, s[44:47], s54 offen sc1
    v_mfma_f32_32x32x16_bf16 v[112:127], a[244:247], a[96:99], v[112:127]
    s_waitcnt vmcnt(11)
    v_cmp_ne_u32 vcc, s3, v32
    s_nop 0
    s_cbranch_vccnz SLOW3
BACK3:
    v_add_u32 v43, 221184, v43
    v_mfma_f32_32x32x16_bf16 v[96:111], a[248:251], a[100:103], v[96:111]
    global_load_dwordx4 a[60:63], v43, s[16:17] offset:-4096 sc1
    v_mfma_f32_32x32x16_bf16 v[112:127], a[252:255], a[100:103], v[112:127]
    v_mfma_f32_32x32x16_bf16 v[96:111], v[224:227], a[104:107], v[96:111]
    global_load_dwordx4 a[64:67], v43, s[16:17] offset:-3072 sc1
    v_mfma_f32_32x32x16_bf16 v[112:127], v[228:231], a[104:107], v[112:127]
    v_mfma_f32_32x32x16_bf16 v[96:111], v[232:235], a[108:111], v[96:111]
    global_load_dwordx4 a[68:71], v43, s[16:17] offset:-2048 sc1
    v_mfma_f32_32x32x16_bf16 v[112:127], v[236:239], a[108:111], v[112:127]
    v_mfma_f32_32x32x16_bf16 v[96:111], v[240:243], a[112:115], v[96:111]
    global_load_dwordx4 a[72:75], v43, s[16:17] offset:-1024 sc1
    v_mfma_f32_32x32x16_bf16 v[112:127], v[244:247], a[112:115], v[112:127]
    v_mfma_f32_32x32x16_bf16 v[96:111], v[248:251], a[116:119], v[96:111]
    global_load_dwordx4 a[76:79], v43, s[16:17] offset:0 sc1
    v_mfma_f32_32x32x16_bf16 v[112:127], v[252:255], a[116:119], v[112:127]
    v_mfma_f32_32x32x16_bf16 v[96:111], v[160:163], a[120:123], v[96:111]
    global_load_dwordx4 a[80:83], v43, s[16:17] offset:1024 sc1
    v_mfma_f32_32x32x16_bf16 v[112:127], v[164:167], a[120:123], v[112:127]
    v_mfma_f32_32x32x16_bf16 v[96:111], v[168:171], a[124:127], v[96:111]
    global_load_dwordx4 a[84:87], v43, s[16:17] offset:2048 sc1
    v_mfma_f32_32x32x16_bf16 v[112:127], v[172:175], a[124:127], v[112:127]
    v_mfma_f32_32x32x16_bf16 v[96:111], v[176:179], a[128:131], v[96:111]
    global_load_dwordx4 a[88:91], v43, s[16:17] offset:3072 sc1
    v_mfma_f32_32x32x16_bf16 v[112:127], v[180:183], a[128:131], v[112:127]
    s_waitcnt vmcnt(18)
    v_mfma_f32_32x32x16_bf16 v[96:111], v[184:187], a[132:135], v[96:111]
    global_load_dwordx4 a[92:95], v43, s[18:19] offset:-4096 sc1
    s_add_u32 m0, s10, 0
    s_nop 0
    buffer_load_dwordx4 v57, s[40:43], 0 offen lds
    v_mfma_f32_32x32x16_bf16 v[112:127], v[188:191], a[132:135], v[112:127]
    s_waitcnt vmcnt(19)
    v_mfma_f32_32x32x16_bf16 v[96:111], a[0:3], a[136:139], v[96:111]
    s_add_u32 m0, s10, 4096
    s_nop 0
    buffer_load_dwordx4 v57, s[40:43], s69 offen lds
    v_mfma_f32_32x32x16_bf16 v[112:127], a[4:7], a[136:139], v[112:127]
    s_waitcnt vmcnt(19)
    v_mfma_f32_32x32x16_bf16 v[96:111], a[8:11], a[140:143], v[96:111]
    s_add_u32 m0, s10, 8192
    s_nop 0
    buffer_load_dwordx4 v57, s[40:43], s70 offen lds
    v_mfma_f32_32x32x16_bf16 v[112:127], a[12:15], a[140:143], v[112:127]
    s_add_u32 m0, s10, 12288
    s_nop 0
    buffer_load_dwordx4 v57, s[40:43], s71 offen lds
    buffer_load_dwordx2 v[88:89], v58, s[44:47], 0 offen offset:0 sc1
    buffer_load_dwordx2 v[90:91], v58, s[44:47], 0 offen offset:2048 sc1
    global_load_dwordx4 a[96:99], v43, s[18:19] offset:-3072 sc1
    s_waitcnt vmcnt(23)
    v_mfma_f32_32x32x16_bf16 v[96:111], a[16:19], a[144:147], v[96:111]
    v_mfma_f32_32x32x16_bf16 v[112:127], a[20:23], a[144:147], v[112:127]
    global_load_dwordx4 a[100:103], v43, s[18:19] offset:-2048 sc1
    s_waitcnt vmcnt(22)
    v_mfma_f32_32x32x16_bf16 v[96:111], a[24:27], a[148:151], v[96:111]
    s_waitcnt vmcnt(17)
    buffer_store_dword v8, v9, s[44:47], s78 offen offset:0 sc1
    s_add_u32 s78, s78, 8192
    v_mfma_f32_32x32x16_bf16 v[112:127], a[28:31], a[148:151], v[112:127]
    global_load_dwordx4 a[104:107], v43, s[18:19] offset:-1024 sc1
    v_mfma_f32_32x32x16_bf16 v[96:111], a[32:35], a[152:155], v[96:111]
    v_mfma_f32_32x32x16_bf16 v[112:127], a[36:39], a[152:155], v[112:127]
    global_load_dwordx4 a[108:111], v43, s[18:19] offset:0 sc1
    v_mfma_f32_32x32x16_bf16 v[96:111], a[40:43], a[156:159], v[96:111]
    v_mfma_f32_32x32x16_bf16 v[112:127], a[44:47], a[156:159], v[112:127]
    global_load_dwordx4 a[112:115], v43, s[18:19] offset:1024 sc1
    v_mfma_f32_32x32x16_bf16 v[96:111], a[48:51], a[56:59], v[96:111]
    v_mfma_f32_32x32x16_bf16 v[112:127], a[52:55], a[56:59], v[112:127]
    global_load_dwordx4 a[116:119], v43, s[20:21] offset:-4096 sc1
    s_waitcnt vmcnt(21)
    v_mfma_f32_32x32x16_bf16 v[192:207], a[160:163], a[60:63], 0
    v_mfma_f32_32x32x16_bf16 v[208:223], a[164:167], a[60:63], 0
    global_load_dwordx4 a[120:123], v43, s[20:21] offset:-3072 sc1
    s_waitcnt vmcnt(21)
    v_mfma_f32_32x32x16_bf16 v[192:207], a[168:171], a[64:67], v[192:207]
    v_mfma_f32_32x32x16_bf16 v[208:223], a[172:175], a[64:67], v[208:223]
    global_load_dwordx4 a[124:127], v43, s[20:21] offset:-2048 sc1
    s_waitcnt vmcnt(21)
    v_mfma_f32_32x32x16_bf16 v[192:207], a[176:179], a[68:71], v[192:207]
    ds_write_b128 v19, v[96:99] offset:0
    v_mfma_f32_32x32x16_bf16 v[208:223], a[180:183], a[68:71], v[208:223]
    global_load_dwordx4 a[128:131], v43, s[20:21] offset:-1024 sc1
    ds_write_b128 v19, v[100:103] offset:1024
    s_waitcnt vmcnt(21)
    v_mfma_f32_32x32x16_bf16 v[192:207], a[184:187], a[72:75], v[192:207]
    ds_write_b128 v20, v[104:107] offset:0
    v_mfma_f32_32x32x16_bf16 v[208:223], a[188:191], a[72:75], v[208:223]
    global_load_dwordx4 a[132:135], v43, s[20:21] offset:0 sc1
    s_movk_i32 s64, 16384
    buffer_load_dword v41, v95, s[44:47], s64 offen sc1
    s_waitcnt vmcnt(22)
    v_mfma_f32_32x32x16_bf16 v[192:207], a[192:195], a[76:79], v[192:207]
    ds_write_b128 v20, v[108:111] offset:1024
    v_mfma_f32_32x32x16_bf16 v[208:223], a[196:199], a[76:79], v[208:223]
    global_load_dwordx4 a[136:139], v43, s[20:21] offset:1024 sc1
    ds_write_b128 v21, v[112:115] offset:0
    s_waitcnt vmcnt(22)
    v_mfma_f32_32x32x16_bf16 v[192:207], a[200:203], a[80:83], v[192:207]
    ds_write_b128 v21, v[116:119] offset:1024
    v_mfma_f32_32x32x16_bf16 v[208:223], a[204:207], a[80:83], v[208:223]
    global_load_dwordx4 a[140:143], v43, s[20:21] offset:2048 sc1
    s_waitcnt vmcnt(22)
    v_mfma_f32_32x32x16_bf16 v[192:207], a[208:211], a[84:87], v[192:207]
    v_mfma_f32_32x32x16_bf16 v[208:223], a[212:215], a[84:87], v[208:223]
    global_load_dwordx4 a[144:147], v43, s[20:21] offset:3072 sc1
    s_waitcnt vmcnt(22)
    v_mfma_f32_32x32x16_bf16 v[192:207], a[216:219], a[88:91], v[192:207]
    v_mfma_f32_32x32x16_bf16 v[208:223], a[220:223], a[88:91], v[208:223]
    global_load_dwordx4 a[148:151], v43, s[26:27] offset:-4096 sc1
    s_waitcnt vmcnt(22)
    v_mfma_f32_32x32x16_bf16 v[192:207], a[224:227], a[92:95], v[192:207]
    global_load_dwordx4 a[152:155], v43, s[26:27] offset:-3072 sc1
    s_waitcnt lgkmcnt(0)
    s_barrier
    v_mfma_f32_32x32x16_bf16 v[208:223], a[228:231], a[92:95], v[208:223]
    ds_read_b128 v[96:99], v22 offset:0
    ds_read_b128 v[100:103], v22 offset:1024
    ds_read_b128 v[104:107], v22 offset:2048
    ds_read_b128 v[108:111], v22 offset:3072
    s_waitcnt vmcnt(16)
    v_mfma_f32_32x32x16_bf16 v[192:207], a[232:235], a[96:99], v[192:207]
    global_load_dwordx4 a[156:159], v43, s[26:27] offset:-2048 sc1
    ds_read_b128 v[112:115], v22 offset:4096
    ds_read_b128 v[116:119], v22 offset:5120
    v_mfma_f32_32x32x16_bf16 v[208:223], a[236:239], a[96:99], v[208:223]
    s_waitcnt vmcnt(16)
    v_mfma_f32_32x32x16_bf16 v[192:207], a[240:243], a[100:103], v[192:207]
    global_load_dwordx4 a[56:59], v43, s[26:27] offset:-1024 sc1
    v_mfma_f32_32x32x16_bf16 v[208:223], a[244:247], a[100:103], v[208:223]
    s_waitcnt vmcnt(15)
    v_mfma_f32_32x32x16_bf16 v[192:207], a[248:251], a[104:107], v[192:207]
    global_load_dwordx4 a[60:63], v43, s[26:27] offset:0 sc1
    s_waitcnt vmcnt(8)
    v_cmp_ne_u32 vcc, s3, v41
    s_nop 0
    s_cbranch_vccnz SLOW4
BACK4:
    v_mfma_f32_32x32x16_bf16 v[208:223], a[252:255], a[104:107], v[208:223]
    v_add_u32 v43, 221184, v43
    s_waitcnt lgkmcnt(2)
    v_add_f32 v96, v96, v104
    v_add_f32 v97, v97, v105
    v_add_f32 v98, v98, v106
    v_mfma_f32_32x32x16_bf16 v[192:207], v[224:227], a[108:111], v[192:207]
    global_load_dwordx4 a[64:67], v43, s[16:17] offset:-4096 sc1
    v_add_f32 v99, v99, v107
    v_add_f32 v100, v100, v108
    v_add_f32 v101, v101, v109
    v_add_f32 v102, v102, v110
    v_mfma_f32_32x32x16_bf16 v[208:223], v[228:231], a[108:111], v[208:223]
    v_add_f32 v103, v103, v111
    s_waitcnt lgkmcnt(0)
    v_add_f32 v112, v112, v120
    v_add_f32 v113, v113, v121
    v_add_f32 v114, v114, v122
    v_mfma_f32_32x32x16_bf16 v[192:207], v[232:235], a[112:115], v[192:207]
    global_load_dwordx4 a[68:71], v43, s[16:17] offset:-3072 sc1
    v_add_f32 v115, v115, v123
    v_add_f32 v116, v116, v124
    v_add_f32 v117, v117, v125
    v_add_f32 v118, v118, v126
    v_mfma_f32_32x32x16_bf16 v[208:223], v[236:239], a[112:115], v[208:223]
    global_load_dwordx4 a[72:75], v43, s[16:17] offset:-2048 sc1
    v_add_f32 v119, v119, v127
    v_add_f32 v44, v96, v112
    v_add_f32 v45, v97, v113
    v_add_f32 v46, v98, v114
    v_mfma_f32_32x32x16_bf16 v[192:207], v[240:243], a[116:119], v[192:207]
    v_add_f32 v47, v99, v115
    v_add_f32 v48, v100, v116
    v_add_f32 v49, v101, v117
    v_add_f32 v50, v102, v118
    v_add_f32 v51, v103, v119
    v_mfma_f32_32x32x16_bf16 v[208:223], v[244:247], a[116:119], v[208:223]
    global_load_dwordx4 a[76:79], v43, s[16:17] offset:-1024 sc1
    v_mfma_f32_32x32x16_bf16 v[192:207], v[248:251], a[120:123], v[192:207]
    v_mfma_f32_32x32x16_bf16 v[208:223], v[252:255], a[120:123], v[208:223]
    global_load_dwordx4 a[80:83], v43, s[16:17] offset:0 sc1
    v_mfma_f32_32x32x16_bf16 v[192:207], v[160:163], a[124:127], v[192:207]
    v_mfma_f32_32x32x16_bf16 v[208:223], v[164:167], a[124:127], v[208:223]
    global_load_dwordx4 a[84:87], v43, s[16:17] offset:1024 sc1
    v_mfma_f32_32x32x16_bf16 v[192:207], v[168:171], a[128:131], v[192:207]
    v_mfma_f32_32x32x16_bf16 v[208:223], v[172:175], a[128:131], v[208:223]
    global_load_dwordx4 a[88:91], v43, s[16:17] offset:2048 sc1
    v_mfma_f32_32x32x16_bf16 v[192:207], v[176:179], a[132:135], v[192:207]
    global_load_dwordx4 a[92:95], v43, s[16:17] offset:3072 sc1
    v_mfma_f32_32x32x16_bf16 v[208:223], v[180:183], a[132:135], v[208:223]
    s_waitcnt vmcnt(15)
    v_mfma_f32_32x32x16_bf16 v[192:207], v[184:187], a[136:139], v[192:207]
    global_load_dwordx4 a[96:99], v43, s[18:19] offset:-4096 sc1
    v_mfma_f32_32x32x16_bf16 v[208:223], v[188:191], a[136:139], v[208:223]
    s_waitcnt vmcnt(15)
    v_mfma_f32_32x32x16_bf16 v[192:207], a[0:3], a[140:143], v[192:207]
    global_load_dwordx4 a[100:103], v43, s[18:19] offset:-3072 sc1
    v_mfma_f32_32x32x16_bf16 v[208:223], a[4:7], a[140:143], v[208:223]
    s_waitcnt vmcnt(15)
    v_mfma_f32_32x32x16_bf16 v[192:207], a[8:11], a[144:147], v[192:207]
    global_load_dwordx4 a[104:107], v43, s[18:19] offset:-2048 sc1
    v_mfma_f32_32x32x16_bf16 v[208:223], a[12:15], a[144:147], v[208:223]
    s_waitcnt vmcnt(15)
    v_mfma_f32_32x32x16_bf16 v[192:207], a[16:19], a[148:151], v[192:207]
    global_load_dwordx4 a[108:111], v43, s[18:19] offset:-1024 sc1
    v_mfma_f32_32x32x16_bf16 v[208:223], a[20:23], a[148:151], v[208:223]
    s_waitcnt vmcnt(15)
    v_mfma_f32_32x32x16_bf16 v[192:207], a[24:27], a[152:155], v[192:207]
    global_load_dwordx4 a[112:115], v43, s[18:19] offset:0 sc1
    v_mfma_f32_32x32x16_bf16 v[208:223], a[28:31], a[152:155], v[208:223]
    s_waitcnt vmcnt(15)
    v_mfma_f32_32x32x16_bf16 v[192:207], a[32:35], a[156:159], v[192:207]
    global_load_dwordx4 a[116:119], v43, s[18:19] offset:1024 sc1
    v_mfma_f32_32x32x16_bf16 v[208:223], a[36:39], a[156:159], v[208:223]
    s_waitcnt vmcnt(15)
    v_mfma_f32_32x32x16_bf16 v[192:207], a[40:43], a[56:59], v[192:207]
    global_load_dwordx4 a[120:123], v43, s[20:21] offset:-4096 sc1
    v_mfma_f32_32x32x16_bf16 v[208:223], a[44:47], a[56:59], v[208:223]
    s_waitcnt vmcnt(15)
    v_mfma_f32_32x32x16_bf16 v[192:207], a[48:51], a[60:63], v[192:207]
    global_load_dwordx4 a[124:127], v43, s[20:21] offset:-3072 sc1
    v_mfma_f32_32x32x16_bf16 v[208:223], a[52:55], a[60:63], v[208:223]
    s_waitcnt vmcnt(15)
    v_mfma_f32_32x32x16_bf16 v[96:111], a[160:163], a[64:67], 0
    global_load_dwordx4 a[128:131], v43, s[20:21] offset:-2048 sc1
    v_mfma_f32_32x32x16_bf16 v[112:127], a[164:167], a[64:67], 0
    s_waitcnt vmcnt(15)
    v_mfma_f32_32x32x16_bf16 v[96:111], a[168:171], a[68:71], v[96:111]
    global_load_dwordx4 a[132:135], v43, s[20:21] offset:-1024 sc1
    v_mfma_f32_32x32x16_bf16 v[112:127], a[172:175], a[68:71], v[112:127]
    s_waitcnt vmcnt(15)
    v_mfma_f32_32x32x16_bf16 v[96:111], a[176:179], a[72:75], v[96:111]
    global_load_dwordx4 a[136:139], v43, s[20:21] offset:0 sc1
    s_movk_i32 s65, 24576
    buffer_load_dword v32, v95, s[44:47], s65 offen sc1
    v_mfma_f32_32x32x16_bf16 v[112:127], a[180:183], a[72:75], v[112:127]
    ds_write_b128 v19, v[192:195] offset:24576
    s_waitcnt vmcnt(16)
    v_mfma_f32_32x32x16_bf16 v[96:111], a[184:187], a[76:79], v[96:111]
    global_load_dwordx4 a[140:143], v43, s[20:21] offset:1024 sc1
    ds_write_b128 v19, v[196:199] offset:25600
    v_mfma_f32_32x32x16_bf16 v[112:127], a[188:191], a[76:79], v[112:127]
    ds_write_b128 v20, v[200:203] offset:24576
    s_waitcnt vmcnt(16)
    v_mfma_f32_32x32x16_bf16 v[96:111], a[192:195], a[80:83], v[96:111]
    global_load_dwordx4 a[144:147], v43, s[20:21] offset:2048 sc1
    ds_write_b128 v20, v[204:207] offset:25600
    v_mfma_f32_32x32x16_bf16 v[112:127], a[196:199], a[80:83], v[112:127]
    ds_write_b128 v21, v[208:211] offset:24576
    s_waitcnt vmcnt(16)
    v_mfma_f32_32x32x16_bf16 v[96:111], a[200:203], a[84:87], v[96:111]
    global_load_dwordx4 a[148:151], v43, s[20:21] offset:3072 sc1
    ds_write_b128 v21, v[212:215] offset:25600
    v_mfma_f32_32x32x16_bf16 v[112:127], a[204:207], a[84:87], v[112:127]
    s_waitcnt vmcnt(16)
    v_mfma_f32_32x32x16_bf16 v[96:111], a[208:211], a[88:91], v[96:111]
    global_load_dwordx4 a[152:155], v43, s[26:27] offset:-4096 sc1
    v_mfma_f32_32x32x16_bf16 v[112:127], a[212:215], a[88:91], v[112:127]
    s_waitcnt vmcnt(16)
    v_mfma_f32_32x32x16_bf16 v[96:111], a[216:219], a[92:95], v[96:111]
    global_load_dwordx4 a[156:159], v43, s[26:27] offset:-3072 sc1
    v_mfma_f32_32x32x16_bf16 v[112:127], a[220:223], a[92:95], v[112:127]
    s_waitcnt vmcnt(16)
    v_mfma_f32_32x32x16_bf16 v[96:111], a[224:227], a[96:99], v[96:111]
    global_load_dwordx4 a[56:59], v43, s[26:27] offset:-2048 sc1
    s_waitcnt lgkmcnt(0)
    s_barrier
    v_mfma_f32_32x32x16_bf16 v[112:127], a[228:231], a[96:99], v[112:127]
    ds_read_b128 v[192:195], v22 offset:24576
    ds_read_b128 v[196:199], v22 offset:25600
    ds_read_b128 v[200:203], v22 offset:26624
    ds_read_b128 v[204:207], v22 offset:27648
    s_waitcnt vmcnt(16)
    v_mfma_f32_32x32x16_bf16 v[96:111], a[232:235], a[100:103], v[96:111]
    global_load_dwordx4 a[60:63], v43, s[26:27] offset:-1024 sc1
    ds_read_b128 v[208:211], v22 offset:28672
    ds_read_b128 v[212:215], v22 offset:29696
    ds_bpermute_b32 v40, v93, v88 offset:0
    ds_read_b128 v[4:7], v56 offset:0
    v_mfma_f32_32x32x16_bf16 v[112:127], a[236:239], a[100:103], v[112:127]
    s_waitcnt vmcnt(16)
    v_mfma_f32_32x32x16_bf16 v[96:111], a[240:243], a[104:107], v[96:111]
    global_load_dwordx4 a[64:67], v43, s[26:27] offset:0 sc1
    s_waitcnt vmcnt(8)
    v_cmp_ne_u32 vcc, s3, v32
    s_nop 0
    s_cbranch_vccnz SLOW5
BACK5:
    v_mfma_f32_32x32x16_bf16 v[112:127], a[244:247], a[104:107], v[112:127]
    v_add_u32 v43, 221184, v43
    v_mfma_f32_32x32x16_bf16 v[96:111], a[248:251], a[108:111], v[96:111]
    global_load_dwordx4 a[68:71], v43, s[16:17] offset:-4096 sc1
    v_mfma_f32_32x32x16_bf16 v[112:127], a[252:255], a[108:111], v[112:127]
    v_mfma_f32_32x32x16_bf16 v[96:111], v[224:227], a[112:115], v[96:111]
    global_load_dwordx4 a[72:75], v43, s[16:17] offset:-3072 sc1
    s_waitcnt lgkmcnt(0)
    v_add_f32 v192, v192, v200
    v_add_f32 v193, v193, v201
    v_add_f32 v194, v194, v202
    v_mfma_f32_32x32x16_bf16 v[112:127], v[228:231], a[112:115], v[112:127]
    v_add_f32 v195, v195, v203
    v_add_f32 v196, v196, v204
    v_add_f32 v197, v197, v205
    v_add_f32 v198, v198, v206
    v_add_f32 v199, v199, v207
    v_mfma_f32_32x32x16_bf16 v[96:111], v[232:235], a[116:119], v[96:111]
    global_load_dwordx4 a[76:79], v43, s[16:17] offset:-2048 sc1
    v_add_f32 v208, v208, v216
    v_add_f32 v209, v209, v217
    v_add_f32 v210, v210, v218
    v_add_f32 v211, v211, v219
    v_mfma_f32_32x32x16_bf16 v[112:127], v[236:239], a[116:119], v[112:127]
    v_add_f32 v212, v212, v220
    v_add_f32 v213, v213, v221
    v_add_f32 v214, v214, v222
    v_add_f32 v215, v215, v223
    v_add_f32 v52, v192, v208
    v_mfma_f32_32x32x16_bf16 v[96:111], v[240:243], a[120:123], v[96:111]
    global_load_dwordx4 a[80:83], v43, s[16:17] offset:-1024 sc1
    v_add_f32 v53, v193, v209
    v_add_f32 v54, v194, v210
    v_add_f32 v55, v195, v211
    v_add_f32 v60, v196, v212
    v_mfma_f32_32x32x16_bf16 v[112:127], v[244:247], a[120:123], v[112:127]
    v_add_f32 v61, v197, v213
    v_add_f32 v62, v198, v214
    v_add_f32 v63, v199, v215
    v_and_b32 v33, s60, v40
    v_mfma_f32_32x32x16_bf16 v[96:111], v[248:251], a[124:127], v[96:111]
    global_load_dwordx4 a[84:87], v43, s[16:17] offset:0 sc1
    v_rcp_f32 v33, v33
    v_lshlrev_b32 v34, 16, v40
    v_mul_f32 v34, v34, v33
    v_mfma_f32_32x32x16_bf16 v[112:127], v[252:255], a[124:127], v[112:127]
    v_mul_f32 v35, v33, v33
    v_lshlrev_b32 v128, 16, v4
    v_and_b32 v129, s60, v4
    v_lshlrev_b32 v130, 16, v5
    v_and_b32 v131, s60, v5
    v_mfma_f32_32x32x16_bf16 v[96:111], v[160:163], a[128:131], v[96:111]
    global_load_dwordx4 a[88:91], v43, s[16:17] offset:1024 sc1
    v_lshlrev_b32 v132, 16, v6
    v_and_b32 v133, s60, v6
    v_lshlrev_b32 v134, 16, v7
    v_and_b32 v135, s60, v7
    v_mfma_f32_32x32x16_bf16 v[112:127], v[164:167], a[128:131], v[112:127]
    v_fma_f32 v44, v44, v35, v128
    v_fma_f32 v45, v45, v35, v129
    v_fma_f32 v46, v46, v35, v130
    v_fma_f32 v47, v47, v35, v131
    v_fma_f32 v48, v48, v35, v132
    v_mfma_f32_32x32x16_bf16 v[96:111], v[168:171], a[132:135], v[96:111]
    global_load_dwordx4 a[92:95], v43, s[16:17] offset:2048 sc1
    v_fma_f32 v49, v49, v35, v133
    v_fma_f32 v50, v50, v35, v134
    v_fma_f32 v51, v51, v35, v135
    v_fma_f32 v128, v128, v33, v34
    v_mfma_f32_32x32x16_bf16 v[112:127], v[172:175], a[132:135], v[112:127]
    v_fma_f32 v129, v129, v33, v34
    v_fma_f32 v130, v130, v33, v34
    v_fma_f32 v131, v131, v33, v34
    v_fma_f32 v132, v132, v33, v34
    v_fma_f32 v133, v133, v33, v34
    v_mfma_f32_32x32x16_bf16 v[96:111], v[176:179], a[136:139], v[96:111]
    global_load_dwordx4 a[96:99], v43, s[16:17] offset:3072 sc1
    v_fma_f32 v134, v134, v33, v34
    v_fma_f32 v135, v135, v33, v34
    v_mfma_f32_32x32x16_bf16 v[112:127], v[180:183], a[136:139], v[112:127]
    ds_bpermute_b32 v40, v93, v88 offset:128
    ds_read_b128 v[4:7], v56 offset:4096
    s_waitcnt vmcnt(15)
    v_mfma_f32_32x32x16_bf16 v[96:111], v[184:187], a[140:143], v[96:111]
    global_load_dwordx4 a[100:103], v43, s[18:19] offset:-4096 sc1
    v_mfma_f32_32x32x16_bf16 v[112:127], v[188:191], a[140:143], v[112:127]
    s_waitcnt vmcnt(15)
    v_mfma_f32_32x32x16_bf16 v[96:111], a[0:3], a[144:147], v[96:111]
    global_load_dwordx4 a[104:107], v43, s[18:19] offset:-3072 sc1
    v_mfma_f32_32x32x16_bf16 v[112:127], a[4:7], a[144:147], v[112:127]
    s_waitcnt vmcnt(15)
    v_mfma_f32_32x32x16_bf16 v[96:111], a[8:11], a[148:151], v[96:111]
    global_load_dwordx4 a[108:111], v43, s[18:19] offset:-2048 sc1
    s_waitcnt lgkmcnt(1)
    v_and_b32 v33, s60, v40
    v_rcp_f32 v33, v33
    v_mfma_f32_32x32x16_bf16 v[112:127], a[12:15], a[148:151], v[112:127]
    v_lshlrev_b32 v34, 16, v40
    v_mul_f32 v34, v34, v33
    v_mul_f32 v35, v33, v33
    s_waitcnt lgkmcnt(0)
    v_lshlrev_b32 v136, 16, v4
    s_waitcnt vmcnt(15)
    v_mfma_f32_32x32x16_bf16 v[96:111], a[16:19], a[152:155], v[96:111]
    global_load_dwordx4 a[112:115], v43, s[18:19] offset:-1024 sc1
    v_and_b32 v137, s60, v4
    v_lshlrev_b32 v138, 16, v5
    v_and_b32 v139, s60, v5
    v_lshlrev_b32 v140, 16, v6
    v_mfma_f32_32x32x16_bf16 v[112:127], a[20:23], a[152:155], v[112:127]
    v_and_b32 v141, s60, v6
    v_lshlrev_b32 v142, 16, v7
    v_and_b32 v143, s60, v7
    v_fma_f32 v52, v52, v35, v136
    s_waitcnt vmcnt(15)
    v_mfma_f32_32x32x16_bf16 v[96:111], a[24:27], a[156:159], v[96:111]
    global_load_dwordx4 a[116:119], v43, s[18:19] offset:0 sc1
    v_fma_f32 v53, v53, v35, v137
    v_fma_f32 v54, v54, v35, v138
    v_fma_f32 v55, v55, v35, v139
    v_fma_f32 v60, v60, v35, v140
    v_mfma_f32_32x32x16_bf16 v[112:127], a[28:31], a[156:159], v[112:127]
    v_fma_f32 v61, v61, v35, v141
    v_fma_f32 v62, v62, v35, v142
    v_fma_f32 v63, v63, v35, v143
    v_fma_f32 v136, v136, v33, v34
    s_waitcnt vmcnt(15)
    v_mfma_f32_32x32x16_bf16 v[96:111], a[32:35], a[56:59], v[96:111]
    global_load_dwordx4 a[120:123], v43, s[18:19] offset:1024 sc1
    v_fma_f32 v137, v137, v33, v34
    v_fma_f32 v138, v138, v33, v34
    v_fma_f32 v139, v139, v33, v34
    v_fma_f32 v140, v140, v33, v34
    v_mfma_f32_32x32x16_bf16 v[112:127], a[36:39], a[56:59], v[112:127]
    v_fma_f32 v141, v141, v33, v34
    v_fma_f32 v142, v142, v33, v34
    v_fma_f32 v143, v143, v33, v34
    s_waitcnt vmcnt(15)
    v_mfma_f32_32x32x16_bf16 v[96:111], a[40:43], a[60:63], v[96:111]
    global_load_dwordx4 a[124:127], v43, s[20:21] offset:-4096 sc1
    v_mfma_f32_32x32x16_bf16 v[112:127], a[44:47], a[60:63], v[112:127]
    s_waitcnt vmcnt(15)
    v_mfma_f32_32x32x16_bf16 v[96:111], a[48:51], a[64:67], v[96:111]
    global_load_dwordx4 a[128:131], v43, s[20:21] offset:-3072 sc1
    v_mfma_f32_32x32x16_bf16 v[112:127], a[52:55], a[64:67], v[112:127]
    s_waitcnt vmcnt(15)
    v_mfma_f32_32x32x16_bf16 v[192:207], a[160:163], a[68:71], 0
    global_load_dwordx4 a[132:135], v43, s[20:21] offset:-2048 sc1
    v_mfma_f32_32x32x16_bf16 v[208:223], a[164:167], a[68:71], 0
    s_waitcnt vmcnt(15)
    v_mfma_f32_32x32x16_bf16 v[192:207], a[168:171], a[72:75], v[192:207]
    global_load_dwordx4 a[136:139], v43, s[20:21] offset:-1024 sc1
    v_mfma_f32_32x32x16_bf16 v[208:223], a[172:175], a[72:75], v[208:223]
    s_waitcnt vmcnt(15)
    v_mfma_f32_32x32x16_bf16 v[192:207], a[176:179], a[76:79], v[192:207]
    global_load_dwordx4 a[140:143], v43, s[20:21] offset:0 sc1
    ds_write_b128 v19, v[96:99] offset:0
    v_mfma_f32_32x32x16_bf16 v[208:223], a[180:183], a[76:79], v[208:223]
    ds_write_b128 v19, v[100:103] offset:1024
    s_waitcnt vmcnt(15)
    v_mfma_f32_32x32x16_bf16 v[192:207], a[184:187], a[80:83], v[192:207]
    global_load_dwordx4 a[144:147], v43, s[20:21] offset:1024 sc1
    ds_write_b128 v20, v[104:107] offset:0
    v_mfma_f32_32x32x16_bf16 v[208:223], a[188:191], a[80:83], v[208:223]
    ds_write_b128 v20, v[108:111] offset:1024
    s_waitcnt vmcnt(15)
    v_mfma_f32_32x32x16_bf16 v[192:207], a[192:195], a[84:87], v[192:207]
    global_load_dwordx4 a[148:151], v43, s[20:21] offset:2048 sc1
    ds_write_b128 v21, v[112:115] offset:0
    v_mfma_f32_32x32x16_bf16 v[208:223], a[196:199], a[84:87], v[208:223]
    ds_write_b128 v21, v[116:119] offset:1024
    s_waitcnt vmcnt(15)
    v_mfma_f32_32x32x16_bf16 v[192:207], a[200:203], a[88:91], v[192:207]
    global_load_dwordx4 a[152:155], v43, s[20:21] offset:3072 sc1
    v_mfma_f32_32x32x16_bf16 v[208:223], a[204:207], a[88:91], v[208:223]
    s_waitcnt vmcnt(15)
    v_mfma_f32_32x32x16_bf16 v[192:207], a[208:211], a[92:95], v[192:207]
    global_load_dwordx4 a[156:159], v43, s[26:27] offset:-4096 sc1
    v_mfma_f32_32x32x16_bf16 v[208:223], a[212:215], a[92:95], v[208:223]
    s_waitcnt vmcnt(15)
    v_mfma_f32_32x32x16_bf16 v[192:207], a[216:219], a[96:99], v[192:207]
PAD3:
    s_cbranch_execz WRETG
    global_load_dwordx4 a[56:59], v43, s[26:27] offset:-3072 sc1
    v_mfma_f32_32x32x16_bf16 v[208:223], a[220:223], a[96:99], v[208:223]
    s_waitcnt lgkmcnt(0)
    s_barrier
    s_waitcnt vmcnt(15)
    v_mfma_f32_32x32x16_bf16 v[192:207], a[224:227], a[100:103], v[192:207]
    global_load_dwordx4 a[60:63], v43, s[26:27] offset:-2048 sc1
    ds_read_b128 v[96:99], v22 offset:0
    ds_read_b128 v[100:103], v22 offset:1024
    ds_read_b128 v[104:107], v22 offset:2048
    ds_read_b128 v[108:111], v22 offset:3072
    v_mfma_f32_32x32x16_bf16 v[208:223], a[228:231], a[100:103], v[208:223]
    ds_read_b128 v[112:115], v22 offset:4096
    ds_read_b128 v[116:119], v22 offset:5120
    s_waitcnt vmcnt(15)
    v_mfma_f32_32x32x16_bf16 v[192:207], a[232:235], a[104:107], v[192:207]
    global_load_dwordx4 a[64:67], v43, s[26:27] offset:-1024 sc1
    v_mfma_f32_32x32x16_bf16 v[208:223], a[236:239], a[104:107], v[208:223]
    s_waitcnt vmcnt(15)
    v_mfma_f32_32x32x16_bf16 v[192:207], a[240:243], a[108:111], v[192:207]
    global_load_dwordx4 a[68:71], v43, s[26:27] offset:0 sc1
    s_movk_i32 s68, 16384
    buffer_load_dword v32, v92, s[44:47], 0 offen sc1
    v_mfma_f32_32x32x16_bf16 v[208:223], a[244:247], a[108:111], v[208:223]
    s_waitcnt vmcnt(16)
    v_mfma_f32_32x32x16_bf16 v[192:207], a[248:251], a[112:115], v[192:207]
    s_waitcnt lgkmcnt(2)
    v_add_f32 v96, v96, v104
    v_add_f32 v97, v97, v105
    v_add_f32 v98, v98, v106
    v_add_f32 v99, v99, v107
    v_mfma_f32_32x32x16_bf16 v[208:223], a[252:255], a[112:115], v[208:223]
    v_add_f32 v100, v100, v108
    v_add_f32 v101, v101, v109
    v_add_f32 v102, v102, v110
    v_add_f32 v103, v103, v111
    s_waitcnt vmcnt(15)
    v_mfma_f32_32x32x16_bf16 v[192:207], v[224:227], a[116:119], v[192:207]
    s_waitcnt lgkmcnt(0)
    v_add_f32 v112, v112, v120
    v_add_f32 v113, v113, v121
    v_add_f32 v114, v114, v122
    v_add_f32 v115, v115, v123
    v_mfma_f32_32x32x16_bf16 v[208:223], v[228:231], a[116:119], v[208:223]
    v_add_f32 v116, v116, v124
    v_add_f32 v117, v117, v125
    v_add_f32 v118, v118, v126
    v_add_f32 v119, v119, v127
    s_waitcnt vmcnt(14)
    v_mfma_f32_32x32x16_bf16 v[192:207], v[232:235], a[120:123], v[192:207]
    v_add_f32 v64, v96, v112
    v_add_f32 v65, v97, v113
    v_add_f32 v66, v98, v114
    v_add_f32 v67, v99, v115
    v_add_f32 v68, v100, v116
    v_mfma_f32_32x32x16_bf16 v[208:223], v[236:239], a[120:123], v[208:223]
    v_add_f32 v69, v101, v117
    v_add_f32 v70, v102, v118
    v_add_f32 v71, v103, v119
    s_waitcnt vmcnt(13)
    v_mfma_f32_32x32x16_bf16 v[192:207], v[240:243], a[124:127], v[192:207]
    ds_bpermute_b32 v40, v93, v90 offset:0
    ds_read_b128 v[4:7], v56 offset:8192
    v_mfma_f32_32x32x16_bf16 v[208:223], v[244:247], a[124:127], v[208:223]
    s_waitcnt vmcnt(12)
    v_mfma_f32_32x32x16_bf16 v[192:207], v[248:251], a[128:131], v[192:207]
    v_mfma_f32_32x32x16_bf16 v[208:223], v[252:255], a[128:131], v[208:223]
    s_waitcnt vmcnt(11)
    v_mfma_f32_32x32x16_bf16 v[192:207], v[160:163], a[132:135], v[192:207]
    v_mfma_f32_32x32x16_bf16 v[208:223], v[164:167], a[132:135], v[208:223]
    s_waitcnt lgkmcnt(1)
    v_and_b32 v33, s60, v40
    v_rcp_f32 v33, v33
    s_waitcnt vmcnt(10)
    v_mfma_f32_32x32x16_bf16 v[192:207], v[168:171], a[136:139], v[192:207]
    v_lshlrev_b32 v34, 16, v40
    v_mul_f32 v34, v34, v33
    v_mul_f32 v35, v33, v33
    s_waitcnt lgkmcnt(0)
    v_lshlrev_b32 v144, 16, v4
    v_mfma_f32_32x32x16_bf16 v[208:223], v[172:175], a[136:139], v[208:223]
    v_and_b32 v145, s60, v4
    v_lshlrev_b32 v146, 16, v5
    v_and_b32 v147, s60, v5
    v_lshlrev_b32 v148, 16, v6
    s_waitcnt vmcnt(9)
    v_mfma_f32_32x32x16_bf16 v[192:207], v[176:179], a[140:143], v[192:207]
    v_and_b32 v149, s60, v6
    v_lshlrev_b32 v150, 16, v7
    v_and_b32 v151, s60, v7
    v_fma_f32 v64, v64, v35, v144
    v_fma_f32 v65, v65, v35, v145
    v_mfma_f32_32x32x16_bf16 v[208:223], v[180:183], a[140:143], v[208:223]
    v_fma_f32 v66, v66, v35, v146
    v_fma_f32 v67, v67, v35, v147
    v_fma_f32 v68, v68, v35, v148
    v_fma_f32 v69, v69, v35, v149
    s_waitcnt vmcnt(8)
    v_mfma_f32_32x32x16_bf16 v[192:207], v[184:187], a[144:147], v[192:207]
    v_fma_f32 v70, v70, v35, v150
    v_fma_f32 v71, v71, v35, v151
    v_fma_f32 v144, v144, v33, v34
    v_fma_f32 v145, v145, v33, v34
    v_fma_f32 v146, v146, v33, v34
    v_mfma_f32_32x32x16_bf16 v[208:223], v[188:191], a[144:147], v[208:223]
    v_fma_f32 v147, v147, v33, v34
    v_fma_f32 v148, v148, v33, v34
    v_fma_f32 v149, v149, v33, v34
    v_fma_f32 v150, v150, v33, v34
    s_waitcnt vmcnt(7)
    v_mfma_f32_32x32x16_bf16 v[192:207], a[0:3], a[148:151], v[192:207]
    s_waitcnt vmcnt(0)
    v_cmp_ne_u32 s[66:67], s3, v32
    v_fma_f32 v151, v151, v33, v34
    v_mfma_f32_32x32x16_bf16 v[208:223], a[4:7], a[148:151], v[208:223]
    buffer_load_dwordx4 v[72:75], v59, s[44:47], 0 offen offset:0 sc1
    buffer_load_dwordx4 v[76:79], v59, s[44:47], s68 offen offset:0 sc1
    v_mfma_f32_32x32x16_bf16 v[192:207], a[8:11], a[152:155], v[192:207]
    buffer_load_dwordx4 v[80:83], v59, s[44:47], 0 offen offset:1024 sc1
    buffer_load_dwordx4 v[84:87], v59, s[44:47], s68 offen offset:1024 sc1
    v_mfma_f32_32x32x16_bf16 v[208:223], a[12:15], a[152:155], v[208:223]
    ds_bpermute_b32 v40, v93, v90 offset:128
    ds_read_b128 v[4:7], v56 offset:12288
    v_mfma_f32_32x32x16_bf16 v[192:207], a[16:19], a[156:159], v[192:207]
    v_mfma_f32_32x32x16_bf16 v[208:223], a[20:23], a[156:159], v[208:223]
    v_mfma_f32_32x32x16_bf16 v[192:207], a[24:27], a[56:59], v[192:207]
    v_mfma_f32_32x32x16_bf16 v[192:207], a[32:35], a[60:63], v[192:207]
    v_mfma_f32_32x32x16_bf16 v[192:207], a[40:43], a[64:67], v[192:207]
    s_waitcnt lgkmcnt(1)
    v_and_b32 v33, s60, v40
    v_rcp_f32 v33, v33
    v_lshlrev_b32 v34, 16, v40
    v_mfma_f32_32x32x16_bf16 v[192:207], a[48:51], a[68:71], v[192:207]
    v_mul_f32 v34, v34, v33
    v_mul_f32 v35, v33, v33
    s_waitcnt lgkmcnt(0)
    v_lshlrev_b32 v26, 16, v4
    v_and_b32 v27, s60, v4
    v_mfma_f32_32x32x16_bf16 v[208:223], a[28:31], a[56:59], v[208:223]
    v_lshlrev_b32 v28, 16, v5
    v_and_b32 v29, s60, v5
    v_lshlrev_b32 v36, 16, v6
    v_and_b32 v37, s60, v6
    v_lshlrev_b32 v38, 16, v7
    v_mfma_f32_32x32x16_bf16 v[208:223], a[36:39], a[60:63], v[208:223]
    ds_write_b128 v19, v[192:195] offset:24576
    v_mfma_f32_32x32x16_bf16 v[208:223], a[44:47], a[64:67], v[208:223]
    ds_write_b128 v19, v[196:199] offset:25600
    v_mfma_f32_32x32x16_bf16 v[208:223], a[52:55], a[68:71], v[208:223]
    ds_write_b128 v20, v[200:203] offset:24576
    ds_write_b128 v20, v[204:207] offset:25600
    s_nop 9
    ds_write_b128 v21, v[208:211] offset:24576
    ds_write_b128 v21, v[212:215] offset:25600
    v_and_b32 v39, s60, v7
    v_fma_f32 v152, v26, v33, v34
    v_fma_f32 v153, v27, v33, v34
    v_fma_f32 v154, v28, v33, v34
    v_fma_f32 v155, v29, v33, v34
    v_fma_f32 v156, v36, v33, v34
    v_fma_f32 v157, v37, v33, v34
    v_fma_f32 v158, v38, v33, v34
    v_fma_f32 v159, v39, v33, v34
    s_cmp_lg_u64 s[66:67], 0
    s_cbranch_scc1 SLOWY
BACKY:
    s_waitcnt vmcnt(3)
    v_lshlrev_b32 v4, 16, v72
    v_lshlrev_b32 v5, 16, v73
    v_lshlrev_b32 v6, 16, v74
    v_lshlrev_b32 v7, 16, v75
    v_pk_fma_f32 v[44:45], v[128:129], v[4:5], v[44:45]
    v_pk_fma_f32 v[46:47], v[130:131], v[6:7], v[46:47]
    s_waitcnt vmcnt(2)
    v_lshlrev_b32 v4, 16, v76
    v_lshlrev_b32 v5, 16, v77
    v_lshlrev_b32 v6, 16, v78
    v_lshlrev_b32 v7, 16, v79
    v_pk_fma_f32 v[48:49], v[132:133], v[4:5], v[48:49]
    v_pk_fma_f32 v[50:51], v[134:135], v[6:7], v[50:51]
    v_cvt_pk_bf16_f32 v128, v44, v45
    v_cvt_pk_bf16_f32 v129, v46, v47
    v_cvt_pk_bf16_f32 v130, v48, v49
    v_cvt_pk_bf16_f32 v131, v50, v51
    v_and_b32 v4, s60, v72
    v_and_b32 v5, s60, v73
    v_and_b32 v6, s60, v74
    v_and_b32 v7, s60, v75
    v_pk_fma_f32 v[52:53], v[136:137], v[4:5], v[52:53]
    v_pk_fma_f32 v[54:55], v[138:139], v[6:7], v[54:55]
    v_and_b32 v4, s60, v76
    v_and_b32 v5, s60, v77
    v_and_b32 v6, s60, v78
    v_and_b32 v7, s60, v79
    v_pk_fma_f32 v[60:61], v[140:141], v[4:5], v[60:61]
    v_pk_fma_f32 v[62:63], v[142:143], v[6:7], v[62:63]
    v_cvt_pk_bf16_f32 v136, v52, v53
    v_cvt_pk_bf16_f32 v137, v54, v55
    v_cvt_pk_bf16_f32 v138, v60, v61
    v_cvt_pk_bf16_f32 v139, v62, v63
    s_waitcnt vmcnt(1)
    v_lshlrev_b32 v4, 16, v80
    v_lshlrev_b32 v5, 16, v81
    v_lshlrev_b32 v6, 16, v82
    v_lshlrev_b32 v7, 16, v83
    v_pk_fma_f32 v[64:65], v[144:145], v[4:5], v[64:65]
    v_pk_fma_f32 v[66:67], v[146:147], v[6:7], v[66:67]
    s_waitcnt vmcnt(0)
    v_lshlrev_b32 v4, 16, v84
    v_lshlrev_b32 v5, 16, v85
    v_lshlrev_b32 v6, 16, v86
    v_lshlrev_b32 v7, 16, v87
    v_pk_fma_f32 v[68:69], v[148:149], v[4:5], v[68:69]
    v_pk_fma_f32 v[70:71], v[150:151], v[6:7], v[70:71]
    v_cvt_pk_bf16_f32 v144, v64, v65
    v_cvt_pk_bf16_f32 v145, v66, v67
    v_cvt_pk_bf16_f32 v146, v68, v69
    v_cvt_pk_bf16_f32 v147, v70, v71
    ds_write_b128 v56, v[128:131] offset:0
    ds_write_b128 v56, v[136:139] offset:4096
    ds_write_b128 v56, v[144:147] offset:8192
    v_and_b32 v4, s60, v80
    v_and_b32 v5, s60, v81
    v_and_b32 v6, s60, v82
    v_and_b32 v7, s60, v83
    v_pk_fma_f32 v[26:27], v[152:153], v[4:5], v[26:27]
    v_pk_fma_f32 v[28:29], v[154:155], v[6:7], v[28:29]
    v_and_b32 v4, s60, v84
    v_and_b32 v5, s60, v85
    v_and_b32 v6, s60, v86
    v_and_b32 v7, s60, v87
    v_pk_fma_f32 v[36:37], v[156:157], v[4:5], v[36:37]
    v_pk_fma_f32 v[38:39], v[158:159], v[6:7], v[38:39]
    s_waitcnt lgkmcnt(0)
    s_barrier
    ds_read_b128 v[192:195], v22 offset:24576
    ds_read_b128 v[196:199], v22 offset:25600
    ds_read_b128 v[200:203], v22 offset:26624
    ds_read_b128 v[204:207], v22 offset:27648
    ds_read_b128 v[208:211], v22 offset:28672
    ds_read_b128 v[212:215], v22 offset:29696
    ds_read_b128 v[160:163], v30 offset:0
    ds_read_b128 v[164:167], v30 offset:4096
    ds_read_b128 v[168:171], v30 offset:8192
    s_waitcnt lgkmcnt(6)
    v_pk_add_f32 v[192:193], v[192:193], v[200:201]
    s_waitcnt lgkmcnt(4)
    v_pk_add_f32 v[208:209], v[208:209], v[216:217]
    v_pk_add_f32 v[194:195], v[194:195], v[202:203]
    v_pk_add_f32 v[210:211], v[210:211], v[218:219]
    v_pk_add_f32 v[196:197], v[196:197], v[204:205]
    s_waitcnt lgkmcnt(3)
    v_pk_add_f32 v[212:213], v[212:213], v[220:221]
    v_pk_add_f32 v[198:199], v[198:199], v[206:207]
    v_pk_add_f32 v[214:215], v[214:215], v[222:223]
    v_mov_b32 v34, v35
    v_pk_add_f32 v[192:193], v[192:193], v[208:209]
    v_pk_add_f32 v[194:195], v[194:195], v[210:211]
    v_pk_add_f32 v[196:197], v[196:197], v[212:213]
    v_pk_add_f32 v[198:199], v[198:199], v[214:215]
    v_pk_fma_f32 v[26:27], v[192:193], v[34:35], v[26:27]
    v_pk_fma_f32 v[28:29], v[194:195], v[34:35], v[28:29]
    v_pk_fma_f32 v[36:37], v[196:197], v[34:35], v[36:37]
    v_pk_fma_f32 v[38:39], v[198:199], v[34:35], v[38:39]
    v_cvt_pk_bf16_f32 v152, v26, v27
    v_cvt_pk_bf16_f32 v153, v28, v29
    v_cvt_pk_bf16_f32 v154, v36, v37
    v_cvt_pk_bf16_f32 v155, v38, v39
    ds_write_b128 v56, v[152:155] offset:12288
    s_waitcnt lgkmcnt(3)
    buffer_store_dwordx4 v[160:163], v57, s[48:51], 0 offen sc1
    s_waitcnt lgkmcnt(2)
    buffer_store_dwordx4 v[164:167], v57, s[48:51], s69 offen sc1
    s_waitcnt lgkmcnt(1)
    buffer_store_dwordx4 v[168:171], v57, s[48:51], s70 offen sc1
    s_waitcnt lgkmcnt(0)
    s_barrier
    ds_read_b128 v[172:175], v30 offset:12288
    s_waitcnt lgkmcnt(0)
    buffer_store_dwordx4 v[172:175], v57, s[48:51], s71 offen sc1
END:
    s_endpgm
ROLEB:
CHG2:
PAD4:
    s_cbranch_execz PAD5
    s_waitcnt lgkmcnt(1)
    v_mfma_f32_32x32x16_bf16 v[192:207], a[0:3], v[96:99], 0
    ds_read_b128 v[112:115], v37 offset:33792
    ds_read_b128 v[116:119], v38 offset:33792
    ds_read_b128 v[120:123], v39 offset:33792
    s_add_u32 m0, s57, 0
    v_add_u32 v18, 40960, v18
    v_add_u32 v19, 40960, v19
    v_mfma_f32_32x32x16_bf16 v[192:207], a[4:7], v[100:103], v[192:207]
    ds_read_b128 v[124:127], v40 offset:33792
    v_cvt_pk_bf16_f32 v52, v48, v48
    v_lshlrev_b32 v52, 16, v52
    v_sub_f32 v52, v48, v52
    v_cvt_pk_bf16_f32 v52, v48, v52
    v_mov_b32 v51, 0
    v_mfma_f32_32x32x16_bf16 v[192:207], a[8:11], v[104:107], v[192:207]
    ds_read_b128 v[96:99], v37 offset:34816
    v_add_u32 v20, 40960, v20
    v_add_u32 v21, 40960, v21
    s_waitcnt lgkmcnt(3)
    v_mfma_f32_32x32x16_bf16 v[192:207], a[12:15], v[108:111], v[192:207]
    ds_read_b128 v[100:103], v38 offset:34816
    buffer_load_dwordx4 v18, s[36:39], s62 offen offset:0  lds
    buffer_load_dwordx4 v19, s[36:39], s63 offen offset:1024  lds
    v_perm_b32 v50, v60, v60, s59
    v_mfma_f32_32x32x16_bf16 v[192:207], a[16:19], v[112:115], v[192:207]
    ds_read_b128 v[104:107], v39 offset:34816
    v_mfma_f32_32x32x16_bf16 v[128:143], v[52:55], v[50:53], v[128:143]
    buffer_load_dwordx4 v20, s[36:39], s64 offen offset:2048  lds
    buffer_load_dwordx4 v21, s[36:39], s65 offen offset:3072  lds
    s_add_u32 m0, s57, 4096
    v_perm_b32 v50, v62, v62, s59
    v_mfma_f32_32x32x16_bf16 v[192:207], a[20:23], v[116:119], v[192:207]
    ds_read_b128 v[108:111], v40 offset:34816
    buffer_load_dwordx4 v18, s[36:39], s66 offen offset:0  lds
    v_mfma_f32_32x32x16_bf16 v[144:159], v[52:55], v[50:53], v[144:159]
    v_perm_b32 v50, v64, v64, s59
    s_waitcnt lgkmcnt(3)
    v_mfma_f32_32x32x16_bf16 v[192:207], a[24:27], v[120:123], v[192:207]
    ds_read_b128 v[112:115], v37 offset:35840
    buffer_load_dwordx4 v19, s[36:39], s67 offen offset:1024  lds
    buffer_load_dwordx4 v20, s[36:39], s68 offen offset:2048  lds
    v_mul_f32 v76, v128, v61
    v_mfma_f32_32x32x16_bf16 v[160:175], v[52:55], v[50:53], v[160:175]
    v_perm_b32 v50, v66, v66, s59
    v_mul_f32 v77, v129, v61
    v_mul_f32 v78, v130, v61
    v_mul_f32 v79, v131, v61
    v_exp_f32 v76, v76
    v_mfma_f32_32x32x16_bf16 v[192:207], a[28:31], v[124:127], v[192:207]
    ds_read_b128 v[116:119], v38 offset:35840
    buffer_load_dwordx4 v21, s[36:39], s69 offen offset:3072  lds
    s_add_u32 m0, s57, 32768
    v_exp_f32 v77, v77
    v_mfma_f32_32x32x16_bf16 v[176:191], v[52:55], v[50:53], v[176:191]
    v_exp_f32 v78, v78
    v_exp_f32 v79, v79
    v_mul_f32 v136, v128, v136
    v_mul_f32 v137, v129, v137
    v_mfma_f32_32x32x16_bf16 v[192:207], a[32:35], v[96:99], v[192:207]
    ds_read_b128 v[120:123], v39 offset:35840
    v_mul_f32 v138, v130, v138
    v_mul_f32 v139, v131, v139
    v_add_f32 v76, 1.0, v76
    v_add_f32 v77, 1.0, v77
    s_waitcnt lgkmcnt(3)
    v_mfma_f32_32x32x16_bf16 v[192:207], a[36:39], v[100:103], v[192:207]
    ds_read_b128 v[124:127], v40 offset:35840
    v_add_f32 v78, 1.0, v78
    v_add_f32 v79, 1.0, v79
    v_rcp_f32 v76, v76
    v_mfma_f32_32x32x16_bf16 v[192:207], a[40:43], v[104:107], v[192:207]
    ds_read_b128 v[96:99], v37 offset:36864
    v_rcp_f32 v77, v77
    v_rcp_f32 v78, v78
    v_mfma_f32_32x32x16_bf16 v[192:207], a[44:47], v[108:111], v[192:207]
    ds_read_b128 v[100:103], v38 offset:36864
    v_rcp_f32 v79, v79
    v_mul_f32 v136, v136, v76
    v_mul_f32 v137, v137, v77
    s_waitcnt lgkmcnt(3)
    v_mfma_f32_32x32x16_bf16 v[192:207], a[48:51], v[112:115], v[192:207]
    ds_read_b128 v[104:107], v39 offset:36864
    v_mul_f32 v138, v138, v78
    v_mul_f32 v139, v139, v79
    v_cvt_pk_bf16_f32 v84, v136, v137
    v_cvt_pk_bf16_f32 v85, v138, v139
    v_mul_f32 v80, v132, v61
    v_mfma_f32_32x32x16_bf16 v[192:207], a[52:55], v[116:119], v[192:207]
    ds_read_b128 v[108:111], v40 offset:36864
    v_mul_f32 v81, v133, v61
    v_mul_f32 v82, v134, v61
    v_mul_f32 v83, v135, v61
    v_exp_f32 v80, v80
    v_mfma_f32_32x32x16_bf16 v[192:207], a[56:59], v[120:123], v[192:207]
    ds_read_b128 v[112:115], v37 offset:37888
    v_exp_f32 v81, v81
    v_exp_f32 v82, v82
    s_waitcnt lgkmcnt(3)
    v_mfma_f32_32x32x16_bf16 v[192:207], a[60:63], v[124:127], v[192:207]
    ds_read_b128 v[116:119], v38 offset:37888
    v_exp_f32 v83, v83
    v_mul_f32 v140, v132, v140
    v_mul_f32 v141, v133, v141
    v_mul_f32 v142, v134, v142
    v_mfma_f32_32x32x16_bf16 v[192:207], a[64:67], v[96:99], v[192:207]
    ds_read_b128 v[120:123], v39 offset:37888
    v_mul_f32 v143, v135, v143
    v_add_f32 v80, 1.0, v80
    v_add_f32 v81, 1.0, v81
    v_add_f32 v82, 1.0, v82
    v_add_f32 v83, 1.0, v83
    v_mfma_f32_32x32x16_bf16 v[192:207], a[68:71], v[100:103], v[192:207]
    ds_read_b128 v[124:127], v40 offset:37888
    v_rcp_f32 v80, v80
    v_rcp_f32 v81, v81
    s_waitcnt lgkmcnt(3)
    v_mfma_f32_32x32x16_bf16 v[192:207], a[72:75], v[104:107], v[192:207]
    ds_read_b128 v[96:99], v37 offset:38912
    v_rcp_f32 v82, v82
    v_rcp_f32 v83, v83
    v_mul_f32 v140, v140, v80
    v_mfma_f32_32x32x16_bf16 v[192:207], a[76:79], v[108:111], v[192:207]
    ds_read_b128 v[100:103], v38 offset:38912
    v_mul_f32 v141, v141, v81
    v_mul_f32 v142, v142, v82
    v_mul_f32 v143, v143, v83
    v_cvt_pk_bf16_f32 v86, v140, v141
    v_cvt_pk_bf16_f32 v87, v142, v143
    v_mfma_f32_32x32x16_bf16 v[192:207], a[80:83], v[112:115], v[192:207]
    ds_read_b128 v[104:107], v39 offset:38912
    v_mul_f32 v76, v144, v63
    v_mul_f32 v77, v145, v63
    v_mul_f32 v78, v146, v63
    v_mul_f32 v79, v147, v63
    s_waitcnt lgkmcnt(3)
    v_mfma_f32_32x32x16_bf16 v[192:207], a[84:87], v[116:119], v[192:207]
    ds_read_b128 v[108:111], v40 offset:38912
    v_exp_f32 v76, v76
    v_exp_f32 v77, v77
    v_mfma_f32_32x32x16_bf16 v[192:207], a[88:91], v[120:123], v[192:207]
    ds_read_b128 v[112:115], v37 offset:39936
    v_exp_f32 v78, v78
    v_exp_f32 v79, v79
    v_mul_f32 v152, v144, v152
    v_mfma_f32_32x32x16_bf16 v[192:207], a[92:95], v[124:127], v[192:207]
    ds_read_b128 v[116:119], v38 offset:39936
    v_mul_f32 v153, v145, v153
    v_mul_f32 v154, v146, v154
    v_mul_f32 v155, v147, v155
    v_add_f32 v76, 1.0, v76
    s_waitcnt lgkmcnt(3)
    v_mfma_f32_32x32x16_bf16 v[192:207], a[96:99], v[96:99], v[192:207]
    ds_read_b128 v[120:123], v39 offset:39936
    v_add_f32 v77, 1.0, v77
    v_add_f32 v78, 1.0, v78
    v_add_f32 v79, 1.0, v79
    v_rcp_f32 v76, v76
    v_mfma_f32_32x32x16_bf16 v[192:207], a[100:103], v[100:103], v[192:207]
    ds_read_b128 v[124:127], v40 offset:39936
    v_rcp_f32 v77, v77
    v_rcp_f32 v78, v78
    v_mfma_f32_32x32x16_bf16 v[192:207], a[104:107], v[104:107], v[192:207]
    s_waitcnt vmcnt(8)
    s_barrier
    ds_read_b128 v[96:99], v33 offset:0
    s_waitcnt lgkmcnt(3)
    v_mfma_f32_32x32x16_bf16 v[192:207], a[108:111], v[108:111], v[192:207]
    ds_read_b128 v[100:103], v34 offset:0
    v_rcp_f32 v79, v79
    v_mul_f32 v152, v152, v76
    v_mul_f32 v153, v153, v77
    v_mul_f32 v154, v154, v78
    v_mfma_f32_32x32x16_bf16 v[192:207], a[112:115], v[112:115], v[192:207]
    ds_read_b128 v[104:107], v35 offset:0
    v_mul_f32 v155, v155, v79
    v_cvt_pk_bf16_f32 v88, v152, v153
    v_cvt_pk_bf16_f32 v89, v154, v155
    v_mul_f32 v80, v148, v63
    v_mul_f32 v81, v149, v63
    v_mfma_f32_32x32x16_bf16 v[192:207], a[116:119], v[116:119], v[192:207]
    ds_read_b128 v[108:111], v36 offset:0
    v_add_u32 v18, 40960, v18
    v_add_u32 v19, 40960, v19
    v_add_u32 v20, 40960, v20
    v_add_u32 v21, 40960, v21
    s_waitcnt lgkmcnt(3)
    v_mfma_f32_32x32x16_bf16 v[192:207], a[120:123], v[120:123], v[192:207]
    ds_read_b128 v[112:115], v33 offset:1024
    v_mul_f32 v82, v150, v63
    v_mul_f32 v83, v151, v63
    v_exp_f32 v80, v80
    v_mfma_f32_32x32x16_bf16 v[192:207], a[124:127], v[124:127], v[192:207]
    ds_read_b128 v[116:119], v34 offset:1024
    v_exp_f32 v81, v81
    v_exp_f32 v82, v82
    v_mfma_f32_32x32x16_bf16 v[192:207], a[128:131], v[96:99], v[192:207]
    ds_read_b128 v[120:123], v35 offset:1024
    v_exp_f32 v83, v83
    v_mul_f32 v156, v148, v156
    v_mul_f32 v157, v149, v157
    s_waitcnt lgkmcnt(3)
    v_mfma_f32_32x32x16_bf16 v[192:207], a[132:135], v[100:103], v[192:207]
    ds_read_b128 v[124:127], v36 offset:1024
    v_mul_f32 v158, v150, v158
    v_mul_f32 v159, v151, v159
    v_add_f32 v80, 1.0, v80
    v_add_f32 v81, 1.0, v81
    v_add_f32 v82, 1.0, v82
    v_mfma_f32_32x32x16_bf16 v[192:207], a[136:139], v[104:107], v[192:207]
    s_waitcnt vmcnt(0)
    s_barrier
    ds_read_b128 v[96:99], v37 offset:0
    v_add_f32 v83, 1.0, v83
    v_mfma_f32_32x32x16_bf16 v[192:207], a[140:143], v[108:111], v[192:207]
    ds_read_b128 v[100:103], v38 offset:0
    buffer_load_dwordx4 v18, s[36:39], s62 offen offset:0  lds
    buffer_load_dwordx4 v19, s[36:39], s63 offen offset:1024  lds
    s_waitcnt lgkmcnt(3)
    v_mfma_f32_32x32x16_bf16 v[192:207], a[144:147], v[112:115], v[192:207]
    ds_read_b128 v[104:107], v39 offset:0
    v_rcp_f32 v80, v80
    v_rcp_f32 v81, v81
    v_mfma_f32_32x32x16_bf16 v[192:207], a[148:151], v[116:119], v[192:207]
    ds_read_b128 v[108:111], v40 offset:0
    buffer_load_dwordx4 v20, s[36:39], s64 offen offset:2048  lds
    buffer_load_dwordx4 v21, s[36:39], s65 offen offset:3072  lds
    s_add_u32 m0, s57, 36864
    v_mfma_f32_32x32x16_bf16 v[192:207], a[152:155], v[120:123], v[192:207]
    ds_read_b128 v[112:115], v37 offset:1024
    v_perm_b32 v50, v68, v68, s59
    v_rcp_f32 v82, v82
    s_waitcnt lgkmcnt(3)
    v_mfma_f32_32x32x16_bf16 v[192:207], a[156:159], v[124:127], v[192:207]
    ds_read_b128 v[116:119], v38 offset:1024
    buffer_load_dwordx4 v18, s[36:39], s66 offen offset:0  lds
    buffer_load_dwordx4 v19, s[36:39], s67 offen offset:1024  lds
    v_mfma_f32_32x32x16_bf16 v[192:207], v[52:55], v[50:53], v[192:207]
    v_rcp_f32 v83, v83
    v_mul_f32 v156, v156, v80
    v_mul_f32 v157, v157, v81
    v_mul_f32 v158, v158, v82
    v_mul_f32 v159, v159, v83
    v_mfma_f32_32x32x16_bf16 v[208:223], a[0:3], v[96:99], 0
    ds_read_b128 v[120:123], v39 offset:1024
    buffer_load_dwordx4 v20, s[36:39], s68 offen offset:2048  lds
    buffer_load_dwordx4 v21, s[36:39], s69 offen offset:3072  lds
    s_add_u32 m0, s57, 0
    v_mfma_f32_32x32x16_bf16 v[208:223], a[4:7], v[100:103], v[208:223]
    ds_read_b128 v[124:127], v40 offset:1024
    v_cvt_pk_bf16_f32 v90, v156, v157
    v_cvt_pk_bf16_f32 v91, v158, v159
    s_waitcnt lgkmcnt(3)
    v_mfma_f32_32x32x16_bf16 v[208:223], a[8:11], v[104:107], v[208:223]
    ds_read_b128 v[96:99], v37 offset:2048
    s_add_u32 s54, s58, 0
    buffer_store_dwordx4 v[84:87], v41, s[44:47], s54 offen sc1
    v_mfma_f32_32x32x16_bf16 v[208:223], a[12:15], v[108:111], v[208:223]
    ds_read_b128 v[100:103], v38 offset:2048
    s_add_u32 s54, s58, 110592
    buffer_store_dwordx4 v[88:91], v41, s[44:47], s54 offen sc1
    v_mfma_f32_32x32x16_bf16 v[208:223], a[16:19], v[112:115], v[208:223]
    ds_read_b128 v[104:107], v39 offset:2048
    v_mul_f32 v76, v160, v65
    v_mul_f32 v77, v161, v65
    v_mul_f32 v78, v162, v65
    v_mul_f32 v79, v163, v65
    s_waitcnt lgkmcnt(3)
    v_mfma_f32_32x32x16_bf16 v[208:223], a[20:23], v[116:119], v[208:223]
    ds_read_b128 v[108:111], v40 offset:2048
    v_exp_f32 v76, v76
    v_exp_f32 v77, v77
    v_mfma_f32_32x32x16_bf16 v[208:223], a[24:27], v[120:123], v[208:223]
    ds_read_b128 v[112:115], v37 offset:3072
    v_exp_f32 v78, v78
    v_exp_f32 v79, v79
    v_mul_f32 v168, v160, v168
    v_mfma_f32_32x32x16_bf16 v[208:223], a[28:31], v[124:127], v[208:223]
    ds_read_b128 v[116:119], v38 offset:3072
    v_mul_f32 v169, v161, v169
    v_mul_f32 v170, v162, v170
    v_mul_f32 v171, v163, v171
    v_add_f32 v76, 1.0, v76
    s_waitcnt lgkmcnt(3)
    v_mfma_f32_32x32x16_bf16 v[208:223], a[32:35], v[96:99], v[208:223]
    ds_read_b128 v[120:123], v39 offset:3072
    v_add_f32 v77, 1.0, v77
    v_add_f32 v78, 1.0, v78
    v_add_f32 v79, 1.0, v79
    v_rcp_f32 v76, v76
    v_mfma_f32_32x32x16_bf16 v[208:223], a[36:39], v[100:103], v[208:223]
    ds_read_b128 v[124:127], v40 offset:3072
    v_rcp_f32 v77, v77
    v_rcp_f32 v78, v78
    v_mfma_f32_32x32x16_bf16 v[208:223], a[40:43], v[104:107], v[208:223]
    ds_read_b128 v[96:99], v37 offset:4096
    v_rcp_f32 v79, v79
    v_mul_f32 v168, v168, v76
    v_mul_f32 v169, v169, v77
    s_waitcnt lgkmcnt(3)
    v_mfma_f32_32x32x16_bf16 v[208:223], a[44:47], v[108:111], v[208:223]
    ds_read_b128 v[100:103], v38 offset:4096
    v_mul_f32 v170, v170, v78
    v_mul_f32 v171, v171, v79
    v_cvt_pk_bf16_f32 v84, v168, v169
    v_cvt_pk_bf16_f32 v85, v170, v171
    v_mul_f32 v80, v164, v65
    v_mfma_f32_32x32x16_bf16 v[208:223], a[48:51], v[112:115], v[208:223]
    ds_read_b128 v[104:107], v39 offset:4096
    v_mul_f32 v81, v165, v65
    v_mul_f32 v82, v166, v65
    v_mul_f32 v83, v167, v65
    v_exp_f32 v80, v80
    v_mfma_f32_32x32x16_bf16 v[208:223], a[52:55], v[116:119], v[208:223]
    ds_read_b128 v[108:111], v40 offset:4096
    v_exp_f32 v81, v81
    v_exp_f32 v82, v82
    s_waitcnt lgkmcnt(3)
    v_mfma_f32_32x32x16_bf16 v[208:223], a[56:59], v[120:123], v[208:223]
    ds_read_b128 v[112:115], v37 offset:5120
    v_exp_f32 v83, v83
    v_mul_f32 v172, v164, v172
    v_mul_f32 v173, v165, v173
    v_mul_f32 v174, v166, v174
    v_mfma_f32_32x32x16_bf16 v[208:223], a[60:63], v[124:127], v[208:223]
    ds_read_b128 v[116:119], v38 offset:5120
    v_mul_f32 v175, v167, v175
    v_add_f32 v80, 1.0, v80
    v_add_f32 v81, 1.0, v81
    v_add_f32 v82, 1.0, v82
    v_add_f32 v83, 1.0, v83
    v_mfma_f32_32x32x16_bf16 v[208:223], a[64:67], v[96:99], v[208:223]
    ds_read_b128 v[120:123], v39 offset:5120
    v_rcp_f32 v80, v80
    v_rcp_f32 v81, v81
    s_waitcnt lgkmcnt(3)
    v_mfma_f32_32x32x16_bf16 v[208:223], a[68:71], v[100:103], v[208:223]
    ds_read_b128 v[124:127], v40 offset:5120
    v_rcp_f32 v82, v82
    v_rcp_f32 v83, v83
    v_mul_f32 v172, v172, v80
    v_mfma_f32_32x32x16_bf16 v[208:223], a[72:75], v[104:107], v[208:223]
    ds_read_b128 v[96:99], v37 offset:6144
    v_mul_f32 v173, v173, v81
    v_mul_f32 v174, v174, v82
    v_mul_f32 v175, v175, v83
    v_cvt_pk_bf16_f32 v86, v172, v173
    v_cvt_pk_bf16_f32 v87, v174, v175
    v_mfma_f32_32x32x16_bf16 v[208:223], a[76:79], v[108:111], v[208:223]
    ds_read_b128 v[100:103], v38 offset:6144
    v_mul_f32 v76, v176, v67
    v_mul_f32 v77, v177, v67
    v_mul_f32 v78, v178, v67
    v_mul_f32 v79, v179, v67
    s_waitcnt lgkmcnt(3)
    v_mfma_f32_32x32x16_bf16 v[208:223], a[80:83], v[112:115], v[208:223]
    ds_read_b128 v[104:107], v39 offset:6144
    v_exp_f32 v76, v76
    v_exp_f32 v77, v77
    v_mfma_f32_32x32x16_bf16 v[208:223], a[84:87], v[116:119], v[208:223]
    ds_read_b128 v[108:111], v40 offset:6144
    v_exp_f32 v78, v78
    v_exp_f32 v79, v79
    v_mul_f32 v184, v176, v184
    v_mfma_f32_32x32x16_bf16 v[208:223], a[88:91], v[120:123], v[208:223]
    ds_read_b128 v[112:115], v37 offset:7168
    v_mul_f32 v185, v177, v185
    v_mul_f32 v186, v178, v186
    v_mul_f32 v187, v179, v187
    v_add_f32 v76, 1.0, v76
    s_waitcnt lgkmcnt(3)
    v_mfma_f32_32x32x16_bf16 v[208:223], a[92:95], v[124:127], v[208:223]
    ds_read_b128 v[116:119], v38 offset:7168
    v_add_f32 v77, 1.0, v77
    v_add_f32 v78, 1.0, v78
    v_add_f32 v79, 1.0, v79
    v_rcp_f32 v76, v76
    v_mfma_f32_32x32x16_bf16 v[208:223], a[96:99], v[96:99], v[208:223]
    ds_read_b128 v[120:123], v39 offset:7168
    v_rcp_f32 v77, v77
    v_rcp_f32 v78, v78
    v_mfma_f32_32x32x16_bf16 v[208:223], a[100:103], v[100:103], v[208:223]
    ds_read_b128 v[124:127], v40 offset:7168
    v_rcp_f32 v79, v79
    v_mul_f32 v184, v184, v76
    v_mul_f32 v185, v185, v77
    s_waitcnt lgkmcnt(3)
    v_mfma_f32_32x32x16_bf16 v[208:223], a[104:107], v[104:107], v[208:223]
    ds_read_b128 v[96:99], v33 offset:2048
    v_mul_f32 v186, v186, v78
    v_mul_f32 v187, v187, v79
    v_cvt_pk_bf16_f32 v88, v184, v185
    v_cvt_pk_bf16_f32 v89, v186, v187
    v_mul_f32 v80, v180, v67
PAD5:
    s_cbranch_execz WRETG
    v_mfma_f32_32x32x16_bf16 v[208:223], a[108:111], v[108:111], v[208:223]
    ds_read_b128 v[100:103], v34 offset:2048
    v_mul_f32 v81, v181, v67
    v_mul_f32 v82, v182, v67
    v_mul_f32 v83, v183, v67
    v_exp_f32 v80, v80
    v_mfma_f32_32x32x16_bf16 v[208:223], a[112:115], v[112:115], v[208:223]
    ds_read_b128 v[104:107], v35 offset:2048
    v_exp_f32 v81, v81
    v_exp_f32 v82, v82
    s_waitcnt lgkmcnt(3)
    v_mfma_f32_32x32x16_bf16 v[208:223], a[116:119], v[116:119], v[208:223]
    ds_read_b128 v[108:111], v36 offset:2048
    s_waitcnt vmcnt(0)
    buffer_store_dword v8, v9, s[44:47], s78 offen offset:0 sc1
    s_add_u32 s78, s78, 8192
    v_mfma_f32_32x32x16_bf16 v[208:223], a[120:123], v[120:123], v[208:223]
    ds_read_b128 v[112:115], v33 offset:3072
    v_add_u32 v18, 40960, v18
    v_add_u32 v19, 40960, v19
    v_add_u32 v20, 40960, v20
    v_add_u32 v21, 40960, v21
    v_mfma_f32_32x32x16_bf16 v[208:223], a[124:127], v[124:127], v[208:223]
    ds_read_b128 v[116:119], v34 offset:3072
    v_exp_f32 v83, v83
    v_mul_f32 v188, v180, v188
    v_mul_f32 v189, v181, v189
    s_waitcnt lgkmcnt(3)
    v_mfma_f32_32x32x16_bf16 v[208:223], a[128:131], v[96:99], v[208:223]
    ds_read_b128 v[120:123], v35 offset:3072
    v_mul_f32 v190, v182, v190
    v_mul_f32 v191, v183, v191
    v_add_f32 v80, 1.0, v80
    v_add_f32 v81, 1.0, v81
    v_add_f32 v82, 1.0, v82
    v_mfma_f32_32x32x16_bf16 v[208:223], a[132:135], v[100:103], v[208:223]
    ds_read_b128 v[124:127], v36 offset:3072
    v_add_f32 v83, 1.0, v83
    v_rcp_f32 v80, v80
    v_rcp_f32 v81, v81
    v_mfma_f32_32x32x16_bf16 v[208:223], a[136:139], v[104:107], v[208:223]
    s_barrier
    ds_read_b128 v[96:99], v37 offset:32768
    s_waitcnt lgkmcnt(3)
    v_mfma_f32_32x32x16_bf16 v[208:223], a[140:143], v[108:111], v[208:223]
    ds_read_b128 v[100:103], v38 offset:32768
    buffer_load_dwordx4 v18, s[36:39], s62 offen offset:0  lds
    buffer_load_dwordx4 v19, s[36:39], s63 offen offset:1024  lds
    v_mfma_f32_32x32x16_bf16 v[208:223], a[144:147], v[112:115], v[208:223]
    ds_read_b128 v[104:107], v39 offset:32768
    v_rcp_f32 v82, v82
    v_rcp_f32 v83, v83
    v_mul_f32 v188, v188, v80
    v_mfma_f32_32x32x16_bf16 v[208:223], a[148:151], v[116:119], v[208:223]
    ds_read_b128 v[108:111], v40 offset:32768
    buffer_load_dwordx4 v20, s[36:39], s64 offen offset:2048  lds
    v_mul_f32 v189, v189, v81
    v_mul_f32 v190, v190, v82
    s_waitcnt lgkmcnt(3)
    v_mfma_f32_32x32x16_bf16 v[208:223], a[152:155], v[120:123], v[208:223]
    ds_read_b128 v[112:115], v37 offset:33792
    buffer_load_dwordx4 v21, s[36:39], s65 offen offset:3072  lds
    s_add_u32 m0, s57, 4096
    v_perm_b32 v50, v70, v70, s59
    v_mul_f32 v191, v191, v83
    v_mfma_f32_32x32x16_bf16 v[208:223], a[156:159], v[124:127], v[208:223]
    ds_read_b128 v[116:119], v38 offset:33792
    buffer_load_dwordx4 v18, s[36:39], s66 offen offset:0  lds
    buffer_load_dwordx4 v19, s[36:39], s67 offen offset:1024  lds
    v_cvt_pk_bf16_f32 v90, v188, v189
    v_mfma_f32_32x32x16_bf16 v[208:223], v[52:55], v[50:53], v[208:223]
    v_cvt_pk_bf16_f32 v91, v190, v191
    v_mfma_f32_32x32x16_bf16 v[128:143], a[0:3], v[96:99], 0
    ds_read_b128 v[120:123], v39 offset:33792
    buffer_load_dwordx4 v20, s[36:39], s68 offen offset:2048  lds
    buffer_load_dwordx4 v21, s[36:39], s69 offen offset:3072  lds
    s_waitcnt lgkmcnt(3)
    v_mfma_f32_32x32x16_bf16 v[128:143], a[4:7], v[100:103], v[128:143]
    ds_read_b128 v[124:127], v40 offset:33792
    s_add_u32 s52, s77, 16
    s_and_b32 s62, s52, 1
    s_lshr_b32 s52, s52, 1
    s_lshl_b32 s52, s52, 2
    s_add_u32 s62, s62, s52
    v_mfma_f32_32x32x16_bf16 v[128:143], a[8:11], v[104:107], v[128:143]
    ds_read_b128 v[96:99], v37 offset:34816
    s_add_u32 s62, s62, 2
    s_mov_b32 s65, s62
    s_mov_b32 s48, s12
    s_mov_b32 s49, s13
    s_mov_b32 s50, 2621440
    v_mfma_f32_32x32x16_bf16 v[128:143], a[12:15], v[108:111], v[128:143]
    ds_read_b128 v[100:103], v38 offset:34816
    s_mov_b32 s51, 0x20000
    s_mul_i32 s52, s30, 9216
    s_add_u32 s64, s52, 98432
    s_mul_i32 s71, s30, 9248
    s_waitcnt lgkmcnt(3)
    v_mfma_f32_32x32x16_bf16 v[128:143], a[16:19], v[112:115], v[128:143]
    ds_read_b128 v[104:107], v39 offset:34816
    s_add_u32 s71, s71, 102784
    s_mov_b32 s69, 4294909952
    v_and_b32 v1, 3, v0
    v_bfe_u32 v2, v0, 2, 2
    v_lshrrev_b32 v3, 4, v0
    v_mfma_f32_32x32x16_bf16 v[128:143], a[20:23], v[116:119], v[128:143]
    ds_read_b128 v[108:111], v40 offset:34816
    s_add_u32 s54, s58, 221184
    buffer_store_dwordx4 v[84:87], v41, s[44:47], s54 offen sc1
    v_mfma_f32_32x32x16_bf16 v[128:143], a[24:27], v[120:123], v[128:143]
    ds_read_b128 v[112:115], v37 offset:35840
    s_add_u32 s54, s58, 331776
    buffer_store_dwordx4 v[88:91], v41, s[44:47], s54 offen sc1
    s_waitcnt lgkmcnt(3)
    v_mfma_f32_32x32x16_bf16 v[128:143], a[28:31], v[124:127], v[128:143]
    ds_read_b128 v[116:119], v38 offset:35840
    v_add_u32 v4, v1, v3
    v_lshlrev_b32 v4, 5, v4
    v_lshl_add_u32 v4, v2, 3, v4
    v_subrev_u32 v4, 96, v4
    v_add_u32 v10, s64, v4
    v_mfma_f32_32x32x16_bf16 v[128:143], a[32:35], v[96:99], v[128:143]
    ds_read_b128 v[120:123], v39 offset:35840
    v_sub_u32 v4, v1, v2
    v_lshlrev_b32 v4, 3, v4
    v_lshlrev_b32 v5, 5, v3
    v_sub_u32 v4, v4, v5
    v_add_u32 v4, 96, v4
    v_mfma_f32_32x32x16_bf16 v[128:143], a[36:39], v[100:103], v[128:143]
    ds_read_b128 v[124:127], v40 offset:35840
    v_add_u32 v11, s71, v4
    s_lshl_b32 s52, s30, 2
    s_add_u32 s52, s52, 147456
    v_lshlrev_b32 v4, 4, v0
    s_waitcnt lgkmcnt(3)
    v_mfma_f32_32x32x16_bf16 v[128:143], a[40:43], v[104:107], v[128:143]
    ds_read_b128 v[96:99], v37 offset:36864
    v_add_u32 v13, s52, v4
    s_lshl_b32 s52, s30, 12
    v_lshlrev_b32 v16, 4, v0
    v_add_u32 v14, s52, v16
    s_lshl_b32 s52, s30, 10
    v_mfma_f32_32x32x16_bf16 v[128:143], a[44:47], v[108:111], v[128:143]
    ds_read_b128 v[100:103], v38 offset:36864
    v_add_u32 v15, s52, v16
    s_mul_i32 s52, s30, -8992
    s_add_u32 s52, s52, s71
    v_mul_u32_u24 v4, 9248, v1
    v_lshrrev_b32 v5, 2, v0
    v_mfma_f32_32x32x16_bf16 v[128:143], a[48:51], v[112:115], v[128:143]
    ds_read_b128 v[104:107], v39 offset:36864
    v_lshl_add_u32 v4, v5, 4, v4
    v_add_u32 v12, s52, v4
    s_lshr_b32 s52, s62, 4
    s_lshl_b32 s52, s52, 12
    s_waitcnt lgkmcnt(3)
    v_mfma_f32_32x32x16_bf16 v[128:143], a[52:55], v[116:119], v[128:143]
    ds_read_b128 v[108:111], v40 offset:36864
    s_add_u32 s52, s52, 12648448
    v_lshlrev_b32 v4, 6, v0
    v_add_u32 v17, s52, v4
    v_mul_f32 v76, v192, v69
    v_mul_f32 v77, v193, v69
    v_mfma_f32_32x32x16_bf16 v[128:143], a[56:59], v[120:123], v[128:143]
    ds_read_b128 v[112:115], v37 offset:37888
    buffer_load_dword v94, v17, s[44:47], 0 offen sc1
    v_mul_f32 v78, v194, v69
    v_mul_f32 v79, v195, v69
    v_mfma_f32_32x32x16_bf16 v[128:143], a[60:63], v[124:127], v[128:143]
    ds_read_b128 v[116:119], v38 offset:37888
    s_lshl_b32 s66, s62, 2
    s_add_u32 s66, s66, s30
    s_lshl_b32 s67, s66, 12
    s_mov_b32 m0, s64
    s_nop 0
    buffer_load_dwordx4 v16, s[48:51], s67 offen offset:0 nt lds
    buffer_load_dwordx4 v16, s[48:51], s67 offen offset:1024 nt lds
    buffer_load_dwordx4 v16, s[48:51], s67 offen offset:2048 nt lds
    buffer_load_dwordx4 v16, s[48:51], s67 offen offset:3072 nt lds
    v_mov_b32 v224, s67
    s_lshl_b32 s66, s66, 1
    v_mov_b32 v225, s66
    global_load_ushort v224, v224, s[12:13]
    global_load_ushort v225, v225, s[14:15]
    s_waitcnt lgkmcnt(3)
    v_mfma_f32_32x32x16_bf16 v[128:143], a[64:67], v[96:99], v[128:143]
    ds_read_b128 v[120:123], v39 offset:37888
    v_mov_b32 v1, s64
    v_mov_b32 v2, s71
    v_cmp_gt_u32 vcc, 32, v0
    s_nop 1
    v_cndmask_b32 v1, v2, v1, vcc
    v_and_b32 v2, 31, v0
    v_lshl_add_u32 v1, v2, 2, v1
    v_subrev_u32 v1, 128, v1
    v_mov_b32 v2, 0
    ds_write_b32 v1, v2
    v_mfma_f32_32x32x16_bf16 v[128:143], a[68:71], v[100:103], v[128:143]
    ds_read_b128 v[124:127], v40 offset:37888
    v_exp_f32 v76, v76
    v_exp_f32 v77, v77
    v_mfma_f32_32x32x16_bf16 v[128:143], a[72:75], v[104:107], v[128:143]
    ds_read_b128 v[96:99], v37 offset:38912
    v_exp_f32 v78, v78
    v_exp_f32 v79, v79
    s_waitcnt lgkmcnt(4)
    v_mfma_f32_32x32x16_bf16 v[128:143], a[76:79], v[108:111], v[128:143]
    ds_read_b128 v[100:103], v38 offset:38912
    v_mul_f32 v200, v192, v200
    v_mul_f32 v201, v193, v201
    v_mul_f32 v202, v194, v202
    v_mul_f32 v203, v195, v203
    v_add_f32 v76, 1.0, v76
    v_mfma_f32_32x32x16_bf16 v[128:143], a[80:83], v[112:115], v[128:143]
    ds_read_b128 v[104:107], v39 offset:38912
    v_add_f32 v77, 1.0, v77
    v_add_f32 v78, 1.0, v78
    v_add_f32 v79, 1.0, v79
    v_rcp_f32 v76, v76
    v_mfma_f32_32x32x16_bf16 v[128:143], a[84:87], v[116:119], v[128:143]
    ds_read_b128 v[108:111], v40 offset:38912
    v_rcp_f32 v77, v77
    v_rcp_f32 v78, v78
    s_waitcnt lgkmcnt(3)
    v_mfma_f32_32x32x16_bf16 v[128:143], a[88:91], v[120:123], v[128:143]
    ds_read_b128 v[112:115], v37 offset:39936
    v_rcp_f32 v79, v79
    v_mul_f32 v200, v200, v76
    v_mul_f32 v201, v201, v77
    v_mul_f32 v202, v202, v78
    v_mfma_f32_32x32x16_bf16 v[128:143], a[92:95], v[124:127], v[128:143]
    ds_read_b128 v[116:119], v38 offset:39936
    v_mul_f32 v203, v203, v79
    v_cvt_pk_bf16_f32 v84, v200, v201
    v_cvt_pk_bf16_f32 v85, v202, v203
    v_mul_f32 v80, v196, v69
    v_mul_f32 v81, v197, v69
    v_mfma_f32_32x32x16_bf16 v[128:143], a[96:99], v[96:99], v[128:143]
    ds_read_b128 v[120:123], v39 offset:39936
    v_mul_f32 v82, v198, v69
    v_mul_f32 v83, v199, v69
    v_exp_f32 v80, v80
    s_waitcnt lgkmcnt(3)
    v_mfma_f32_32x32x16_bf16 v[128:143], a[100:103], v[100:103], v[128:143]
    ds_read_b128 v[124:127], v40 offset:39936
    v_exp_f32 v81, v81
    v_exp_f32 v82, v82
    v_mfma_f32_32x32x16_bf16 v[128:143], a[104:107], v[104:107], v[128:143]
    ds_read_b128 v[96:99], v33 offset:4096
    v_exp_f32 v83, v83
    v_mul_f32 v204, v196, v204
    v_mul_f32 v205, v197, v205
    v_mul_f32 v206, v198, v206
    v_mfma_f32_32x32x16_bf16 v[128:143], a[108:111], v[108:111], v[128:143]
    ds_read_b128 v[100:103], v34 offset:4096
    v_mul_f32 v207, v199, v207
    v_add_f32 v80, 1.0, v80
    v_add_f32 v81, 1.0, v81
    v_add_f32 v82, 1.0, v82
    s_waitcnt lgkmcnt(3)
    v_mfma_f32_32x32x16_bf16 v[128:143], a[112:115], v[112:115], v[128:143]
    ds_read_b128 v[104:107], v35 offset:4096
    v_add_f32 v83, 1.0, v83
    v_rcp_f32 v80, v80
    v_rcp_f32 v81, v81
    v_mfma_f32_32x32x16_bf16 v[128:143], a[116:119], v[116:119], v[128:143]
    ds_read_b128 v[108:111], v36 offset:4096
    s_waitcnt vmcnt(7)
    buffer_store_dword v8, v9, s[44:47], s78 offen offset:0 sc1
    s_add_u32 s78, s78, 8192
    v_mfma_f32_32x32x16_bf16 v[128:143], a[120:123], v[120:123], v[128:143]
    ds_read_b128 v[112:115], v33 offset:5120
    v_rcp_f32 v82, v82
    v_rcp_f32 v83, v83
    s_waitcnt lgkmcnt(3)
    v_mfma_f32_32x32x16_bf16 v[128:143], a[124:127], v[124:127], v[128:143]
    ds_read_b128 v[116:119], v34 offset:5120
    v_mul_f32 v204, v204, v80
    v_mul_f32 v205, v205, v81
    v_mul_f32 v206, v206, v82
    v_mul_f32 v207, v207, v83
    v_cvt_pk_bf16_f32 v86, v204, v205
    v_mfma_f32_32x32x16_bf16 v[128:143], a[128:131], v[96:99], v[128:143]
    ds_read_b128 v[120:123], v35 offset:5120
    v_cvt_pk_bf16_f32 v87, v206, v207
    v_mul_f32 v76, v208, v71
    v_mul_f32 v77, v209, v71
    v_mul_f32 v78, v210, v71
    v_mul_f32 v79, v211, v71
    v_mfma_f32_32x32x16_bf16 v[128:143], a[132:135], v[100:103], v[128:143]
    ds_read_b128 v[124:127], v36 offset:5120
    v_exp_f32 v76, v76
    v_exp_f32 v77, v77
    s_waitcnt lgkmcnt(3)
    v_mfma_f32_32x32x16_bf16 v[128:143], a[136:139], v[104:107], v[128:143]
    s_barrier
    ds_read_b128 v[96:99], v37 offset:0
    v_exp_f32 v78, v78
    v_mfma_f32_32x32x16_bf16 v[128:143], a[140:143], v[108:111], v[128:143]
    ds_read_b128 v[100:103], v38 offset:0
    v_exp_f32 v79, v79
    v_mul_f32 v216, v208, v216
    v_mul_f32 v217, v209, v217
    v_mul_f32 v218, v210, v218
    v_mfma_f32_32x32x16_bf16 v[128:143], a[144:147], v[112:115], v[128:143]
    ds_read_b128 v[104:107], v39 offset:0
    v_mul_f32 v219, v211, v219
    v_add_f32 v76, 1.0, v76
    v_add_f32 v77, 1.0, v77
    v_add_f32 v78, 1.0, v78
    s_waitcnt lgkmcnt(3)
    v_mfma_f32_32x32x16_bf16 v[128:143], a[148:151], v[116:119], v[128:143]
    ds_read_b128 v[108:111], v40 offset:0
    v_add_f32 v79, 1.0, v79
    v_rcp_f32 v76, v76
    v_rcp_f32 v77, v77
    v_mfma_f32_32x32x16_bf16 v[128:143], a[152:155], v[120:123], v[128:143]
    ds_read_b128 v[112:115], v37 offset:1024
    v_perm_b32 v50, v72, v72, s59
    v_rcp_f32 v78, v78
    v_rcp_f32 v79, v79
    v_mfma_f32_32x32x16_bf16 v[128:143], a[156:159], v[124:127], v[128:143]
    ds_read_b128 v[116:119], v38 offset:1024
    s_waitcnt vmcnt(7)
    v_cmp_ne_u32 vcc, s3, v94
    s_nop 0
    s_cbranch_vccnz SLOW6
BACK6:
    s_lshl_b32 s68, s62, 14
    v_mfma_f32_32x32x16_bf16 v[128:143], v[52:55], v[50:53], v[128:143]
    s_add_u32 s67, s68, 0
    buffer_load_dwordx4 v[228:231], v15, s[44:47], s67 offen sc1
    s_add_u32 s67, s68, 4096
    v_mul_f32 v216, v216, v76
    s_waitcnt lgkmcnt(3)
    v_mfma_f32_32x32x16_bf16 v[144:159], a[0:3], v[96:99], 0
    ds_read_b128 v[120:123], v39 offset:1024
    buffer_load_dwordx4 v[232:235], v15, s[44:47], s67 offen sc1
    s_add_u32 s67, s68, 8192
    buffer_load_dwordx4 v[236:239], v15, s[44:47], s67 offen sc1
    v_mfma_f32_32x32x16_bf16 v[144:159], a[4:7], v[100:103], v[144:159]
    ds_read_b128 v[124:127], v40 offset:1024
    s_add_u32 s67, s68, 12288
    buffer_load_dwordx4 v[240:243], v15, s[44:47], s67 offen sc1
    s_mov_b32 s70, 0
    s_mov_b32 s79, 0
    v_mfma_f32_32x32x16_bf16 v[144:159], a[8:11], v[104:107], v[144:159]
    ds_read_b128 v[96:99], v37 offset:2048
    s_mov_b32 s71, 4294838272
    v_mov_b32 v23, 0x80000000
    v_mov_b32 v24, 0x80000000
    v_add_u32 v22, 18432, v14
    s_waitcnt lgkmcnt(3)
    v_mfma_f32_32x32x16_bf16 v[144:159], a[12:15], v[108:111], v[144:159]
    ds_read_b128 v[100:103], v38 offset:2048
    v_mul_f32 v217, v217, v77
    v_mul_f32 v218, v218, v78
    v_mul_f32 v219, v219, v79
    v_cvt_pk_bf16_f32 v88, v216, v217
    v_cvt_pk_bf16_f32 v89, v218, v219
    v_mfma_f32_32x32x16_bf16 v[144:159], a[16:19], v[112:115], v[144:159]
    ds_read_b128 v[104:107], v39 offset:2048
    v_mul_f32 v80, v212, v71
    v_mul_f32 v81, v213, v71
    v_mul_f32 v82, v214, v71
    v_mul_f32 v83, v215, v71
    v_mfma_f32_32x32x16_bf16 v[144:159], a[20:23], v[116:119], v[144:159]
    ds_read_b128 v[108:111], v40 offset:2048
    v_exp_f32 v80, v80
    v_exp_f32 v81, v81
    s_waitcnt lgkmcnt(3)
    v_mfma_f32_32x32x16_bf16 v[144:159], a[24:27], v[120:123], v[144:159]
    ds_read_b128 v[112:115], v37 offset:3072
    v_exp_f32 v82, v82
    v_exp_f32 v83, v83
    v_mul_f32 v220, v212, v220
    v_mfma_f32_32x32x16_bf16 v[144:159], a[28:31], v[124:127], v[144:159]
    ds_read_b128 v[116:119], v38 offset:3072
    v_mul_f32 v221, v213, v221
    v_mul_f32 v222, v214, v222
    v_mul_f32 v223, v215, v223
    v_add_f32 v80, 1.0, v80
    v_add_f32 v81, 1.0, v81
    v_mfma_f32_32x32x16_bf16 v[144:159], a[32:35], v[96:99], v[144:159]
    ds_read_b128 v[120:123], v39 offset:3072
    v_add_f32 v82, 1.0, v82
    v_add_f32 v83, 1.0, v83
    v_rcp_f32 v80, v80
    s_waitcnt lgkmcnt(3)
    v_mfma_f32_32x32x16_bf16 v[144:159], a[36:39], v[100:103], v[144:159]
    ds_read_b128 v[124:127], v40 offset:3072
    v_rcp_f32 v81, v81
    v_rcp_f32 v82, v82
    v_mfma_f32_32x32x16_bf16 v[144:159], a[40:43], v[104:107], v[144:159]
    ds_read_b128 v[96:99], v37 offset:4096
    v_rcp_f32 v83, v83
    v_mul_f32 v220, v220, v80
    v_mul_f32 v221, v221, v81
    v_mul_f32 v222, v222, v82
    v_mfma_f32_32x32x16_bf16 v[144:159], a[44:47], v[108:111], v[144:159]
    ds_read_b128 v[100:103], v38 offset:4096
    v_mul_f32 v223, v223, v83
    v_cvt_pk_bf16_f32 v90, v220, v221
    v_cvt_pk_bf16_f32 v91, v222, v223
    s_waitcnt lgkmcnt(3)
    v_mfma_f32_32x32x16_bf16 v[144:159], a[48:51], v[112:115], v[144:159]
    ds_read_b128 v[104:107], v39 offset:4096
    s_add_u32 s54, s58, 442368
    buffer_store_dwordx4 v[84:87], v41, s[44:47], s54 offen sc1
    v_mfma_f32_32x32x16_bf16 v[144:159], a[52:55], v[116:119], v[144:159]
    ds_read_b128 v[108:111], v40 offset:4096
    s_add_u32 s54, s58, 552960
    buffer_store_dwordx4 v[88:91], v41, s[44:47], s54 offen sc1
    v_mfma_f32_32x32x16_bf16 v[144:159], a[56:59], v[120:123], v[144:159]
    ds_read_b128 v[112:115], v37 offset:5120
    v_mul_f32 v76, v128, v73
    v_mul_f32 v77, v129, v73
    v_mul_f32 v78, v130, v73
    v_mul_f32 v79, v131, v73
    s_waitcnt lgkmcnt(3)
    v_mfma_f32_32x32x16_bf16 v[144:159], a[60:63], v[124:127], v[144:159]
    ds_read_b128 v[116:119], v38 offset:5120
    v_exp_f32 v76, v76
    v_exp_f32 v77, v77
    v_mfma_f32_32x32x16_bf16 v[144:159], a[64:67], v[96:99], v[144:159]
    ds_read_b128 v[120:123], v39 offset:5120
    v_exp_f32 v78, v78
    v_exp_f32 v79, v79
    v_mul_f32 v136, v128, v136
    v_mfma_f32_32x32x16_bf16 v[144:159], a[68:71], v[100:103], v[144:159]
    ds_read_b128 v[124:127], v40 offset:5120
    v_mul_f32 v137, v129, v137
    v_mul_f32 v138, v130, v138
    v_mul_f32 v139, v131, v139
    v_add_f32 v76, 1.0, v76
    s_waitcnt lgkmcnt(3)
    v_mfma_f32_32x32x16_bf16 v[144:159], a[72:75], v[104:107], v[144:159]
    ds_read_b128 v[96:99], v37 offset:6144
    v_add_f32 v77, 1.0, v77
    v_add_f32 v78, 1.0, v78
    v_add_f32 v79, 1.0, v79
    v_rcp_f32 v76, v76
    v_mfma_f32_32x32x16_bf16 v[144:159], a[76:79], v[108:111], v[144:159]
    ds_read_b128 v[100:103], v38 offset:6144
    v_rcp_f32 v77, v77
    v_rcp_f32 v78, v78
    v_mfma_f32_32x32x16_bf16 v[144:159], a[80:83], v[112:115], v[144:159]
    ds_read_b128 v[104:107], v39 offset:6144
    v_rcp_f32 v79, v79
    v_mul_f32 v136, v136, v76
    v_mul_f32 v137, v137, v77
    s_waitcnt lgkmcnt(3)
    v_mfma_f32_32x32x16_bf16 v[144:159], a[84:87], v[116:119], v[144:159]
    ds_read_b128 v[108:111], v40 offset:6144
    v_mul_f32 v138, v138, v78
    v_mul_f32 v139, v139, v79
    v_cvt_pk_bf16_f32 v84, v136, v137
    v_cvt_pk_bf16_f32 v85, v138, v139
    v_mul_f32 v80, v132, v73
    v_mfma_f32_32x32x16_bf16 v[144:159], a[88:91], v[120:123], v[144:159]
    ds_read_b128 v[112:115], v37 offset:7168
    v_mul_f32 v81, v133, v73
    v_mul_f32 v82, v134, v73
    v_mul_f32 v83, v135, v73
    v_exp_f32 v80, v80
    v_mfma_f32_32x32x16_bf16 v[144:159], a[92:95], v[124:127], v[144:159]
    ds_read_b128 v[116:119], v38 offset:7168
    v_exp_f32 v81, v81
    v_exp_f32 v82, v82
    s_waitcnt lgkmcnt(3)
    v_mfma_f32_32x32x16_bf16 v[144:159], a[96:99], v[96:99], v[144:159]
    ds_read_b128 v[120:123], v39 offset:7168
    v_exp_f32 v83, v83
    v_mul_f32 v140, v132, v140
    v_mul_f32 v141, v133, v141
    v_mul_f32 v142, v134, v142
    v_mfma_f32_32x32x16_bf16 v[144:159], a[100:103], v[100:103], v[144:159]
    ds_read_b128 v[124:127], v40 offset:7168
    v_mul_f32 v143, v135, v143
    v_add_f32 v80, 1.0, v80
    v_add_f32 v81, 1.0, v81
    v_add_f32 v82, 1.0, v82
    v_add_f32 v83, 1.0, v83
    v_mfma_f32_32x32x16_bf16 v[144:159], a[104:107], v[104:107], v[144:159]
    ds_read_b128 v[96:99], v33 offset:6144
    v_rcp_f32 v80, v80
    v_rcp_f32 v81, v81
    s_waitcnt lgkmcnt(3)
    v_mfma_f32_32x32x16_bf16 v[144:159], a[108:111], v[108:111], v[144:159]
    ds_read_b128 v[100:103], v34 offset:6144
    v_rcp_f32 v82, v82
    v_rcp_f32 v83, v83
    v_mul_f32 v140, v140, v80
    v_mfma_f32_32x32x16_bf16 v[144:159], a[112:115], v[112:115], v[144:159]
    ds_read_b128 v[104:107], v35 offset:6144
    v_mul_f32 v141, v141, v81
    v_mul_f32 v142, v142, v82
    v_mul_f32 v143, v143, v83
    v_cvt_pk_bf16_f32 v86, v140, v141
    v_cvt_pk_bf16_f32 v87, v142, v143
    v_mfma_f32_32x32x16_bf16 v[144:159], a[116:119], v[116:119], v[144:159]
    ds_read_b128 v[108:111], v36 offset:6144
    s_waitcnt lgkmcnt(3)
    v_mfma_f32_32x32x16_bf16 v[144:159], a[120:123], v[120:123], v[144:159]
    ds_read_b128 v[112:115], v33 offset:7168
    v_mfma_f32_32x32x16_bf16 v[144:159], a[124:127], v[124:127], v[144:159]
    ds_read_b128 v[116:119], v34 offset:7168
    v_mfma_f32_32x32x16_bf16 v[144:159], a[128:131], v[96:99], v[144:159]
    ds_read_b128 v[120:123], v35 offset:7168
    s_waitcnt lgkmcnt(3)
    v_mfma_f32_32x32x16_bf16 v[144:159], a[132:135], v[100:103], v[144:159]
    ds_read_b128 v[124:127], v36 offset:7168
    v_mfma_f32_32x32x16_bf16 v[144:159], a[136:139], v[104:107], v[144:159]
    v_mfma_f32_32x32x16_bf16 v[144:159], a[140:143], v[108:111], v[144:159]
    s_waitcnt lgkmcnt(1)
    v_mfma_f32_32x32x16_bf16 v[144:159], a[144:147], v[112:115], v[144:159]
    v_mfma_f32_32x32x16_bf16 v[144:159], a[148:151], v[116:119], v[144:159]
    v_mfma_f32_32x32x16_bf16 v[144:159], a[152:155], v[120:123], v[144:159]
    v_perm_b32 v50, v74, v74, s59
    s_waitcnt lgkmcnt(0)
    v_mfma_f32_32x32x16_bf16 v[144:159], a[156:159], v[124:127], v[144:159]
    s_waitcnt vmcnt(0)
    buffer_store_dword v8, v9, s[44:47], s78 offen offset:0 sc1
    s_add_u32 s78, s78, 8192
    v_mfma_f32_32x32x16_bf16 v[144:159], v[52:55], v[50:53], v[144:159]
    s_nop 11
    v_mul_f32 v76, v144, v75
    v_mul_f32 v77, v145, v75
    v_mul_f32 v78, v146, v75
    v_mul_f32 v79, v147, v75
    v_exp_f32 v76, v76
    v_exp_f32 v77, v77
    v_exp_f32 v78, v78
    v_exp_f32 v79, v79
    v_mul_f32 v152, v144, v152
    v_mul_f32 v153, v145, v153
    v_mul_f32 v154, v146, v154
    v_mul_f32 v155, v147, v155
    v_add_f32 v76, 1.0, v76
    v_add_f32 v77, 1.0, v77
    v_add_f32 v78, 1.0, v78
    v_add_f32 v79, 1.0, v79
    v_rcp_f32 v76, v76
    v_rcp_f32 v77, v77
    v_rcp_f32 v78, v78
    v_rcp_f32 v79, v79
    v_mul_f32 v152, v152, v76
    v_mul_f32 v153, v153, v77
    v_mul_f32 v154, v154, v78
    v_mul_f32 v155, v155, v79
    v_cvt_pk_bf16_f32 v88, v152, v153
    v_cvt_pk_bf16_f32 v89, v154, v155
    v_mul_f32 v80, v148, v75
    v_mul_f32 v81, v149, v75
    v_mul_f32 v82, v150, v75
    v_mul_f32 v83, v151, v75
    v_exp_f32 v80, v80
    v_exp_f32 v81, v81
    v_exp_f32 v82, v82
    v_exp_f32 v83, v83
    v_mul_f32 v156, v148, v156
    v_mul_f32 v157, v149, v157
    v_mul_f32 v158, v150, v158
    v_mul_f32 v159, v151, v159
    v_add_f32 v80, 1.0, v80
    v_add_f32 v81, 1.0, v81
    v_add_f32 v82, 1.0, v82
    v_add_f32 v83, 1.0, v83
    v_rcp_f32 v80, v80
    v_rcp_f32 v81, v81
    v_rcp_f32 v82, v82
    v_rcp_f32 v83, v83
    v_mul_f32 v156, v156, v80
    v_mul_f32 v157, v157, v81
    v_mul_f32 v158, v158, v82
    v_mul_f32 v159, v159, v83
    v_cvt_pk_bf16_f32 v90, v156, v157
    v_cvt_pk_bf16_f32 v91, v158, v159
    s_add_u32 s54, s58, 663552
    buffer_store_dwordx4 v[84:87], v41, s[44:47], s54 offen sc1
    s_add_u32 s54, s58, 774144
    buffer_store_dwordx4 v[88:91], v41, s[44:47], s54 offen sc1
    ds_write_b128 v12, v[228:231] offset:0
    ds_write_b128 v12, v[232:235] offset:1024
    ds_write_b128 v12, v[236:239] offset:2048
    ds_write_b128 v12, v[240:243] offset:3072
    v_lshlrev_b32 v224, 16, v224
    v_lshlrev_b32 v225, 16, v225
    v_add_f32 v224, v224, v225
    v_cvt_pk_bf16_f32 v224, v224, v224
    v_mov_b32 v225, s64
    ds_write_b16 v225, v224
    s_mov_b32 s70, s78
    v_mov_b32 v24, v9
    v_accvgpr_write_b32 a128, 0
    v_accvgpr_write_b32 a129, 0
    s_waitcnt lgkmcnt(0)
    s_barrier
    s_branch CONV_LAST
AUX2:
    v_and_b32 v1, 3, v0
    v_bfe_u32 v2, v0, 2, 2
    v_lshl_add_u32 v1, v1, 3, v2
    v_lshrrev_b32 v3, 5, v0
    v_bfe_u32 v4, v0, 4, 1
    v_lshlrev_b32 v4, 3, v4
    v_add_u32 v4, s57, v4
    v_add_u32 v5, 4, v1
    v_bfe_u32 v6, v5, 3, 2
    v_bfe_u32 v7, v5, 1, 1
    v_lshl_add_u32 v6, v6, 1, v7
    v_xor_b32 v6, v6, v3
    v_lshlrev_b32 v6, 4, v6
    v_lshl_add_u32 v6, v5, 7, v6
    v_add_u32 v176, v6, v4
    v_xor_b32 v177, 32, v176
    v_xor_b32 v178, 64, v176
    v_xor_b32 v179, 96, v176
    v_add_u32 v5, 8, v1
    v_bfe_u32 v6, v5, 3, 2
    v_bfe_u32 v7, v5, 1, 1
    v_lshl_add_u32 v6, v6, 1, v7
    v_xor_b32 v6, v6, v3
    v_lshlrev_b32 v6, 4, v6
    v_lshl_add_u32 v6, v5, 7, v6
    v_add_u32 v180, v6, v4
    v_xor_b32 v181, 32, v180
    v_xor_b32 v182, 64, v180
    v_xor_b32 v183, 96, v180
    v_add_u32 v5, 12, v1
    v_bfe_u32 v6, v5, 3, 2
    v_bfe_u32 v7, v5, 1, 1
    v_lshl_add_u32 v6, v6, 1, v7
    v_xor_b32 v6, v6, v3
    v_lshlrev_b32 v6, 4, v6
    v_lshl_add_u32 v6, v5, 7, v6
    v_add_u32 v184, v6, v4
    v_xor_b32 v185, 32, v184
    v_xor_b32 v186, 64, v184
    v_xor_b32 v187, 96, v184
    v_add_u32 v5, 5, v1
    v_bfe_u32 v6, v5, 3, 2
    v_bfe_u32 v7, v5, 1, 1
    v_lshl_add_u32 v6, v6, 1, v7
    v_xor_b32 v6, v6, v3
    v_lshlrev_b32 v6, 4, v6
    v_lshl_add_u32 v6, v5, 7, v6
    v_add_u32 v188, v6, v4
    v_xor_b32 v189, 32, v188
    v_xor_b32 v190, 64, v188
    v_xor_b32 v191, 96, v188
    v_add_u32 v5, 9, v1
    v_bfe_u32 v6, v5, 3, 2
    v_bfe_u32 v7, v5, 1, 1
    v_lshl_add_u32 v6, v6, 1, v7
    v_xor_b32 v6, v6, v3
    v_lshlrev_b32 v6, 4, v6
    v_lshl_add_u32 v6, v5, 7, v6
    v_add_u32 v192, v6, v4
    v_xor_b32 v193, 32, v192
    v_xor_b32 v194, 64, v192
    v_xor_b32 v195, 96, v192
    v_add_u32 v5, 13, v1
    v_bfe_u32 v6, v5, 3, 2
    v_bfe_u32 v7, v5, 1, 1
    v_lshl_add_u32 v6, v6, 1, v7
    v_xor_b32 v6, v6, v3
    v_lshlrev_b32 v6, 4, v6
    v_lshl_add_u32 v6, v5, 7, v6
    v_add_u32 v196, v6, v4
    v_xor_b32 v197, 32, v196
    v_xor_b32 v198, 64, v196
    v_xor_b32 v199, 96, v196
    v_add_u32 v5, 0, v1
    v_bfe_u32 v6, v5, 3, 2
    v_bfe_u32 v7, v5, 1, 1
    v_lshl_add_u32 v6, v6, 1, v7
    v_xor_b32 v6, v6, v3
    v_lshlrev_b32 v6, 4, v6
    v_lshl_add_u32 v6, v5, 7, v6
    v_add_u32 v6, 5120, v6
    v_add_u32 v200, v6, v4
    v_xor_b32 v201, 32, v200
    v_xor_b32 v202, 64, v200
    v_xor_b32 v203, 96, v200
    v_add_u32 v5, 4, v1
    v_bfe_u32 v6, v5, 3, 2
    v_bfe_u32 v7, v5, 1, 1
    v_lshl_add_u32 v6, v6, 1, v7
    v_xor_b32 v6, v6, v3
    v_lshlrev_b32 v6, 4, v6
    v_lshl_add_u32 v6, v5, 7, v6
    v_add_u32 v6, 5120, v6
    v_add_u32 v204, v6, v4
    v_xor_b32 v205, 32, v204
    v_xor_b32 v206, 64, v204
    v_xor_b32 v207, 96, v204
    v_lshrrev_b32 v1, 4, v0
    v_and_b32 v2, 15, v0
    v_lshlrev_b32 v1, 14, v1
    v_lshl_add_u32 v120, v2, 4, v1
    s_lshl_b32 s52, s32, 18
    s_lshl_b32 s53, s58, 3
    s_add_u32 s56, s52, s53
    s_lshl_b32 s52, s32, 12
    s_lshl_b32 s53, s58, 1
    s_add_u32 s52, s52, s53
    s_add_u32 s78, s52, 12648448
    v_cmp_gt_u32 vcc, 16, v0
    v_mov_b32 v1, 0x80000000
    v_lshlrev_b32 v2, 2, v0
    v_cndmask_b32 v9, v1, v2, vcc
    s_add_u32 m0, s57, 9216
    s_add_u32 s67, s66, 645120
    buffer_load_dwordx4 v170, s[36:39], s67 offen nt lds
    s_add_u32 m0, s57, 10240
    s_add_u32 s67, s66, 655360
    buffer_load_dwordx4 v171, s[36:39], s67 offen nt lds
    s_add_u32 m0, s57, 11264
    s_add_u32 s67, s66, 665600
    buffer_load_dwordx4 v172, s[36:39], s67 offen nt lds
    s_lshl_b32 s62, s32, 4
    s_lshl_b32 s52, s33, 2
    s_add_u32 s62, s62, s52
    s_add_u32 s64, s57, 128
    s_mul_i32 s71, s30, 36896
    s_add_u32 s71, s71, 4480
    v_and_b32 v1, 3, v0
    v_bfe_u32 v2, v0, 2, 2
    v_lshrrev_b32 v3, 4, v0
    v_add_u32 v4, v1, v3
    v_lshlrev_b32 v4, 5, v4
    v_lshl_add_u32 v4, v2, 3, v4
    v_subrev_u32 v4, 96, v4
    v_add_u32 v10, s64, v4
    v_sub_u32 v4, v1, v2
    v_lshlrev_b32 v4, 3, v4
    v_lshlrev_b32 v5, 5, v3
    v_sub_u32 v4, v4, v5
    v_add_u32 v4, 96, v4
    v_add_u32 v11, s71, v4
    s_lshl_b32 s52, s30, 2
    s_add_u32 s52, s52, 147456
    v_lshlrev_b32 v4, 4, v0
    v_add_u32 v13, s52, v4
    s_lshl_b32 s52, s30, 12
    v_lshlrev_b32 v16, 4, v0
    v_add_u32 v14, s52, v16
    s_lshl_b32 s52, s30, 10
    v_add_u32 v15, s52, v16
    s_mul_i32 s52, s30, -36640
    s_add_u32 s52, s52, s71
    v_mul_u32_u24 v4, 36896, v1
    v_lshrrev_b32 v5, 2, v0
    v_lshl_add_u32 v4, v5, 4, v4
    v_add_u32 v12, s52, v4
    s_lshr_b32 s52, s62, 4
    s_lshl_b32 s52, s52, 12
    s_add_u32 s52, s52, 12648448
    v_lshlrev_b32 v4, 6, v0
    v_add_u32 v17, s52, v4
    v_accvgpr_write_b32 a128, 0
    v_accvgpr_write_b32 a129, 0
    s_lshl_b32 s52, s32, 12
    s_add_u32 s52, s52, 12648448
    v_min_u32 v1, 15, v0
    v_lshlrev_b32 v1, 6, v1
    v_add_u32 v27, s52, v1
    v_min_u32 v1, 31, v0
    v_lshlrev_b32 v1, 6, v1
    v_add_u32 v25, s52, v1
    v_min_u32 v1, 47, v0
    v_lshlrev_b32 v1, 6, v1
    v_add_u32 v26, s52, v1
    s_add_u32 s65, s62, 1
    s_mov_b32 s69, 9216
    v_or_b32 v1, s30, v0
    v_cmp_eq_u32 vcc, 0, v1
    v_mov_b32 v1, 0x80000000
    v_mov_b32 v2, 128
    v_cndmask_b32 v28, v1, v2, vcc
    v_mov_b32 v29, 1
    s_mov_b64 exec, 0
    s_cmp_eq_u32 s30, 0
    s_cbranch_scc1 CHX0
    s_cmp_eq_u32 s30, 1
    s_cbranch_scc1 CHX1
    s_cmp_eq_u32 s30, 2
    s_cbranch_scc1 CHX2
    s_branch CHX3
WRETX:
    s_mov_b64 exec, -1
    s_add_u32 m0, s57, 12288
    s_add_u32 s67, s66, 675840
    buffer_load_dwordx4 v173, s[36:39], s67 offen nt lds
    s_add_u32 m0, s57, 13312
    s_add_u32 s67, s66, 686080
    buffer_load_dwordx4 v170, s[36:39], s67 offen nt lds
    s_add_u32 m0, s57, 14336
    s_add_u32 s67, s66, 655360
    buffer_load_dwordx4 v170, s[40:43], s67 offen nt lds
    s_add_u32 m0, s57, 15360
    s_add_u32 s67, s66, 665600
    buffer_load_dwordx4 v171, s[40:43], s67 offen nt lds
    s_add_u32 m0, s57, 16384
    s_add_u32 s67, s66, 675840
    buffer_load_dwordx4 v172, s[40:43], s67 offen nt lds
    s_add_u32 m0, s57, 17408
    s_add_u32 s67, s66, 686080
    buffer_load_dwordx4 v173, s[40:43], s67 offen nt lds
    v_mov_b32 v1, 0
    global_load_dword v8, v1, s[26:27] sc1
    s_add_u32 m0, s57, 18432
    s_add_u32 s67, s66, 1300480
    buffer_load_dwordx4 v170, s[36:39], s67 offen nt lds
    s_add_u32 m0, s57, 19456
    s_add_u32 s67, s66, 1310720
    buffer_load_dwordx4 v171, s[36:39], s67 offen nt lds
    s_add_u32 m0, s57, 20480
    s_add_u32 s67, s66, 1320960
    buffer_load_dwordx4 v172, s[36:39], s67 offen nt lds
    s_waitcnt vmcnt(25)
    v_alignbit_b32 v208, v216, v216, 16
    v_alignbit_b32 v212, v217, v217, 16
    s_waitcnt vmcnt(24)
    v_alignbit_b32 v209, v218, v218, 16
    v_alignbit_b32 v213, v219, v219, 16
    s_waitcnt vmcnt(23)
    v_alignbit_b32 v210, v220, v220, 16
    v_alignbit_b32 v214, v221, v221, 16
    s_waitcnt vmcnt(22)
    v_alignbit_b32 v211, v222, v222, 16
    v_alignbit_b32 v215, v223, v223, 16
    s_waitcnt vmcnt(13)
    ds_read_b64_tr_b16 v[128:129], v176 offset:0
    ds_read_b64_tr_b16 v[130:131], v180 offset:0
    ds_read_b64_tr_b16 v[132:133], v184 offset:0
    ds_read_b64_tr_b16 v[134:135], v188 offset:0
    ds_read_b64_tr_b16 v[136:137], v192 offset:0
    ds_read_b64_tr_b16 v[138:139], v196 offset:0
    ds_read_b64_tr_b16 v[140:141], v200 offset:0
    ds_read_b64_tr_b16 v[142:143], v204 offset:0
    ds_read_b64_tr_b16 v[144:145], v177 offset:0
    ds_read_b64_tr_b16 v[146:147], v181 offset:0
    ds_read_b64_tr_b16 v[148:149], v185 offset:0
    ds_read_b64_tr_b16 v[150:151], v189 offset:0
    ds_read_b64_tr_b16 v[152:153], v193 offset:0
    ds_read_b64_tr_b16 v[154:155], v197 offset:0
    ds_read_b64_tr_b16 v[156:157], v201 offset:0
    ds_read_b64_tr_b16 v[158:159], v205 offset:0
    s_add_u32 m0, s57, 21504
    s_add_u32 s67, s66, 1331200
    buffer_load_dwordx4 v173, s[36:39], s67 offen nt lds
    s_add_u32 m0, s57, 22528
    s_add_u32 s67, s66, 1341440
    buffer_load_dwordx4 v170, s[36:39], s67 offen nt lds
    s_waitcnt lgkmcnt(8)
    v_dot2_f32_bf16 v96, v134, v212, 0
    v_dot2_f32_bf16 v97, v129, v212, 0
    v_dot2_f32_bf16 v98, v135, v212, 0
    v_dot2_f32_bf16 v99, v130, v212, 0
    v_dot2_f32_bf16 v100, v136, v212, 0
    v_dot2_f32_bf16 v101, v131, v212, 0
    v_dot2_f32_bf16 v102, v137, v212, 0
    v_dot2_f32_bf16 v103, v132, v212, 0
    v_dot2_f32_bf16 v96, v135, v208, v96
    v_dot2_f32_bf16 v97, v130, v208, v97
    v_dot2_f32_bf16 v98, v136, v208, v98
    v_dot2_f32_bf16 v99, v131, v208, v99
    v_dot2_f32_bf16 v100, v137, v208, v100
    v_dot2_f32_bf16 v101, v132, v208, v101
    v_dot2_f32_bf16 v102, v138, v208, v102
    v_dot2_f32_bf16 v103, v133, v208, v103
    v_lshlrev_b32 v104, 16, v140
    v_and_b32 v105, s60, v140
    v_lshlrev_b32 v106, 16, v141
    v_and_b32 v107, s60, v141
    v_lshlrev_b32 v108, 16, v142
    v_and_b32 v109, s60, v142
    v_lshlrev_b32 v110, 16, v143
    v_and_b32 v111, s60, v143
    v_pk_mul_f32 v[96:97], v[96:97], v[104:105]
    v_pk_mul_f32 v[98:99], v[98:99], v[106:107]
    v_pk_mul_f32 v[100:101], v[100:101], v[108:109]
    v_pk_mul_f32 v[102:103], v[102:103], v[110:111]
    v_cvt_pk_bf16_f32 v224, v96, v97
    v_cvt_pk_bf16_f32 v225, v98, v99
    v_cvt_pk_bf16_f32 v226, v100, v101
    v_cvt_pk_bf16_f32 v227, v102, v103
    ds_read_b64_tr_b16 v[128:129], v178 offset:0
    ds_read_b64_tr_b16 v[130:131], v182 offset:0
    ds_read_b64_tr_b16 v[132:133], v186 offset:0
    ds_read_b64_tr_b16 v[134:135], v190 offset:0
    ds_read_b64_tr_b16 v[136:137], v194 offset:0
    ds_read_b64_tr_b16 v[138:139], v198 offset:0
    ds_read_b64_tr_b16 v[140:141], v202 offset:0
    ds_read_b64_tr_b16 v[142:143], v206 offset:0
    s_add_u32 m0, s57, 23552
    s_add_u32 s67, s66, 1310720
    buffer_load_dwordx4 v170, s[40:43], s67 offen nt lds
    s_add_u32 m0, s57, 24576
    s_add_u32 s67, s66, 1320960
    buffer_load_dwordx4 v171, s[40:43], s67 offen nt lds
    s_waitcnt lgkmcnt(8)
    v_dot2_f32_bf16 v96, v150, v213, 0
    v_dot2_f32_bf16 v97, v145, v213, 0
    v_dot2_f32_bf16 v98, v151, v213, 0
    v_dot2_f32_bf16 v99, v146, v213, 0
    v_dot2_f32_bf16 v100, v152, v213, 0
    v_dot2_f32_bf16 v101, v147, v213, 0
    v_dot2_f32_bf16 v102, v153, v213, 0
    v_dot2_f32_bf16 v103, v148, v213, 0
    v_dot2_f32_bf16 v96, v151, v209, v96
    v_dot2_f32_bf16 v97, v146, v209, v97
    v_dot2_f32_bf16 v98, v152, v209, v98
    v_dot2_f32_bf16 v99, v147, v209, v99
    v_dot2_f32_bf16 v100, v153, v209, v100
    v_dot2_f32_bf16 v101, v148, v209, v101
    v_dot2_f32_bf16 v102, v154, v209, v102
    v_dot2_f32_bf16 v103, v149, v209, v103
    v_lshlrev_b32 v104, 16, v156
    v_and_b32 v105, s60, v156
    v_lshlrev_b32 v106, 16, v157
    v_and_b32 v107, s60, v157
    v_lshlrev_b32 v108, 16, v158
    v_and_b32 v109, s60, v158
    v_lshlrev_b32 v110, 16, v159
    v_and_b32 v111, s60, v159
    v_pk_mul_f32 v[96:97], v[96:97], v[104:105]
    v_pk_mul_f32 v[98:99], v[98:99], v[106:107]
    v_pk_mul_f32 v[100:101], v[100:101], v[108:109]
    v_pk_mul_f32 v[102:103], v[102:103], v[110:111]
    v_cvt_pk_bf16_f32 v228, v96, v97
    v_cvt_pk_bf16_f32 v229, v98, v99
    v_cvt_pk_bf16_f32 v230, v100, v101
    v_cvt_pk_bf16_f32 v231, v102, v103
    ds_read_b64_tr_b16 v[144:145], v179 offset:0
    ds_read_b64_tr_b16 v[146:147], v183 offset:0
    ds_read_b64_tr_b16 v[148:149], v187 offset:0
    ds_read_b64_tr_b16 v[150:151], v191 offset:0
    ds_read_b64_tr_b16 v[152:153], v195 offset:0
    ds_read_b64_tr_b16 v[154:155], v199 offset:0
    ds_read_b64_tr_b16 v[156:157], v203 offset:0
    ds_read_b64_tr_b16 v[158:159], v207 offset:0
    s_add_u32 m0, s57, 25600
    s_add_u32 s67, s66, 1331200
    buffer_load_dwordx4 v172, s[40:43], s67 offen nt lds
    s_add_u32 m0, s57, 26624
    s_add_u32 s67, s66, 1341440
    buffer_load_dwordx4 v173, s[40:43], s67 offen nt lds
    s_waitcnt lgkmcnt(8)
    v_dot2_f32_bf16 v96, v134, v214, 0
    v_dot2_f32_bf16 v97, v129, v214, 0
    v_dot2_f32_bf16 v98, v135, v214, 0
    v_dot2_f32_bf16 v99, v130, v214, 0
    v_dot2_f32_bf16 v100, v136, v214, 0
    v_dot2_f32_bf16 v101, v131, v214, 0
    v_dot2_f32_bf16 v102, v137, v214, 0
    v_dot2_f32_bf16 v103, v132, v214, 0
    v_dot2_f32_bf16 v96, v135, v210, v96
    v_dot2_f32_bf16 v97, v130, v210, v97
    v_dot2_f32_bf16 v98, v136, v210, v98
    v_dot2_f32_bf16 v99, v131, v210, v99
    v_dot2_f32_bf16 v100, v137, v210, v100
    v_dot2_f32_bf16 v101, v132, v210, v101
    v_dot2_f32_bf16 v102, v138, v210, v102
    v_dot2_f32_bf16 v103, v133, v210, v103
    v_lshlrev_b32 v104, 16, v140
    v_and_b32 v105, s60, v140
    v_lshlrev_b32 v106, 16, v141
    v_and_b32 v107, s60, v141
    v_lshlrev_b32 v108, 16, v142
    v_and_b32 v109, s60, v142
    v_lshlrev_b32 v110, 16, v143
    v_and_b32 v111, s60, v143
    v_pk_mul_f32 v[96:97], v[96:97], v[104:105]
    v_pk_mul_f32 v[98:99], v[98:99], v[106:107]
    v_pk_mul_f32 v[100:101], v[100:101], v[108:109]
    v_pk_mul_f32 v[102:103], v[102:103], v[110:111]
    v_cvt_pk_bf16_f32 v232, v96, v97
    v_cvt_pk_bf16_f32 v233, v98, v99
    v_cvt_pk_bf16_f32 v234, v100, v101
    v_cvt_pk_bf16_f32 v235, v102, v103
    s_waitcnt lgkmcnt(0)
    v_dot2_f32_bf16 v96, v150, v215, 0
    v_dot2_f32_bf16 v97, v145, v215, 0
    v_dot2_f32_bf16 v98, v151, v215, 0
    v_dot2_f32_bf16 v99, v146, v215, 0
    v_dot2_f32_bf16 v100, v152, v215, 0
    v_dot2_f32_bf16 v101, v147, v215, 0
    v_dot2_f32_bf16 v102, v153, v215, 0
    v_dot2_f32_bf16 v103, v148, v215, 0
    v_dot2_f32_bf16 v96, v151, v211, v96
    v_dot2_f32_bf16 v97, v146, v211, v97
    v_dot2_f32_bf16 v98, v152, v211, v98
    v_dot2_f32_bf16 v99, v147, v211, v99
    v_dot2_f32_bf16 v100, v153, v211, v100
    v_dot2_f32_bf16 v101, v148, v211, v101
    v_dot2_f32_bf16 v102, v154, v211, v102
    v_dot2_f32_bf16 v103, v149, v211, v103
    v_lshlrev_b32 v104, 16, v156
    v_and_b32 v105, s60, v156
    v_lshlrev_b32 v106, 16, v157
    v_and_b32 v107, s60, v157
    v_lshlrev_b32 v108, 16, v158
    v_and_b32 v109, s60, v158
    v_lshlrev_b32 v110, 16, v159
    v_and_b32 v111, s60, v159
    v_pk_mul_f32 v[96:97], v[96:97], v[104:105]
    v_pk_mul_f32 v[98:99], v[98:99], v[106:107]
    v_pk_mul_f32 v[100:101], v[100:101], v[108:109]
    v_pk_mul_f32 v[102:103], v[102:103], v[110:111]
    v_cvt_pk_bf16_f32 v236, v96, v97
    v_cvt_pk_bf16_f32 v237, v98, v99
    v_cvt_pk_bf16_f32 v238, v100, v101
    v_cvt_pk_bf16_f32 v239, v102, v103
    s_add_u32 s55, s56, 0
    buffer_store_dwordx4 v[224:227], v120, s[44:47], s55 offen sc1
    s_add_u32 s55, s56, 65536
    buffer_store_dwordx4 v[228:231], v120, s[44:47], s55 offen sc1
    s_add_u32 s55, s56, 131072
    buffer_store_dwordx4 v[232:235], v120, s[44:47], s55 offen sc1
    s_add_u32 s55, s56, 196608
    buffer_store_dwordx4 v[236:239], v120, s[44:47], s55 offen sc1
    s_waitcnt vmcnt(13)
    v_readfirstlane_b32 s3, v8
    s_nop 0
    s_cmp_eq_u32 s3, 0
    s_cbranch_scc1 SLOW7
BACK7:
    ds_read_b64_tr_b16 v[128:129], v176 offset:9216
    ds_read_b64_tr_b16 v[130:131], v180 offset:9216
    ds_read_b64_tr_b16 v[132:133], v184 offset:9216
    ds_read_b64_tr_b16 v[134:135], v188 offset:9216
    ds_read_b64_tr_b16 v[136:137], v192 offset:9216
    ds_read_b64_tr_b16 v[138:139], v196 offset:9216
    ds_read_b64_tr_b16 v[140:141], v200 offset:9216
    ds_read_b64_tr_b16 v[142:143], v204 offset:9216
    ds_read_b64_tr_b16 v[144:145], v177 offset:9216
    ds_read_b64_tr_b16 v[146:147], v181 offset:9216
    ds_read_b64_tr_b16 v[148:149], v185 offset:9216
    ds_read_b64_tr_b16 v[150:151], v189 offset:9216
    ds_read_b64_tr_b16 v[152:153], v193 offset:9216
    ds_read_b64_tr_b16 v[154:155], v197 offset:9216
    ds_read_b64_tr_b16 v[156:157], v201 offset:9216
    ds_read_b64_tr_b16 v[158:159], v205 offset:9216
    s_add_u32 m0, s57, 27648
    s_add_u32 s67, s66, 1955840
    buffer_load_dwordx4 v170, s[36:39], s67 offen nt lds
    s_add_u32 m0, s57, 28672
    s_add_u32 s67, s66, 1966080
    buffer_load_dwordx4 v171, s[36:39], s67 offen nt lds
    s_add_u32 m0, s57, 29696
    s_add_u32 s67, s66, 1976320
    buffer_load_dwordx4 v172, s[36:39], s67 offen nt lds
    s_add_u32 m0, s57, 30720
    s_add_u32 s67, s66, 1986560
    buffer_load_dwordx4 v173, s[36:39], s67 offen nt lds
    s_add_u32 m0, s57, 31744
    s_add_u32 s67, s66, 1996800
    buffer_load_dwordx4 v170, s[36:39], s67 offen nt lds
    s_waitcnt lgkmcnt(8)
    v_dot2_f32_bf16 v96, v134, v212, 0
    v_dot2_f32_bf16 v97, v129, v212, 0
    v_dot2_f32_bf16 v98, v135, v212, 0
    v_dot2_f32_bf16 v99, v130, v212, 0
    v_dot2_f32_bf16 v100, v136, v212, 0
    v_dot2_f32_bf16 v101, v131, v212, 0
    v_dot2_f32_bf16 v102, v137, v212, 0
    v_dot2_f32_bf16 v103, v132, v212, 0
    v_dot2_f32_bf16 v96, v135, v208, v96
    v_dot2_f32_bf16 v97, v130, v208, v97
    v_dot2_f32_bf16 v98, v136, v208, v98
    v_dot2_f32_bf16 v99, v131, v208, v99
    v_dot2_f32_bf16 v100, v137, v208, v100
    v_dot2_f32_bf16 v101, v132, v208, v101
    v_dot2_f32_bf16 v102, v138, v208, v102
    v_dot2_f32_bf16 v103, v133, v208, v103
    v_lshlrev_b32 v104, 16, v140
    v_and_b32 v105, s60, v140
    v_lshlrev_b32 v106, 16, v141
    v_and_b32 v107, s60, v141
    v_lshlrev_b32 v108, 16, v142
    v_and_b32 v109, s60, v142
    v_lshlrev_b32 v110, 16, v143
    v_and_b32 v111, s60, v143
    v_pk_mul_f32 v[96:97], v[96:97], v[104:105]
    v_pk_mul_f32 v[98:99], v[98:99], v[106:107]
    v_pk_mul_f32 v[100:101], v[100:101], v[108:109]
    v_pk_mul_f32 v[102:103], v[102:103], v[110:111]
    v_cvt_pk_bf16_f32 v224, v96, v97
    v_cvt_pk_bf16_f32 v225, v98, v99
    v_cvt_pk_bf16_f32 v226, v100, v101
    v_cvt_pk_bf16_f32 v227, v102, v103
    ds_read_b64_tr_b16 v[128:129], v178 offset:9216
    ds_read_b64_tr_b16 v[130:131], v182 offset:9216
    ds_read_b64_tr_b16 v[132:133], v186 offset:9216
    ds_read_b64_tr_b16 v[134:135], v190 offset:9216
    ds_read_b64_tr_b16 v[136:137], v194 offset:9216
    ds_read_b64_tr_b16 v[138:139], v198 offset:9216
    ds_read_b64_tr_b16 v[140:141], v202 offset:9216
    ds_read_b64_tr_b16 v[142:143], v206 offset:9216
    s_add_u32 m0, s57, 32768
    s_add_u32 s67, s66, 1966080
    buffer_load_dwordx4 v170, s[40:43], s67 offen nt lds
    s_add_u32 m0, s57, 33792
    s_add_u32 s67, s66, 1976320
    buffer_load_dwordx4 v171, s[40:43], s67 offen nt lds
    s_add_u32 m0, s57, 34816
    s_add_u32 s67, s66, 1986560
    buffer_load_dwordx4 v172, s[40:43], s67 offen nt lds
    s_add_u32 m0, s57, 35840
    s_add_u32 s67, s66, 1996800
    buffer_load_dwordx4 v173, s[40:43], s67 offen nt lds
    s_waitcnt lgkmcnt(8)
    v_dot2_f32_bf16 v96, v150, v213, 0
    v_dot2_f32_bf16 v97, v145, v213, 0
    v_dot2_f32_bf16 v98, v151, v213, 0
    v_dot2_f32_bf16 v99, v146, v213, 0
    v_dot2_f32_bf16 v100, v152, v213, 0
    v_dot2_f32_bf16 v101, v147, v213, 0
    v_dot2_f32_bf16 v102, v153, v213, 0
    v_dot2_f32_bf16 v103, v148, v213, 0
    v_dot2_f32_bf16 v96, v151, v209, v96
    v_dot2_f32_bf16 v97, v146, v209, v97
    v_dot2_f32_bf16 v98, v152, v209, v98
    v_dot2_f32_bf16 v99, v147, v209, v99
    v_dot2_f32_bf16 v100, v153, v209, v100
    v_dot2_f32_bf16 v101, v148, v209, v101
    v_dot2_f32_bf16 v102, v154, v209, v102
    v_dot2_f32_bf16 v103, v149, v209, v103
    v_lshlrev_b32 v104, 16, v156
    v_and_b32 v105, s60, v156
    v_lshlrev_b32 v106, 16, v157
    v_and_b32 v107, s60, v157
    v_lshlrev_b32 v108, 16, v158
    v_and_b32 v109, s60, v158
    v_lshlrev_b32 v110, 16, v159
    v_and_b32 v111, s60, v159
    v_pk_mul_f32 v[96:97], v[96:97], v[104:105]
    v_pk_mul_f32 v[98:99], v[98:99], v[106:107]
    v_pk_mul_f32 v[100:101], v[100:101], v[108:109]
    v_pk_mul_f32 v[102:103], v[102:103], v[110:111]
    v_cvt_pk_bf16_f32 v228, v96, v97
    v_cvt_pk_bf16_f32 v229, v98, v99
    v_cvt_pk_bf16_f32 v230, v100, v101
    v_cvt_pk_bf16_f32 v231, v102, v103
    ds_read_b64_tr_b16 v[144:145], v179 offset:9216
    ds_read_b64_tr_b16 v[146:147], v183 offset:9216
    ds_read_b64_tr_b16 v[148:149], v187 offset:9216
    ds_read_b64_tr_b16 v[150:151], v191 offset:9216
    ds_read_b64_tr_b16 v[152:153], v195 offset:9216
    ds_read_b64_tr_b16 v[154:155], v199 offset:9216
    ds_read_b64_tr_b16 v[156:157], v203 offset:9216
    ds_read_b64_tr_b16 v[158:159], v207 offset:9216
    s_lshl_b32 s66, s62, 2
    s_add_u32 s66, s66, s30
    s_lshl_b32 s67, s66, 12
    s_mov_b32 m0, s64
    s_nop 0
    buffer_load_dwordx4 v16, s[48:51], s67 offen offset:0 nt lds
    buffer_load_dwordx4 v16, s[48:51], s67 offen offset:1024 nt lds
    buffer_load_dwordx4 v16, s[48:51], s67 offen offset:2048 nt lds
    buffer_load_dwordx4 v16, s[48:51], s67 offen offset:3072 nt lds
    v_mov_b32 v80, s67
    s_lshl_b32 s66, s66, 1
    v_mov_b32 v81, s66
    global_load_ushort v80, v80, s[12:13]
    global_load_ushort v81, v81, s[14:15]
    s_waitcnt lgkmcnt(8)
    v_dot2_f32_bf16 v96, v134, v214, 0
    v_dot2_f32_bf16 v97, v129, v214, 0
    v_dot2_f32_bf16 v98, v135, v214, 0
    v_dot2_f32_bf16 v99, v130, v214, 0
    v_dot2_f32_bf16 v100, v136, v214, 0
    v_dot2_f32_bf16 v101, v131, v214, 0
    v_dot2_f32_bf16 v102, v137, v214, 0
    v_dot2_f32_bf16 v103, v132, v214, 0
    v_dot2_f32_bf16 v96, v135, v210, v96
    v_dot2_f32_bf16 v97, v130, v210, v97
    v_dot2_f32_bf16 v98, v136, v210, v98
    v_dot2_f32_bf16 v99, v131, v210, v99
    v_dot2_f32_bf16 v100, v137, v210, v100
    v_dot2_f32_bf16 v101, v132, v210, v101
    v_dot2_f32_bf16 v102, v138, v210, v102
    v_dot2_f32_bf16 v103, v133, v210, v103
    v_lshlrev_b32 v104, 16, v140
    v_and_b32 v105, s60, v140
    v_lshlrev_b32 v106, 16, v141
    v_and_b32 v107, s60, v141
    v_lshlrev_b32 v108, 16, v142
    v_and_b32 v109, s60, v142
    v_lshlrev_b32 v110, 16, v143
    v_and_b32 v111, s60, v143
    v_pk_mul_f32 v[96:97], v[96:97], v[104:105]
    v_pk_mul_f32 v[98:99], v[98:99], v[106:107]
    v_pk_mul_f32 v[100:101], v[100:101], v[108:109]
    v_pk_mul_f32 v[102:103], v[102:103], v[110:111]
    v_cvt_pk_bf16_f32 v232, v96, v97
    v_cvt_pk_bf16_f32 v233, v98, v99
    v_cvt_pk_bf16_f32 v234, v100, v101
    v_cvt_pk_bf16_f32 v235, v102, v103
    s_waitcnt lgkmcnt(0)
    v_dot2_f32_bf16 v96, v150, v215, 0
    v_dot2_f32_bf16 v97, v145, v215, 0
    v_dot2_f32_bf16 v98, v151, v215, 0
    v_dot2_f32_bf16 v99, v146, v215, 0
    v_dot2_f32_bf16 v100, v152, v215, 0
    v_dot2_f32_bf16 v101, v147, v215, 0
    v_dot2_f32_bf16 v102, v153, v215, 0
    v_dot2_f32_bf16 v103, v148, v215, 0
    v_dot2_f32_bf16 v96, v151, v211, v96
    v_dot2_f32_bf16 v97, v146, v211, v97
    v_dot2_f32_bf16 v98, v152, v211, v98
    v_dot2_f32_bf16 v99, v147, v211, v99
    v_dot2_f32_bf16 v100, v153, v211, v100
    v_dot2_f32_bf16 v101, v148, v211, v101
    v_dot2_f32_bf16 v102, v154, v211, v102
    v_dot2_f32_bf16 v103, v149, v211, v103
    v_lshlrev_b32 v104, 16, v156
    v_and_b32 v105, s60, v156
    v_lshlrev_b32 v106, 16, v157
    v_and_b32 v107, s60, v157
    v_lshlrev_b32 v108, 16, v158
    v_and_b32 v109, s60, v158
    v_lshlrev_b32 v110, 16, v159
    v_and_b32 v111, s60, v159
    v_pk_mul_f32 v[96:97], v[96:97], v[104:105]
    v_pk_mul_f32 v[98:99], v[98:99], v[106:107]
    v_pk_mul_f32 v[100:101], v[100:101], v[108:109]
    v_pk_mul_f32 v[102:103], v[102:103], v[110:111]
    v_cvt_pk_bf16_f32 v236, v96, v97
    v_cvt_pk_bf16_f32 v237, v98, v99
    v_cvt_pk_bf16_f32 v238, v100, v101
    v_cvt_pk_bf16_f32 v239, v102, v103
    s_waitcnt vmcnt(15)
    buffer_store_dword v8, v9, s[44:47], s78 offen offset:0 sc1
    s_add_u32 s55, s56, 4096
    buffer_store_dwordx4 v[224:227], v120, s[44:47], s55 offen sc1
    s_add_u32 s55, s56, 69632
    buffer_store_dwordx4 v[228:231], v120, s[44:47], s55 offen sc1
    s_add_u32 s55, s56, 135168
    buffer_store_dwordx4 v[232:235], v120, s[44:47], s55 offen sc1
    s_add_u32 s55, s56, 200704
    buffer_store_dwordx4 v[236:239], v120, s[44:47], s55 offen sc1
    ds_read_b64_tr_b16 v[128:129], v176 offset:18432
    ds_read_b64_tr_b16 v[130:131], v180 offset:18432
    ds_read_b64_tr_b16 v[132:133], v184 offset:18432
    ds_read_b64_tr_b16 v[134:135], v188 offset:18432
    ds_read_b64_tr_b16 v[136:137], v192 offset:18432
    ds_read_b64_tr_b16 v[138:139], v196 offset:18432
    ds_read_b64_tr_b16 v[140:141], v200 offset:18432
    ds_read_b64_tr_b16 v[142:143], v204 offset:18432
    ds_read_b64_tr_b16 v[144:145], v177 offset:18432
    ds_read_b64_tr_b16 v[146:147], v181 offset:18432
    ds_read_b64_tr_b16 v[148:149], v185 offset:18432
    ds_read_b64_tr_b16 v[150:151], v189 offset:18432
    ds_read_b64_tr_b16 v[152:153], v193 offset:18432
    ds_read_b64_tr_b16 v[154:155], v197 offset:18432
    ds_read_b64_tr_b16 v[156:157], v201 offset:18432
    ds_read_b64_tr_b16 v[158:159], v205 offset:18432
    s_waitcnt lgkmcnt(8)
    v_dot2_f32_bf16 v96, v134, v212, 0
    v_dot2_f32_bf16 v97, v129, v212, 0
    v_dot2_f32_bf16 v98, v135, v212, 0
    v_dot2_f32_bf16 v99, v130, v212, 0
    v_dot2_f32_bf16 v100, v136, v212, 0
    v_dot2_f32_bf16 v101, v131, v212, 0
    v_dot2_f32_bf16 v102, v137, v212, 0
    v_dot2_f32_bf16 v103, v132, v212, 0
    v_dot2_f32_bf16 v96, v135, v208, v96
    v_dot2_f32_bf16 v97, v130, v208, v97
    v_dot2_f32_bf16 v98, v136, v208, v98
    v_dot2_f32_bf16 v99, v131, v208, v99
    v_dot2_f32_bf16 v100, v137, v208, v100
    v_dot2_f32_bf16 v101, v132, v208, v101
    v_dot2_f32_bf16 v102, v138, v208, v102
    v_dot2_f32_bf16 v103, v133, v208, v103
    v_lshlrev_b32 v104, 16, v140
    v_and_b32 v105, s60, v140
    v_lshlrev_b32 v106, 16, v141
    v_and_b32 v107, s60, v141
    v_lshlrev_b32 v108, 16, v142
    v_and_b32 v109, s60, v142
    v_lshlrev_b32 v110, 16, v143
    v_and_b32 v111, s60, v143
    v_pk_mul_f32 v[96:97], v[96:97], v[104:105]
    v_pk_mul_f32 v[98:99], v[98:99], v[106:107]
    v_pk_mul_f32 v[100:101], v[100:101], v[108:109]
    v_pk_mul_f32 v[102:103], v[102:103], v[110:111]
    v_cvt_pk_bf16_f32 v224, v96, v97
    v_cvt_pk_bf16_f32 v225, v98, v99
    v_cvt_pk_bf16_f32 v226, v100, v101
    v_cvt_pk_bf16_f32 v227, v102, v103
    ds_read_b64_tr_b16 v[128:129], v178 offset:18432
    ds_read_b64_tr_b16 v[130:131], v182 offset:18432
CHX0:
PAD6:
    s_cbranch_execz WRETX
    ds_read_b64_tr_b16 v[132:133], v186 offset:18432
    ds_read_b64_tr_b16 v[134:135], v190 offset:18432
    ds_read_b64_tr_b16 v[136:137], v194 offset:18432
    ds_read_b64_tr_b16 v[138:139], v198 offset:18432
    ds_read_b64_tr_b16 v[140:141], v202 offset:18432
    ds_read_b64_tr_b16 v[142:143], v206 offset:18432
    v_mov_b32 v1, s64
    v_mov_b32 v2, s71
    v_cmp_gt_u32 vcc, 32, v0
    s_nop 1
    v_cndmask_b32 v1, v2, v1, vcc
    v_and_b32 v2, 31, v0
    v_lshl_add_u32 v1, v2, 2, v1
    v_subrev_u32 v1, 128, v1
    v_mov_b32 v2, 0
    ds_write_b32 v1, v2
    s_waitcnt lgkmcnt(9)
    v_dot2_f32_bf16 v96, v150, v213, 0
    v_dot2_f32_bf16 v97, v145, v213, 0
    v_dot2_f32_bf16 v98, v151, v213, 0
    v_dot2_f32_bf16 v99, v146, v213, 0
    v_dot2_f32_bf16 v100, v152, v213, 0
    v_dot2_f32_bf16 v101, v147, v213, 0
    v_dot2_f32_bf16 v102, v153, v213, 0
    v_dot2_f32_bf16 v103, v148, v213, 0
    v_dot2_f32_bf16 v96, v151, v209, v96
    v_dot2_f32_bf16 v97, v146, v209, v97
    v_dot2_f32_bf16 v98, v152, v209, v98
    v_dot2_f32_bf16 v99, v147, v209, v99
    v_dot2_f32_bf16 v100, v153, v209, v100
    v_dot2_f32_bf16 v101, v148, v209, v101
    v_dot2_f32_bf16 v102, v154, v209, v102
    v_dot2_f32_bf16 v103, v149, v209, v103
    v_lshlrev_b32 v104, 16, v156
    v_and_b32 v105, s60, v156
    v_lshlrev_b32 v106, 16, v157
    v_and_b32 v107, s60, v157
    v_lshlrev_b32 v108, 16, v158
    v_and_b32 v109, s60, v158
    v_lshlrev_b32 v110, 16, v159
    v_and_b32 v111, s60, v159
    v_pk_mul_f32 v[96:97], v[96:97], v[104:105]
    v_pk_mul_f32 v[98:99], v[98:99], v[106:107]
    v_pk_mul_f32 v[100:101], v[100:101], v[108:109]
    v_pk_mul_f32 v[102:103], v[102:103], v[110:111]
    v_cvt_pk_bf16_f32 v228, v96, v97
    v_cvt_pk_bf16_f32 v229, v98, v99
    v_cvt_pk_bf16_f32 v230, v100, v101
    v_cvt_pk_bf16_f32 v231, v102, v103
    ds_read_b64_tr_b16 v[144:145], v179 offset:18432
    ds_read_b64_tr_b16 v[146:147], v183 offset:18432
    ds_read_b64_tr_b16 v[148:149], v187 offset:18432
    ds_read_b64_tr_b16 v[150:151], v191 offset:18432
    ds_read_b64_tr_b16 v[152:153], v195 offset:18432
    ds_read_b64_tr_b16 v[154:155], v199 offset:18432
    ds_read_b64_tr_b16 v[156:157], v203 offset:18432
    ds_read_b64_tr_b16 v[158:159], v207 offset:18432
    s_add_u32 s52, s64, 9216
    s_add_u32 s53, s71, 9216
    v_mov_b32 v1, s52
    v_mov_b32 v2, s53
    v_cmp_gt_u32 vcc, 32, v0
    s_nop 1
    v_cndmask_b32 v1, v2, v1, vcc
    v_and_b32 v2, 31, v0
    v_lshl_add_u32 v1, v2, 2, v1
    v_subrev_u32 v1, 128, v1
    v_mov_b32 v2, 0
    ds_write_b32 v1, v2
    s_mov_b32 s70, 0
    s_mov_b32 s79, 0
    s_mov_b32 s71, 4294838272
    v_mov_b32 v23, 0x80000000
    v_mov_b32 v24, 0x80000000
    v_add_u32 v22, 18432, v14
    s_waitcnt lgkmcnt(10)
    v_dot2_f32_bf16 v96, v134, v214, 0
    v_dot2_f32_bf16 v97, v129, v214, 0
    v_dot2_f32_bf16 v98, v135, v214, 0
    v_dot2_f32_bf16 v99, v130, v214, 0
    v_dot2_f32_bf16 v100, v136, v214, 0
    v_dot2_f32_bf16 v101, v131, v214, 0
    v_dot2_f32_bf16 v102, v137, v214, 0
    v_dot2_f32_bf16 v103, v132, v214, 0
    v_dot2_f32_bf16 v96, v135, v210, v96
    v_dot2_f32_bf16 v97, v130, v210, v97
    v_dot2_f32_bf16 v98, v136, v210, v98
    v_dot2_f32_bf16 v99, v131, v210, v99
    v_dot2_f32_bf16 v100, v137, v210, v100
    v_dot2_f32_bf16 v101, v132, v210, v101
    v_dot2_f32_bf16 v102, v138, v210, v102
    v_dot2_f32_bf16 v103, v133, v210, v103
    v_lshlrev_b32 v104, 16, v140
    v_and_b32 v105, s60, v140
    v_lshlrev_b32 v106, 16, v141
    v_and_b32 v107, s60, v141
    v_lshlrev_b32 v108, 16, v142
    v_and_b32 v109, s60, v142
    v_lshlrev_b32 v110, 16, v143
    v_and_b32 v111, s60, v143
    v_pk_mul_f32 v[96:97], v[96:97], v[104:105]
    v_pk_mul_f32 v[98:99], v[98:99], v[106:107]
    v_pk_mul_f32 v[100:101], v[100:101], v[108:109]
    v_pk_mul_f32 v[102:103], v[102:103], v[110:111]
    v_cvt_pk_bf16_f32 v232, v96, v97
    v_cvt_pk_bf16_f32 v233, v98, v99
    v_cvt_pk_bf16_f32 v234, v100, v101
    v_cvt_pk_bf16_f32 v235, v102, v103
    buffer_load_dword v94, v27, s[44:47], 0 offen sc1
    s_waitcnt lgkmcnt(1)
    v_dot2_f32_bf16 v96, v150, v215, 0
    v_dot2_f32_bf16 v97, v145, v215, 0
    v_dot2_f32_bf16 v98, v151, v215, 0
    v_dot2_f32_bf16 v99, v146, v215, 0
    v_dot2_f32_bf16 v100, v152, v215, 0
    v_dot2_f32_bf16 v101, v147, v215, 0
    v_dot2_f32_bf16 v102, v153, v215, 0
    v_dot2_f32_bf16 v103, v148, v215, 0
    v_dot2_f32_bf16 v96, v151, v211, v96
    v_dot2_f32_bf16 v97, v146, v211, v97
    v_dot2_f32_bf16 v98, v152, v211, v98
    v_dot2_f32_bf16 v99, v147, v211, v99
    v_dot2_f32_bf16 v100, v153, v211, v100
    v_dot2_f32_bf16 v101, v148, v211, v101
    v_dot2_f32_bf16 v102, v154, v211, v102
    v_dot2_f32_bf16 v103, v149, v211, v103
    v_lshlrev_b32 v104, 16, v156
    v_and_b32 v105, s60, v156
    v_lshlrev_b32 v106, 16, v157
    v_and_b32 v107, s60, v157
    v_lshlrev_b32 v108, 16, v158
    v_and_b32 v109, s60, v158
    v_lshlrev_b32 v110, 16, v159
    v_and_b32 v111, s60, v159
    v_pk_mul_f32 v[96:97], v[96:97], v[104:105]
    v_pk_mul_f32 v[98:99], v[98:99], v[106:107]
    v_pk_mul_f32 v[100:101], v[100:101], v[108:109]
    v_pk_mul_f32 v[102:103], v[102:103], v[110:111]
    v_cvt_pk_bf16_f32 v236, v96, v97
    v_cvt_pk_bf16_f32 v237, v98, v99
    v_cvt_pk_bf16_f32 v238, v100, v101
    v_cvt_pk_bf16_f32 v239, v102, v103
    s_waitcnt vmcnt(1)
    buffer_store_dword v8, v9, s[44:47], s78 offen offset:1024 sc1
    s_add_u32 s55, s56, 8192
    buffer_store_dwordx4 v[224:227], v120, s[44:47], s55 offen sc1
    s_add_u32 s55, s56, 73728
    buffer_store_dwordx4 v[228:231], v120, s[44:47], s55 offen sc1
    s_add_u32 s55, s56, 139264
    buffer_store_dwordx4 v[232:235], v120, s[44:47], s55 offen sc1
    s_add_u32 s55, s56, 204800
    buffer_store_dwordx4 v[236:239], v120, s[44:47], s55 offen sc1
    ds_read_b64_tr_b16 v[128:129], v176 offset:27648
    ds_read_b64_tr_b16 v[130:131], v180 offset:27648
    ds_read_b64_tr_b16 v[132:133], v184 offset:27648
    ds_read_b64_tr_b16 v[134:135], v188 offset:27648
    ds_read_b64_tr_b16 v[136:137], v192 offset:27648
    ds_read_b64_tr_b16 v[138:139], v196 offset:27648
    ds_read_b64_tr_b16 v[140:141], v200 offset:27648
    ds_read_b64_tr_b16 v[142:143], v204 offset:27648
    ds_read_b64_tr_b16 v[144:145], v177 offset:27648
    ds_read_b64_tr_b16 v[146:147], v181 offset:27648
    ds_read_b64_tr_b16 v[148:149], v185 offset:27648
    ds_read_b64_tr_b16 v[150:151], v189 offset:27648
    ds_read_b64_tr_b16 v[152:153], v193 offset:27648
    ds_read_b64_tr_b16 v[154:155], v197 offset:27648
    ds_read_b64_tr_b16 v[156:157], v201 offset:27648
    ds_read_b64_tr_b16 v[158:159], v205 offset:27648
    v_lshlrev_b32 v80, 16, v80
    v_lshlrev_b32 v81, 16, v81
    v_add_f32 v80, v80, v81
    v_cvt_pk_bf16_f32 v80, v80, v80
    v_mov_b32 v81, s64
    ds_write_b16 v81, v80
    s_waitcnt lgkmcnt(9)
    v_dot2_f32_bf16 v96, v134, v212, 0
    v_dot2_f32_bf16 v97, v129, v212, 0
    v_dot2_f32_bf16 v98, v135, v212, 0
    v_dot2_f32_bf16 v99, v130, v212, 0
    v_dot2_f32_bf16 v100, v136, v212, 0
    v_dot2_f32_bf16 v101, v131, v212, 0
    v_dot2_f32_bf16 v102, v137, v212, 0
    v_dot2_f32_bf16 v103, v132, v212, 0
    v_dot2_f32_bf16 v96, v135, v208, v96
    v_dot2_f32_bf16 v97, v130, v208, v97
    v_dot2_f32_bf16 v98, v136, v208, v98
    v_dot2_f32_bf16 v99, v131, v208, v99
    v_dot2_f32_bf16 v100, v137, v208, v100
    v_dot2_f32_bf16 v101, v132, v208, v101
    v_dot2_f32_bf16 v102, v138, v208, v102
    v_dot2_f32_bf16 v103, v133, v208, v103
    v_lshlrev_b32 v104, 16, v140
    v_and_b32 v105, s60, v140
    v_lshlrev_b32 v106, 16, v141
    v_and_b32 v107, s60, v141
    v_lshlrev_b32 v108, 16, v142
    v_and_b32 v109, s60, v142
    v_lshlrev_b32 v110, 16, v143
    v_and_b32 v111, s60, v143
    v_pk_mul_f32 v[96:97], v[96:97], v[104:105]
    v_pk_mul_f32 v[98:99], v[98:99], v[106:107]
    v_pk_mul_f32 v[100:101], v[100:101], v[108:109]
    v_pk_mul_f32 v[102:103], v[102:103], v[110:111]
    v_cvt_pk_bf16_f32 v224, v96, v97
    v_cvt_pk_bf16_f32 v225, v98, v99
    v_cvt_pk_bf16_f32 v226, v100, v101
    v_cvt_pk_bf16_f32 v227, v102, v103
    ds_read_b64_tr_b16 v[128:129], v178 offset:27648
    ds_read_b64_tr_b16 v[130:131], v182 offset:27648
    ds_read_b64_tr_b16 v[132:133], v186 offset:27648
    ds_read_b64_tr_b16 v[134:135], v190 offset:27648
    ds_read_b64_tr_b16 v[136:137], v194 offset:27648
    ds_read_b64_tr_b16 v[138:139], v198 offset:27648
    ds_read_b64_tr_b16 v[140:141], v202 offset:27648
    ds_read_b64_tr_b16 v[142:143], v206 offset:27648
    s_waitcnt vmcnt(5)
    v_cmp_ne_u32 vcc, s3, v94
    s_nop 0
    s_cbranch_vccnz SLOW8
BACK8:
    s_lshl_b32 s68, s62, 14
    s_add_u32 s67, s68, 0
    buffer_load_dwordx4 v[64:67], v15, s[44:47], s67 offen sc1
    s_waitcnt lgkmcnt(9)
    v_dot2_f32_bf16 v96, v150, v213, 0
    v_dot2_f32_bf16 v97, v145, v213, 0
    v_dot2_f32_bf16 v98, v151, v213, 0
    v_dot2_f32_bf16 v99, v146, v213, 0
    v_dot2_f32_bf16 v100, v152, v213, 0
    v_dot2_f32_bf16 v101, v147, v213, 0
    v_dot2_f32_bf16 v102, v153, v213, 0
    v_dot2_f32_bf16 v103, v148, v213, 0
    v_dot2_f32_bf16 v96, v151, v209, v96
    v_dot2_f32_bf16 v97, v146, v209, v97
    v_dot2_f32_bf16 v98, v152, v209, v98
    v_dot2_f32_bf16 v99, v147, v209, v99
    v_dot2_f32_bf16 v100, v153, v209, v100
    v_dot2_f32_bf16 v101, v148, v209, v101
    v_dot2_f32_bf16 v102, v154, v209, v102
    v_dot2_f32_bf16 v103, v149, v209, v103
    v_lshlrev_b32 v104, 16, v156
    v_and_b32 v105, s60, v156
    v_lshlrev_b32 v106, 16, v157
    v_and_b32 v107, s60, v157
    v_lshlrev_b32 v108, 16, v158
    v_and_b32 v109, s60, v158
    v_lshlrev_b32 v110, 16, v159
    v_and_b32 v111, s60, v159
    v_pk_mul_f32 v[96:97], v[96:97], v[104:105]
    v_pk_mul_f32 v[98:99], v[98:99], v[106:107]
    v_pk_mul_f32 v[100:101], v[100:101], v[108:109]
    v_pk_mul_f32 v[102:103], v[102:103], v[110:111]
    v_cvt_pk_bf16_f32 v228, v96, v97
    v_cvt_pk_bf16_f32 v229, v98, v99
    v_cvt_pk_bf16_f32 v230, v100, v101
    v_cvt_pk_bf16_f32 v231, v102, v103
    ds_read_b64_tr_b16 v[144:145], v179 offset:27648
    ds_read_b64_tr_b16 v[146:147], v183 offset:27648
    ds_read_b64_tr_b16 v[148:149], v187 offset:27648
    ds_read_b64_tr_b16 v[150:151], v191 offset:27648
    ds_read_b64_tr_b16 v[152:153], v195 offset:27648
    ds_read_b64_tr_b16 v[154:155], v199 offset:27648
    ds_read_b64_tr_b16 v[156:157], v203 offset:27648
    ds_read_b64_tr_b16 v[158:159], v207 offset:27648
    s_waitcnt lgkmcnt(8)
    v_dot2_f32_bf16 v96, v134, v214, 0
    v_dot2_f32_bf16 v97, v129, v214, 0
    v_dot2_f32_bf16 v98, v135, v214, 0
    v_dot2_f32_bf16 v99, v130, v214, 0
    v_dot2_f32_bf16 v100, v136, v214, 0
    v_dot2_f32_bf16 v101, v131, v214, 0
    v_dot2_f32_bf16 v102, v137, v214, 0
    v_dot2_f32_bf16 v103, v132, v214, 0
    v_dot2_f32_bf16 v96, v135, v210, v96
    v_dot2_f32_bf16 v97, v130, v210, v97
    v_dot2_f32_bf16 v98, v136, v210, v98
    v_dot2_f32_bf16 v99, v131, v210, v99
    v_dot2_f32_bf16 v100, v137, v210, v100
    v_dot2_f32_bf16 v101, v132, v210, v101
    v_dot2_f32_bf16 v102, v138, v210, v102
    v_dot2_f32_bf16 v103, v133, v210, v103
    v_lshlrev_b32 v104, 16, v140
    v_and_b32 v105, s60, v140
    v_lshlrev_b32 v106, 16, v141
    v_and_b32 v107, s60, v141
    v_lshlrev_b32 v108, 16, v142
    v_and_b32 v109, s60, v142
    v_lshlrev_b32 v110, 16, v143
    v_and_b32 v111, s60, v143
    v_pk_mul_f32 v[96:97], v[96:97], v[104:105]
    v_pk_mul_f32 v[98:99], v[98:99], v[106:107]
    v_pk_mul_f32 v[100:101], v[100:101], v[108:109]
    v_pk_mul_f32 v[102:103], v[102:103], v[110:111]
    v_cvt_pk_bf16_f32 v232, v96, v97
    v_cvt_pk_bf16_f32 v233, v98, v99
    v_cvt_pk_bf16_f32 v234, v100, v101
    v_cvt_pk_bf16_f32 v235, v102, v103
    s_waitcnt lgkmcnt(0)
    v_dot2_f32_bf16 v96, v150, v215, 0
    v_dot2_f32_bf16 v97, v145, v215, 0
    v_dot2_f32_bf16 v98, v151, v215, 0
    v_dot2_f32_bf16 v99, v146, v215, 0
    v_dot2_f32_bf16 v100, v152, v215, 0
    v_dot2_f32_bf16 v101, v147, v215, 0
    v_dot2_f32_bf16 v102, v153, v215, 0
    v_dot2_f32_bf16 v103, v148, v215, 0
    v_dot2_f32_bf16 v96, v151, v211, v96
    v_dot2_f32_bf16 v97, v146, v211, v97
    v_dot2_f32_bf16 v98, v152, v211, v98
    v_dot2_f32_bf16 v99, v147, v211, v99
    v_dot2_f32_bf16 v100, v153, v211, v100
    v_dot2_f32_bf16 v101, v148, v211, v101
    v_dot2_f32_bf16 v102, v154, v211, v102
    v_dot2_f32_bf16 v103, v149, v211, v103
    v_lshlrev_b32 v104, 16, v156
    v_and_b32 v105, s60, v156
    v_lshlrev_b32 v106, 16, v157
    v_and_b32 v107, s60, v157
    v_lshlrev_b32 v108, 16, v158
    v_and_b32 v109, s60, v158
    v_lshlrev_b32 v110, 16, v159
    v_and_b32 v111, s60, v159
    v_pk_mul_f32 v[96:97], v[96:97], v[104:105]
    v_pk_mul_f32 v[98:99], v[98:99], v[106:107]
    v_pk_mul_f32 v[100:101], v[100:101], v[108:109]
    v_pk_mul_f32 v[102:103], v[102:103], v[110:111]
    v_cvt_pk_bf16_f32 v236, v96, v97
    v_cvt_pk_bf16_f32 v237, v98, v99
    v_cvt_pk_bf16_f32 v238, v100, v101
    v_cvt_pk_bf16_f32 v239, v102, v103
    s_waitcnt vmcnt(1)
    buffer_store_dword v8, v9, s[44:47], s78 offen offset:2048 sc1
    s_add_u32 s55, s56, 12288
    buffer_store_dwordx4 v[224:227], v120, s[44:47], s55 offen sc1
    s_add_u32 s55, s56, 77824
    buffer_store_dwordx4 v[228:231], v120, s[44:47], s55 offen sc1
    s_add_u32 s55, s56, 143360
    buffer_store_dwordx4 v[232:235], v120, s[44:47], s55 offen sc1
    s_add_u32 s55, s56, 208896
    buffer_store_dwordx4 v[236:239], v120, s[44:47], s55 offen sc1
    s_mov_b32 s36, s26
    s_mov_b32 s37, s27
    s_mov_b32 s38, 256
    s_mov_b32 s39, 0x20000
    s_waitcnt vmcnt(5)
    ds_write_b128 v12, v[64:67] offset:0
    s_waitcnt lgkmcnt(0)
    s_barrier
    buffer_load_dword v94, v25, s[44:47], 0 offen sc1
    ds_read_b64_tr_b16 a[0:1], v10 offset:0
    ds_read_b64_tr_b16 a[2:3], v10 offset:128
    ds_read_b64_tr_b16 a[126:127], v11 offset:0
    ds_read_b64_tr_b16 a[124:125], v11 offset:128
    ds_read_b64_tr_b16 a[4:5], v10 offset:256
    ds_read_b64_tr_b16 a[6:7], v10 offset:384
    ds_read_b64_tr_b16 a[122:123], v11 offset:256
    ds_read_b64_tr_b16 a[120:121], v11 offset:384
    s_waitcnt lgkmcnt(5)
    v_mfma_f32_16x16x32_bf16 v[128:131], a[0:3], a[126:129], 0
    ds_read_b64_tr_b16 a[8:9], v10 offset:512
    s_waitcnt lgkmcnt(5)
    v_mfma_f32_16x16x32_bf16 v[132:135], a[0:3], a[124:127], 0
    ds_read_b64_tr_b16 a[10:11], v10 offset:640
    s_waitcnt lgkmcnt(4)
    v_mfma_f32_16x16x32_bf16 v[136:139], a[4:7], a[126:129], 0
    ds_read_b64_tr_b16 a[118:119], v11 offset:512
    s_waitcnt lgkmcnt(4)
    v_mfma_f32_16x16x32_bf16 v[136:139], a[0:3], a[122:125], v[136:139]
    ds_read_b64_tr_b16 a[116:117], v11 offset:640
    v_add_f32_dpp v96, v131, v130 wave_shr:1 row_mask:0xf bank_mask:0xf bound_ctrl:0
    v_mfma_f32_16x16x32_bf16 v[140:143], a[4:7], a[124:127], 0
    ds_read_b64_tr_b16 a[12:13], v10 offset:768
    s_waitcnt lgkmcnt(5)
    v_mfma_f32_16x16x32_bf16 v[140:143], a[0:3], a[120:123], v[140:143]
    ds_read_b64_tr_b16 a[14:15], v10 offset:896
    s_waitcnt lgkmcnt(4)
    v_mfma_f32_16x16x32_bf16 v[144:147], a[8:11], a[126:129], 0
    ds_read_b64_tr_b16 a[114:115], v11 offset:768
    v_add_f32_dpp v97, v96, v129 wave_shr:1 row_mask:0xf bank_mask:0xf bound_ctrl:0
    v_mfma_f32_16x16x32_bf16 v[144:147], a[4:7], a[122:125], v[144:147]
    ds_read_b64_tr_b16 a[112:113], v11 offset:896
    s_waitcnt lgkmcnt(5)
    v_mfma_f32_16x16x32_bf16 v[144:147], a[0:3], a[118:121], v[144:147]
    ds_read_b64_tr_b16 a[16:17], v10 offset:1024
    v_add_f32_dpp v104, v97, v128 wave_shr:1 row_mask:0xf bank_mask:0xf bound_ctrl:0
    v_mfma_f32_16x16x32_bf16 v[148:151], a[8:11], a[124:127], 0
    ds_read_b64_tr_b16 a[18:19], v10 offset:1152
    v_add_f32_dpp v98, v131, v134 wave_ror:1 row_mask:0xf bank_mask:0xf
    v_mfma_f32_16x16x32_bf16 v[148:151], a[4:7], a[120:123], v[148:151]
    ds_read_b64_tr_b16 a[20:21], v10 offset:1280
    s_waitcnt lgkmcnt(7)
    v_mfma_f32_16x16x32_bf16 v[148:151], a[0:3], a[116:119], v[148:151]
    ds_read_b64_tr_b16 a[22:23], v10 offset:1408
    s_waitcnt lgkmcnt(6)
    v_mfma_f32_16x16x32_bf16 v[152:155], a[12:15], a[126:129], 0
    ds_read_b64_tr_b16 a[24:25], v10 offset:1536
    v_add_f32_dpp v99, v96, v133 wave_ror:1 row_mask:0xf bank_mask:0xf
    v_mfma_f32_16x16x32_bf16 v[152:155], a[8:11], a[122:125], v[152:155]
    ds_read_b64_tr_b16 a[26:27], v10 offset:1664
    v_add_f32_dpp v98, v135, v134 wave_shr:1 row_mask:0xf bank_mask:0xf
    v_mfma_f32_16x16x32_bf16 v[152:155], a[4:7], a[118:121], v[152:155]
    v_add_f32_dpp v105, v97, v132 wave_ror:1 row_mask:0xf bank_mask:0xf
    s_waitcnt lgkmcnt(7)
    v_mfma_f32_16x16x32_bf16 v[152:155], a[0:3], a[114:117], v[152:155]
    v_add_f32_dpp v99, v98, v133 wave_shr:1 row_mask:0xf bank_mask:0xf
    v_mfma_f32_16x16x32_bf16 v[156:159], a[12:15], a[124:127], 0
    v_mfma_f32_16x16x32_bf16 v[156:159], a[8:11], a[120:123], v[156:159]
    v_add_f32_dpp v105, v99, v132 wave_shr:1 row_mask:0xf bank_mask:0xf
    v_add_f32_dpp v100, v135, v138 wave_ror:1 row_mask:0xf bank_mask:0xf
    v_mfma_f32_16x16x32_bf16 v[156:159], a[4:7], a[116:119], v[156:159]
    v_add_f32_dpp v101, v98, v137 wave_ror:1 row_mask:0xf bank_mask:0xf
    s_waitcnt lgkmcnt(6)
    v_mfma_f32_16x16x32_bf16 v[156:159], a[0:3], a[112:115], v[156:159]
    v_add_f32_dpp v100, v139, v138 wave_shr:1 row_mask:0xf bank_mask:0xf
    s_waitcnt lgkmcnt(4)
    v_mfma_f32_16x16x32_bf16 v[160:163], a[16:19], a[126:129], 0
    ds_read_b64_tr_b16 a[28:29], v10 offset:1792
    v_add_f32_dpp v106, v99, v136 wave_ror:1 row_mask:0xf bank_mask:0xf
    v_mfma_f32_16x16x32_bf16 v[160:163], a[12:15], a[122:125], v[160:163]
    ds_read_b64_tr_b16 a[30:31], v10 offset:1920
    v_add_f32_dpp v101, v100, v137 wave_shr:1 row_mask:0xf bank_mask:0xf
    v_mfma_f32_16x16x32_bf16 v[160:163], a[8:11], a[118:121], v[160:163]
    v_cvt_pk_bf16_f32 v109, v104, v105
    v_add_f32_dpp v106, v101, v136 wave_shr:1 row_mask:0xf bank_mask:0xf
    v_mfma_f32_16x16x32_bf16 v[160:163], a[4:7], a[114:117], v[160:163]
    ds_write_b32 v13, v109 offset:0
    v_mfma_f32_16x16x32_bf16 v[164:167], a[16:19], a[124:127], 0
    v_add_f32_dpp v102, v139, v142 wave_ror:1 row_mask:0xf bank_mask:0xf
    v_add_f32_dpp v103, v100, v141 wave_ror:1 row_mask:0xf bank_mask:0xf
    v_mfma_f32_16x16x32_bf16 v[164:167], a[12:15], a[120:123], v[164:167]
    v_add_f32_dpp v102, v143, v142 wave_shr:1 row_mask:0xf bank_mask:0xf
    v_add_f32_dpp v107, v101, v140 wave_ror:1 row_mask:0xf bank_mask:0xf
    v_mfma_f32_16x16x32_bf16 v[164:167], a[8:11], a[116:119], v[164:167]
    v_add_f32_dpp v103, v102, v141 wave_shr:1 row_mask:0xf bank_mask:0xf
    v_mfma_f32_16x16x32_bf16 v[164:167], a[4:7], a[112:115], v[164:167]
    s_waitcnt lgkmcnt(3)
    v_mfma_f32_16x16x32_bf16 v[168:171], a[20:23], a[126:129], 0
    ds_read_b64_tr_b16 a[32:33], v10 offset:2048
    v_add_f32_dpp v107, v103, v140 wave_shr:1 row_mask:0xf bank_mask:0xf
    v_mfma_f32_16x16x32_bf16 v[168:171], a[16:19], a[122:125], v[168:171]
    ds_read_b64_tr_b16 a[34:35], v10 offset:2176
    v_add_f32_dpp v96, v143, v146 wave_ror:1 row_mask:0xf bank_mask:0xf
    v_mfma_f32_16x16x32_bf16 v[168:171], a[12:15], a[118:121], v[168:171]
    v_add_f32_dpp v97, v102, v145 wave_ror:1 row_mask:0xf bank_mask:0xf
    v_add_f32_dpp v96, v147, v146 wave_shr:1 row_mask:0xf bank_mask:0xf
    v_mfma_f32_16x16x32_bf16 v[168:171], a[8:11], a[114:117], v[168:171]
    v_add_f32_dpp v104, v103, v144 wave_ror:1 row_mask:0xf bank_mask:0xf
    v_add_f32_dpp v97, v96, v145 wave_shr:1 row_mask:0xf bank_mask:0xf
    v_mfma_f32_16x16x32_bf16 v[172:175], a[20:23], a[124:127], 0
    v_cvt_pk_bf16_f32 v110, v106, v107
    v_add_f32_dpp v104, v97, v144 wave_shr:1 row_mask:0xf bank_mask:0xf
    v_mfma_f32_16x16x32_bf16 v[172:175], a[16:19], a[120:123], v[172:175]
    ds_write_b32 v13, v110 offset:1024
    v_mfma_f32_16x16x32_bf16 v[172:175], a[12:15], a[116:119], v[172:175]
    v_add_f32_dpp v98, v147, v150 wave_ror:1 row_mask:0xf bank_mask:0xf
    v_add_f32_dpp v99, v96, v149 wave_ror:1 row_mask:0xf bank_mask:0xf
    v_mfma_f32_16x16x32_bf16 v[172:175], a[8:11], a[112:115], v[172:175]
    v_add_f32_dpp v98, v151, v150 wave_shr:1 row_mask:0xf bank_mask:0xf
    v_add_f32_dpp v105, v97, v148 wave_ror:1 row_mask:0xf bank_mask:0xf
    v_mfma_f32_16x16x32_bf16 v[176:179], a[24:27], a[126:129], 0
    ds_read_b64_tr_b16 a[36:37], v10 offset:2304
    v_add_f32_dpp v99, v98, v149 wave_shr:1 row_mask:0xf bank_mask:0xf
    v_mfma_f32_16x16x32_bf16 v[176:179], a[20:23], a[122:125], v[176:179]
    ds_read_b64_tr_b16 a[38:39], v10 offset:2432
    v_add_f32_dpp v105, v99, v148 wave_shr:1 row_mask:0xf bank_mask:0xf
    v_mfma_f32_16x16x32_bf16 v[176:179], a[16:19], a[118:121], v[176:179]
    s_waitcnt vmcnt(0)
    v_cmp_ne_u32 vcc, s3, v94
    s_nop 0
    s_cbranch_vccnz SLOW9
BACK9:
    v_mfma_f32_16x16x32_bf16 v[176:179], a[12:15], a[114:117], v[176:179]
    s_lshl_b32 s68, s62, 14
    s_add_u32 s67, s68, 4096
    v_mfma_f32_16x16x32_bf16 v[180:183], a[24:27], a[124:127], 0
    buffer_load_dwordx4 v[52:55], v15, s[44:47], s67 offen sc1
    v_mfma_f32_16x16x32_bf16 v[180:183], a[20:23], a[120:123], v[180:183]
    buffer_load_dword v94, v26, s[44:47], 0 offen sc1
    v_mfma_f32_16x16x32_bf16 v[180:183], a[16:19], a[116:119], v[180:183]
    buffer_store_dword v8, v9, s[44:47], s78 offen offset:3072 sc1
    v_mfma_f32_16x16x32_bf16 v[180:183], a[12:15], a[112:115], v[180:183]
    v_add_f32_dpp v100, v151, v154 wave_ror:1 row_mask:0xf bank_mask:0xf
    s_waitcnt lgkmcnt(3)
    v_mfma_f32_16x16x32_bf16 v[184:187], a[28:31], a[126:129], 0
    ds_read_b64_tr_b16 a[40:41], v10 offset:2560
    v_add_f32_dpp v101, v98, v153 wave_ror:1 row_mask:0xf bank_mask:0xf
    v_mfma_f32_16x16x32_bf16 v[184:187], a[24:27], a[122:125], v[184:187]
    ds_read_b64_tr_b16 a[42:43], v10 offset:2688
    v_add_f32_dpp v100, v155, v154 wave_shr:1 row_mask:0xf bank_mask:0xf
    v_mfma_f32_16x16x32_bf16 v[184:187], a[20:23], a[118:121], v[184:187]
    v_add_f32_dpp v106, v99, v152 wave_ror:1 row_mask:0xf bank_mask:0xf
    v_add_f32_dpp v101, v100, v153 wave_shr:1 row_mask:0xf bank_mask:0xf
    v_mfma_f32_16x16x32_bf16 v[184:187], a[16:19], a[114:117], v[184:187]
    v_cvt_pk_bf16_f32 v111, v104, v105
    v_add_f32_dpp v106, v101, v152 wave_shr:1 row_mask:0xf bank_mask:0xf
    v_mfma_f32_16x16x32_bf16 v[188:191], a[28:31], a[124:127], 0
    ds_write_b32 v13, v111 offset:2048
    v_mfma_f32_16x16x32_bf16 v[188:191], a[24:27], a[120:123], v[188:191]
    v_add_f32_dpp v102, v155, v158 wave_ror:1 row_mask:0xf bank_mask:0xf
    v_add_f32_dpp v103, v100, v157 wave_ror:1 row_mask:0xf bank_mask:0xf
    v_mfma_f32_16x16x32_bf16 v[188:191], a[20:23], a[116:119], v[188:191]
    s_add_u32 s64, s64, s69
    s_lshl_b32 s66, s65, 2
    v_mfma_f32_16x16x32_bf16 v[188:191], a[16:19], a[112:115], v[188:191]
    s_add_u32 s66, s66, s30
    s_lshl_b32 s67, s66, 12
    v_mfma_f32_16x16x32_bf16 v[192:195], a[32:35], a[126:129], 0
    s_mov_b32 m0, s64
    ds_read_b64_tr_b16 a[44:45], v10 offset:2816
    v_mfma_f32_16x16x32_bf16 v[192:195], a[28:31], a[122:125], v[192:195]
    buffer_load_dwordx4 v16, s[48:51], s67 offen offset:0 nt lds
    v_mfma_f32_16x16x32_bf16 v[192:195], a[24:27], a[118:121], v[192:195]
    buffer_load_dwordx4 v16, s[48:51], s67 offen offset:1024 nt lds
    v_mfma_f32_16x16x32_bf16 v[192:195], a[20:23], a[114:117], v[192:195]
    buffer_load_dwordx4 v16, s[48:51], s67 offen offset:2048 nt lds
    v_mfma_f32_16x16x32_bf16 v[196:199], a[32:35], a[124:127], 0
    buffer_load_dwordx4 v16, s[48:51], s67 offen offset:3072 nt lds
    v_mfma_f32_16x16x32_bf16 v[196:199], a[28:31], a[120:123], v[196:199]
    ds_read_b64_tr_b16 a[46:47], v10 offset:2944
    v_mov_b32 v80, s67
    v_mfma_f32_16x16x32_bf16 v[196:199], a[24:27], a[116:119], v[196:199]
    s_lshl_b32 s66, s66, 1
    v_mov_b32 v81, s66
    v_mfma_f32_16x16x32_bf16 v[196:199], a[20:23], a[112:115], v[196:199]
    global_load_ushort v80, v80, s[12:13]
    s_waitcnt lgkmcnt(3)
    v_mfma_f32_16x16x32_bf16 v[200:203], a[36:39], a[126:129], 0
    global_load_ushort v81, v81, s[14:15]
    ds_read_b64_tr_b16 a[48:49], v10 offset:3072
    v_mfma_f32_16x16x32_bf16 v[200:203], a[32:35], a[122:125], v[200:203]
    ds_read_b64_tr_b16 a[50:51], v10 offset:3200
    v_add_f32_dpp v102, v159, v158 wave_shr:1 row_mask:0xf bank_mask:0xf
    v_mfma_f32_16x16x32_bf16 v[200:203], a[28:31], a[118:121], v[200:203]
    v_add_f32_dpp v107, v101, v156 wave_ror:1 row_mask:0xf bank_mask:0xf
    v_add_f32_dpp v103, v102, v157 wave_shr:1 row_mask:0xf bank_mask:0xf
    v_mfma_f32_16x16x32_bf16 v[200:203], a[24:27], a[114:117], v[200:203]
    v_mfma_f32_16x16x32_bf16 v[204:207], a[36:39], a[124:127], 0
    v_add_f32_dpp v107, v103, v156 wave_shr:1 row_mask:0xf bank_mask:0xf
    v_mfma_f32_16x16x32_bf16 v[204:207], a[32:35], a[120:123], v[204:207]
    v_mfma_f32_16x16x32_bf16 v[204:207], a[28:31], a[116:119], v[204:207]
    v_mfma_f32_16x16x32_bf16 v[204:207], a[24:27], a[112:115], v[204:207]
    v_mfma_f32_16x16x32_bf16 v[208:211], a[40:43], a[126:129], 0
    v_mfma_f32_16x16x32_bf16 v[208:211], a[36:39], a[122:125], v[208:211]
    v_mfma_f32_16x16x32_bf16 v[208:211], a[32:35], a[118:121], v[208:211]
    s_waitcnt vmcnt(8)
    ds_write_b128 v12, v[52:55] offset:1024
    v_mfma_f32_16x16x32_bf16 v[208:211], a[28:31], a[114:117], v[208:211]
    v_mfma_f32_16x16x32_bf16 v[212:215], a[40:43], a[124:127], 0
    v_mfma_f32_16x16x32_bf16 v[212:215], a[36:39], a[120:123], v[212:215]
    v_mfma_f32_16x16x32_bf16 v[212:215], a[32:35], a[116:119], v[212:215]
    v_mfma_f32_16x16x32_bf16 v[212:215], a[28:31], a[112:115], v[212:215]
    s_waitcnt lgkmcnt(1)
    v_mfma_f32_16x16x32_bf16 v[216:219], a[44:47], a[126:129], 0
    s_waitcnt lgkmcnt(0)
    s_barrier
    v_mfma_f32_16x16x32_bf16 v[216:219], a[40:43], a[122:125], v[216:219]
    ds_read_b64_tr_b16 a[110:111], v11 offset:1024
    v_mfma_f32_16x16x32_bf16 v[216:219], a[36:39], a[118:121], v[216:219]
    ds_read_b64_tr_b16 a[108:109], v11 offset:1152
    v_mfma_f32_16x16x32_bf16 v[216:219], a[32:35], a[114:117], v[216:219]
    ds_read_b64_tr_b16 a[106:107], v11 offset:1280
    v_mfma_f32_16x16x32_bf16 v[220:223], a[44:47], a[124:127], 0
    ds_read_b64_tr_b16 a[104:105], v11 offset:1408
    v_mfma_f32_16x16x32_bf16 v[220:223], a[40:43], a[120:123], v[220:223]
    ds_read_b64_tr_b16 a[102:103], v11 offset:1536
    v_mfma_f32_16x16x32_bf16 v[220:223], a[36:39], a[116:119], v[220:223]
    ds_read_b64_tr_b16 a[100:101], v11 offset:1664
    v_mfma_f32_16x16x32_bf16 v[220:223], a[32:35], a[112:115], v[220:223]
    ds_read_b64_tr_b16 a[98:99], v11 offset:1792
    v_mfma_f32_16x16x32_bf16 v[224:227], a[48:51], a[126:129], 0
    s_waitcnt vmcnt(7)
    v_cmp_ne_u32 vcc, s3, v94
    s_nop 0
    s_cbranch_vccnz SLOW10
BACK10:
    v_mfma_f32_16x16x32_bf16 v[224:227], a[44:47], a[122:125], v[224:227]
    s_lshl_b32 s68, s62, 14
    s_add_u32 s67, s68, 8192
    v_mfma_f32_16x16x32_bf16 v[224:227], a[40:43], a[118:121], v[224:227]
    buffer_load_dwordx4 v[56:59], v15, s[44:47], s67 offen sc1
    v_mfma_f32_16x16x32_bf16 v[224:227], a[36:39], a[114:117], v[224:227]
CHX1:
PAD7:
    s_cbranch_execz PAD8
    ds_read_b64_tr_b16 a[96:97], v11 offset:1920
    v_mfma_f32_16x16x32_bf16 v[228:231], a[48:51], a[124:127], 0
    v_mfma_f32_16x16x32_bf16 v[228:231], a[44:47], a[120:123], v[228:231]
    v_mfma_f32_16x16x32_bf16 v[228:231], a[40:43], a[116:119], v[228:231]
    v_mfma_f32_16x16x32_bf16 v[228:231], a[36:39], a[112:115], v[228:231]
    s_waitcnt lgkmcnt(5)
    v_mfma_f32_16x16x32_bf16 v[160:163], a[0:3], a[110:113], v[160:163]
    v_mfma_f32_16x16x32_bf16 v[164:167], a[0:3], a[108:111], v[164:167]
    v_mfma_f32_16x16x32_bf16 v[168:171], a[4:7], a[110:113], v[168:171]
    v_mfma_f32_16x16x32_bf16 v[168:171], a[0:3], a[106:109], v[168:171]
    v_mfma_f32_16x16x32_bf16 v[172:175], a[4:7], a[108:111], v[172:175]
    s_waitcnt lgkmcnt(1)
    v_mfma_f32_16x16x32_bf16 v[172:175], a[0:3], a[104:107], v[172:175]
    v_mfma_f32_16x16x32_bf16 v[176:179], a[8:11], a[110:113], v[176:179]
    v_mfma_f32_16x16x32_bf16 v[176:179], a[4:7], a[106:109], v[176:179]
    v_add_f32_dpp v96, v159, v162 wave_ror:1 row_mask:0xf bank_mask:0xf
    v_add_f32_dpp v97, v102, v161 wave_ror:1 row_mask:0xf bank_mask:0xf
    v_mfma_f32_16x16x32_bf16 v[176:179], a[0:3], a[102:105], v[176:179]
    v_add_f32_dpp v96, v163, v162 wave_shr:1 row_mask:0xf bank_mask:0xf
    v_add_f32_dpp v104, v103, v160 wave_ror:1 row_mask:0xf bank_mask:0xf
    v_mfma_f32_16x16x32_bf16 v[180:183], a[8:11], a[108:111], v[180:183]
    v_add_f32_dpp v97, v96, v161 wave_shr:1 row_mask:0xf bank_mask:0xf
    v_cvt_pk_bf16_f32 v112, v106, v107
    v_mfma_f32_16x16x32_bf16 v[180:183], a[4:7], a[104:107], v[180:183]
    ds_write_b32 v13, v112 offset:3072
    v_mfma_f32_16x16x32_bf16 v[180:183], a[0:3], a[100:103], v[180:183]
    v_add_f32_dpp v104, v97, v160 wave_shr:1 row_mask:0xf bank_mask:0xf
    v_add_f32_dpp v98, v163, v166 wave_ror:1 row_mask:0xf bank_mask:0xf
    v_mfma_f32_16x16x32_bf16 v[184:187], a[12:15], a[110:113], v[184:187]
    buffer_load_dword v94, v17, s[44:47], 0 offen sc1
    v_mfma_f32_16x16x32_bf16 v[184:187], a[8:11], a[106:109], v[184:187]
    buffer_atomic_add v29, v28, s[36:39], 0 offen sc0 sc1
    v_mfma_f32_16x16x32_bf16 v[184:187], a[4:7], a[102:105], v[184:187]
    v_add_f32_dpp v99, v96, v165 wave_ror:1 row_mask:0xf bank_mask:0xf
    v_add_f32_dpp v98, v167, v166 wave_shr:1 row_mask:0xf bank_mask:0xf
    v_mfma_f32_16x16x32_bf16 v[184:187], a[0:3], a[98:101], v[184:187]
    v_add_f32_dpp v105, v97, v164 wave_ror:1 row_mask:0xf bank_mask:0xf
    v_add_f32_dpp v99, v98, v165 wave_shr:1 row_mask:0xf bank_mask:0xf
    v_mfma_f32_16x16x32_bf16 v[188:191], a[12:15], a[108:111], v[188:191]
    v_mfma_f32_16x16x32_bf16 v[188:191], a[8:11], a[104:107], v[188:191]
    v_add_f32_dpp v105, v99, v164 wave_shr:1 row_mask:0xf bank_mask:0xf
    v_add_f32_dpp v100, v167, v170 wave_ror:1 row_mask:0xf bank_mask:0xf
    v_mfma_f32_16x16x32_bf16 v[188:191], a[4:7], a[100:103], v[188:191]
    v_add_f32_dpp v101, v98, v169 wave_ror:1 row_mask:0xf bank_mask:0xf
    s_waitcnt lgkmcnt(1)
    v_mfma_f32_16x16x32_bf16 v[188:191], a[0:3], a[96:99], v[188:191]
    v_add_f32_dpp v100, v171, v170 wave_shr:1 row_mask:0xf bank_mask:0xf
    v_add_f32_dpp v106, v99, v168 wave_ror:1 row_mask:0xf bank_mask:0xf
    v_mfma_f32_16x16x32_bf16 v[192:195], a[16:19], a[110:113], v[192:195]
    v_add_f32_dpp v101, v100, v169 wave_shr:1 row_mask:0xf bank_mask:0xf
    v_cvt_pk_bf16_f32 v113, v104, v105
    v_mfma_f32_16x16x32_bf16 v[192:195], a[12:15], a[106:109], v[192:195]
    ds_write_b32 v13, v113 offset:4096
    v_mfma_f32_16x16x32_bf16 v[192:195], a[8:11], a[102:105], v[192:195]
    v_add_f32_dpp v106, v101, v168 wave_shr:1 row_mask:0xf bank_mask:0xf
    v_add_f32_dpp v102, v171, v174 wave_ror:1 row_mask:0xf bank_mask:0xf
    v_mfma_f32_16x16x32_bf16 v[192:195], a[4:7], a[98:101], v[192:195]
    v_add_f32_dpp v103, v100, v173 wave_ror:1 row_mask:0xf bank_mask:0xf
    v_add_f32_dpp v102, v175, v174 wave_shr:1 row_mask:0xf bank_mask:0xf
    v_mfma_f32_16x16x32_bf16 v[196:199], a[16:19], a[108:111], v[196:199]
    v_add_f32_dpp v107, v101, v172 wave_ror:1 row_mask:0xf bank_mask:0xf
    v_add_f32_dpp v103, v102, v173 wave_shr:1 row_mask:0xf bank_mask:0xf
    v_mfma_f32_16x16x32_bf16 v[196:199], a[12:15], a[104:107], v[196:199]
    v_mfma_f32_16x16x32_bf16 v[196:199], a[8:11], a[100:103], v[196:199]
    v_add_f32_dpp v107, v103, v172 wave_shr:1 row_mask:0xf bank_mask:0xf
    v_add_f32_dpp v96, v175, v178 wave_ror:1 row_mask:0xf bank_mask:0xf
    v_mfma_f32_16x16x32_bf16 v[196:199], a[4:7], a[96:99], v[196:199]
    v_add_f32_dpp v97, v102, v177 wave_ror:1 row_mask:0xf bank_mask:0xf
    v_add_f32_dpp v96, v179, v178 wave_shr:1 row_mask:0xf bank_mask:0xf
    v_mfma_f32_16x16x32_bf16 v[200:203], a[20:23], a[110:113], v[200:203]
    v_add_f32_dpp v104, v103, v176 wave_ror:1 row_mask:0xf bank_mask:0xf
    v_add_f32_dpp v97, v96, v177 wave_shr:1 row_mask:0xf bank_mask:0xf
    v_mfma_f32_16x16x32_bf16 v[200:203], a[16:19], a[106:109], v[200:203]
    v_cvt_pk_bf16_f32 v114, v106, v107
    v_add_f32_dpp v104, v97, v176 wave_shr:1 row_mask:0xf bank_mask:0xf
    v_mfma_f32_16x16x32_bf16 v[200:203], a[12:15], a[102:105], v[200:203]
    s_waitcnt vmcnt(2)
    ds_write_b128 v12, v[56:59] offset:2048
    v_mfma_f32_16x16x32_bf16 v[200:203], a[8:11], a[98:101], v[200:203]
    ds_write_b32 v13, v114 offset:5120
    v_mfma_f32_16x16x32_bf16 v[204:207], a[20:23], a[108:111], v[204:207]
    v_add_f32_dpp v98, v179, v182 wave_ror:1 row_mask:0xf bank_mask:0xf
    v_add_f32_dpp v99, v96, v181 wave_ror:1 row_mask:0xf bank_mask:0xf
    v_mfma_f32_16x16x32_bf16 v[204:207], a[16:19], a[104:107], v[204:207]
    v_add_f32_dpp v98, v183, v182 wave_shr:1 row_mask:0xf bank_mask:0xf
    v_add_f32_dpp v105, v97, v180 wave_ror:1 row_mask:0xf bank_mask:0xf
    v_mfma_f32_16x16x32_bf16 v[204:207], a[12:15], a[100:103], v[204:207]
    v_add_f32_dpp v99, v98, v181 wave_shr:1 row_mask:0xf bank_mask:0xf
    v_mfma_f32_16x16x32_bf16 v[204:207], a[8:11], a[96:99], v[204:207]
    v_mfma_f32_16x16x32_bf16 v[208:211], a[24:27], a[110:113], v[208:211]
    s_waitcnt lgkmcnt(1)
    s_barrier
    v_mfma_f32_16x16x32_bf16 v[208:211], a[20:23], a[106:109], v[208:211]
    ds_read_b64_tr_b16 a[94:95], v11 offset:2048
    v_add_f32_dpp v105, v99, v180 wave_shr:1 row_mask:0xf bank_mask:0xf
    v_mfma_f32_16x16x32_bf16 v[208:211], a[16:19], a[102:105], v[208:211]
    ds_read_b64_tr_b16 a[92:93], v11 offset:2176
    v_add_f32_dpp v100, v183, v186 wave_ror:1 row_mask:0xf bank_mask:0xf
    v_mfma_f32_16x16x32_bf16 v[208:211], a[12:15], a[98:101], v[208:211]
    ds_read_b64_tr_b16 a[90:91], v11 offset:2304
    v_add_f32_dpp v101, v98, v185 wave_ror:1 row_mask:0xf bank_mask:0xf
    v_mfma_f32_16x16x32_bf16 v[212:215], a[24:27], a[108:111], v[212:215]
    ds_read_b64_tr_b16 a[88:89], v11 offset:2432
    v_add_f32_dpp v100, v187, v186 wave_shr:1 row_mask:0xf bank_mask:0xf
    v_mfma_f32_16x16x32_bf16 v[212:215], a[20:23], a[104:107], v[212:215]
    ds_read_b64_tr_b16 a[86:87], v11 offset:2560
    v_add_f32_dpp v106, v99, v184 wave_ror:1 row_mask:0xf bank_mask:0xf
    v_mfma_f32_16x16x32_bf16 v[212:215], a[16:19], a[100:103], v[212:215]
    ds_read_b64_tr_b16 a[84:85], v11 offset:2688
    v_add_f32_dpp v101, v100, v185 wave_shr:1 row_mask:0xf bank_mask:0xf
    v_mfma_f32_16x16x32_bf16 v[212:215], a[12:15], a[96:99], v[212:215]
    ds_read_b64_tr_b16 a[82:83], v11 offset:2816
    v_cvt_pk_bf16_f32 v115, v104, v105
    v_mfma_f32_16x16x32_bf16 v[216:219], a[28:31], a[110:113], v[216:219]
    ds_write_b32 v13, v115 offset:6144
    v_mfma_f32_16x16x32_bf16 v[216:219], a[24:27], a[106:109], v[216:219]
    v_add_f32_dpp v106, v101, v184 wave_shr:1 row_mask:0xf bank_mask:0xf
    v_add_f32_dpp v102, v187, v190 wave_ror:1 row_mask:0xf bank_mask:0xf
    v_mfma_f32_16x16x32_bf16 v[216:219], a[20:23], a[102:105], v[216:219]
    v_add_f32_dpp v103, v100, v189 wave_ror:1 row_mask:0xf bank_mask:0xf
    v_add_f32_dpp v102, v191, v190 wave_shr:1 row_mask:0xf bank_mask:0xf
    v_mfma_f32_16x16x32_bf16 v[216:219], a[16:19], a[98:101], v[216:219]
    ds_read_b64_tr_b16 a[80:81], v11 offset:2944
    v_add_f32_dpp v107, v101, v188 wave_ror:1 row_mask:0xf bank_mask:0xf
    v_mfma_f32_16x16x32_bf16 v[220:223], a[28:31], a[108:111], v[220:223]
    v_add_f32_dpp v103, v102, v189 wave_shr:1 row_mask:0xf bank_mask:0xf
    v_mfma_f32_16x16x32_bf16 v[220:223], a[24:27], a[104:107], v[220:223]
    v_mfma_f32_16x16x32_bf16 v[220:223], a[20:23], a[100:103], v[220:223]
    s_waitcnt vmcnt(1)
    v_cmp_ne_u32 vcc, s3, v94
    s_nop 0
    s_cbranch_vccnz SLOW11
BACK11:
    v_mfma_f32_16x16x32_bf16 v[220:223], a[16:19], a[96:99], v[220:223]
    s_lshl_b32 s68, s62, 14
    s_waitcnt lgkmcnt(6)
    v_mfma_f32_16x16x32_bf16 v[192:195], a[0:3], a[94:97], v[192:195]
    s_add_u32 s67, s68, 12288
    v_add_f32_dpp v107, v103, v188 wave_shr:1 row_mask:0xf bank_mask:0xf
    v_mfma_f32_16x16x32_bf16 v[196:199], a[0:3], a[92:95], v[196:199]
    buffer_load_dwordx4 v[60:63], v15, s[44:47], s67 offen sc1
    v_mfma_f32_16x16x32_bf16 v[200:203], a[4:7], a[94:97], v[200:203]
    s_lshl_b32 s68, s65, 14
    s_add_u32 s67, s68, 0
    v_mfma_f32_16x16x32_bf16 v[200:203], a[0:3], a[90:93], v[200:203]
    buffer_load_dwordx4 v[64:67], v15, s[44:47], s67 offen sc1
    v_mfma_f32_16x16x32_bf16 v[204:207], a[4:7], a[92:95], v[204:207]
    s_add_u32 s67, s68, 4096
    s_waitcnt lgkmcnt(1)
    v_mfma_f32_16x16x32_bf16 v[204:207], a[0:3], a[88:91], v[204:207]
    buffer_load_dwordx4 v[68:71], v15, s[44:47], s67 offen sc1
    v_mfma_f32_16x16x32_bf16 v[208:211], a[8:11], a[94:97], v[208:211]
    s_add_u32 s67, s68, 8192
    v_add_f32_dpp v96, v191, v194 wave_ror:1 row_mask:0xf bank_mask:0xf
    v_mfma_f32_16x16x32_bf16 v[208:211], a[4:7], a[90:93], v[208:211]
    buffer_load_dwordx4 v[72:75], v15, s[44:47], s67 offen sc1
    v_mfma_f32_16x16x32_bf16 v[208:211], a[0:3], a[86:89], v[208:211]
    s_add_u32 s67, s68, 12288
    v_add_f32_dpp v97, v102, v193 wave_ror:1 row_mask:0xf bank_mask:0xf
    v_mfma_f32_16x16x32_bf16 v[212:215], a[8:11], a[92:95], v[212:215]
    buffer_load_dwordx4 v[76:79], v15, s[44:47], s67 offen sc1
    v_mfma_f32_16x16x32_bf16 v[212:215], a[4:7], a[88:91], v[212:215]
    v_add_f32_dpp v96, v195, v194 wave_shr:1 row_mask:0xf bank_mask:0xf
    v_add_f32_dpp v104, v103, v192 wave_ror:1 row_mask:0xf bank_mask:0xf
    v_mfma_f32_16x16x32_bf16 v[212:215], a[0:3], a[84:87], v[212:215]
    v_add_f32_dpp v97, v96, v193 wave_shr:1 row_mask:0xf bank_mask:0xf
    v_cvt_pk_bf16_f32 v108, v106, v107
    v_mfma_f32_16x16x32_bf16 v[216:219], a[12:15], a[94:97], v[216:219]
    ds_read_b64_tr_b16 a[52:53], v10 offset:3328
    v_add_f32_dpp v104, v97, v192 wave_shr:1 row_mask:0xf bank_mask:0xf
    v_mfma_f32_16x16x32_bf16 v[216:219], a[8:11], a[90:93], v[216:219]
    ds_read_b64_tr_b16 a[54:55], v10 offset:3456
    v_add_f32_dpp v98, v195, v198 wave_ror:1 row_mask:0xf bank_mask:0xf
    v_mfma_f32_16x16x32_bf16 v[216:219], a[4:7], a[86:89], v[216:219]
    ds_write_b32 v13, v108 offset:7168
    v_mfma_f32_16x16x32_bf16 v[216:219], a[0:3], a[82:85], v[216:219]
    v_add_f32_dpp v99, v96, v197 wave_ror:1 row_mask:0xf bank_mask:0xf
    v_add_f32_dpp v98, v199, v198 wave_shr:1 row_mask:0xf bank_mask:0xf
    v_mfma_f32_16x16x32_bf16 v[220:223], a[12:15], a[92:95], v[220:223]
    v_add_f32_dpp v105, v97, v196 wave_ror:1 row_mask:0xf bank_mask:0xf
    v_add_f32_dpp v99, v98, v197 wave_shr:1 row_mask:0xf bank_mask:0xf
    v_mfma_f32_16x16x32_bf16 v[220:223], a[8:11], a[88:91], v[220:223]
    v_mfma_f32_16x16x32_bf16 v[220:223], a[4:7], a[84:87], v[220:223]
    v_add_f32_dpp v105, v99, v196 wave_shr:1 row_mask:0xf bank_mask:0xf
    s_waitcnt lgkmcnt(3)
    v_mfma_f32_16x16x32_bf16 v[220:223], a[0:3], a[80:83], v[220:223]
    v_add_f32_dpp v100, v199, v202 wave_ror:1 row_mask:0xf bank_mask:0xf
    v_add_f32_dpp v101, v98, v201 wave_ror:1 row_mask:0xf bank_mask:0xf
    v_mfma_f32_16x16x32_bf16 v[224:227], a[32:35], a[110:113], v[224:227]
    v_add_f32_dpp v100, v203, v202 wave_shr:1 row_mask:0xf bank_mask:0xf
    v_add_f32_dpp v106, v99, v200 wave_ror:1 row_mask:0xf bank_mask:0xf
    v_mfma_f32_16x16x32_bf16 v[224:227], a[28:31], a[106:109], v[224:227]
    v_add_f32_dpp v101, v100, v201 wave_shr:1 row_mask:0xf bank_mask:0xf
    v_cvt_pk_bf16_f32 v109, v104, v105
    v_mfma_f32_16x16x32_bf16 v[224:227], a[24:27], a[102:105], v[224:227]
    ds_write_b32 v13, v109 offset:8192
    v_mfma_f32_16x16x32_bf16 v[224:227], a[20:23], a[98:101], v[224:227]
    v_add_f32_dpp v106, v101, v200 wave_shr:1 row_mask:0xf bank_mask:0xf
    v_add_f32_dpp v102, v203, v206 wave_ror:1 row_mask:0xf bank_mask:0xf
    v_mfma_f32_16x16x32_bf16 v[224:227], a[16:19], a[94:97], v[224:227]
    v_add_f32_dpp v103, v100, v205 wave_ror:1 row_mask:0xf bank_mask:0xf
    v_add_f32_dpp v102, v207, v206 wave_shr:1 row_mask:0xf bank_mask:0xf
    v_mfma_f32_16x16x32_bf16 v[224:227], a[12:15], a[90:93], v[224:227]
    v_add_f32_dpp v107, v101, v204 wave_ror:1 row_mask:0xf bank_mask:0xf
    v_add_f32_dpp v103, v102, v205 wave_shr:1 row_mask:0xf bank_mask:0xf
    v_mfma_f32_16x16x32_bf16 v[224:227], a[8:11], a[86:89], v[224:227]
    s_waitcnt vmcnt(5)
    v_readfirstlane_b32 s66, v29
    v_mfma_f32_16x16x32_bf16 v[224:227], a[4:7], a[82:85], v[224:227]
    s_lshl_b32 s67, s30, 2
    v_mov_b32 v30, s67
    v_mfma_f32_16x16x32_bf16 v[228:231], a[32:35], a[108:111], v[228:231]
    v_mov_b32 v29, s66
    v_add_f32_dpp v107, v103, v204 wave_shr:1 row_mask:0xf bank_mask:0xf
    v_mfma_f32_16x16x32_bf16 v[228:231], a[28:31], a[104:107], v[228:231]
    ds_write_b32 v30, v29 offset:9152
    v_mfma_f32_16x16x32_bf16 v[228:231], a[24:27], a[100:103], v[228:231]
    v_add_f32_dpp v96, v207, v210 wave_ror:1 row_mask:0xf bank_mask:0xf
    v_add_f32_dpp v97, v102, v209 wave_ror:1 row_mask:0xf bank_mask:0xf
    v_mfma_f32_16x16x32_bf16 v[228:231], a[20:23], a[96:99], v[228:231]
    v_add_f32_dpp v96, v211, v210 wave_shr:1 row_mask:0xf bank_mask:0xf
    v_add_f32_dpp v104, v103, v208 wave_ror:1 row_mask:0xf bank_mask:0xf
    v_mfma_f32_16x16x32_bf16 v[228:231], a[16:19], a[92:95], v[228:231]
    v_add_f32_dpp v97, v96, v209 wave_shr:1 row_mask:0xf bank_mask:0xf
    v_cvt_pk_bf16_f32 v110, v106, v107
    v_mfma_f32_16x16x32_bf16 v[228:231], a[12:15], a[88:91], v[228:231]
    ds_write_b32 v13, v110 offset:9216
    v_mfma_f32_16x16x32_bf16 v[228:231], a[8:11], a[84:87], v[228:231]
    v_add_f32_dpp v104, v97, v208 wave_shr:1 row_mask:0xf bank_mask:0xf
    v_add_f32_dpp v98, v211, v214 wave_ror:1 row_mask:0xf bank_mask:0xf
    v_mfma_f32_16x16x32_bf16 v[228:231], a[4:7], a[80:83], v[228:231]
    v_add_f32_dpp v99, v96, v213 wave_ror:1 row_mask:0xf bank_mask:0xf
    s_waitcnt lgkmcnt(2)
    v_mfma_f32_16x16x32_bf16 v[232:235], a[52:55], a[126:129], 0
    v_add_f32_dpp v98, v215, v214 wave_shr:1 row_mask:0xf bank_mask:0xf
    v_add_f32_dpp v105, v97, v212 wave_ror:1 row_mask:0xf bank_mask:0xf
    v_mfma_f32_16x16x32_bf16 v[232:235], a[48:51], a[122:125], v[232:235]
    v_add_f32_dpp v99, v98, v213 wave_shr:1 row_mask:0xf bank_mask:0xf
    v_mfma_f32_16x16x32_bf16 v[232:235], a[44:47], a[118:121], v[232:235]
    s_waitcnt vmcnt(4)
    ds_write_b128 v12, v[60:63] offset:3072
    v_mfma_f32_16x16x32_bf16 v[232:235], a[40:43], a[114:117], v[232:235]
    v_add_f32_dpp v105, v99, v212 wave_shr:1 row_mask:0xf bank_mask:0xf
    v_add_f32_dpp v100, v215, v218 wave_ror:1 row_mask:0xf bank_mask:0xf
    v_mfma_f32_16x16x32_bf16 v[232:235], a[36:39], a[110:113], v[232:235]
    v_add_f32_dpp v101, v98, v217 wave_ror:1 row_mask:0xf bank_mask:0xf
    v_add_f32_dpp v100, v219, v218 wave_shr:1 row_mask:0xf bank_mask:0xf
    v_mfma_f32_16x16x32_bf16 v[232:235], a[32:35], a[106:109], v[232:235]
    v_add_f32_dpp v106, v99, v216 wave_ror:1 row_mask:0xf bank_mask:0xf
    v_add_f32_dpp v101, v100, v217 wave_shr:1 row_mask:0xf bank_mask:0xf
    v_mfma_f32_16x16x32_bf16 v[232:235], a[28:31], a[102:105], v[232:235]
    v_cvt_pk_bf16_f32 v111, v104, v105
    v_add_f32_dpp v106, v101, v216 wave_shr:1 row_mask:0xf bank_mask:0xf
    v_mfma_f32_16x16x32_bf16 v[232:235], a[24:27], a[98:101], v[232:235]
    ds_write_b32 v13, v111 offset:10240
    v_mfma_f32_16x16x32_bf16 v[232:235], a[20:23], a[94:97], v[232:235]
    s_waitcnt lgkmcnt(1)
    s_barrier
    v_mfma_f32_16x16x32_bf16 v[232:235], a[16:19], a[90:93], v[232:235]
    ds_read_b64_tr_b16 a[78:79], v11 offset:3072
    v_mov_b32 v30, 0
    v_mfma_f32_16x16x32_bf16 v[232:235], a[12:15], a[86:89], v[232:235]
    ds_read_b32 v29, v30 offset:9152
    ds_read_b64_tr_b16 a[76:77], v11 offset:3200
    v_mfma_f32_16x16x32_bf16 v[232:235], a[8:11], a[82:85], v[232:235]
    ds_read_b64_tr_b16 a[74:75], v11 offset:3328
    v_add_f32_dpp v102, v219, v222 wave_ror:1 row_mask:0xf bank_mask:0xf
    v_mfma_f32_16x16x32_bf16 v[236:239], a[52:55], a[124:127], 0
    ds_read_b64_tr_b16 a[72:73], v11 offset:3456
    v_add_f32_dpp v103, v100, v221 wave_ror:1 row_mask:0xf bank_mask:0xf
    v_mfma_f32_16x16x32_bf16 v[236:239], a[48:51], a[120:123], v[236:239]
    ds_read_b64_tr_b16 a[56:57], v10 offset:3584
    v_add_f32_dpp v102, v223, v222 wave_shr:1 row_mask:0xf bank_mask:0xf
    v_mfma_f32_16x16x32_bf16 v[236:239], a[44:47], a[116:119], v[236:239]
    ds_read_b64_tr_b16 a[58:59], v10 offset:3712
    v_add_f32_dpp v107, v101, v220 wave_ror:1 row_mask:0xf bank_mask:0xf
    v_mfma_f32_16x16x32_bf16 v[236:239], a[40:43], a[112:115], v[236:239]
    v_add_f32_dpp v103, v102, v221 wave_shr:1 row_mask:0xf bank_mask:0xf
    v_mfma_f32_16x16x32_bf16 v[236:239], a[36:39], a[108:111], v[236:239]
    v_mfma_f32_16x16x32_bf16 v[236:239], a[32:35], a[104:107], v[236:239]
    v_add_f32_dpp v107, v103, v220 wave_shr:1 row_mask:0xf bank_mask:0xf
    v_mfma_f32_16x16x32_bf16 v[236:239], a[28:31], a[100:103], v[236:239]
    v_mfma_f32_16x16x32_bf16 v[236:239], a[24:27], a[96:99], v[236:239]
    v_mfma_f32_16x16x32_bf16 v[236:239], a[20:23], a[92:95], v[236:239]
    ds_read_b64_tr_b16 a[70:71], v11 offset:3584
    v_mfma_f32_16x16x32_bf16 v[236:239], a[16:19], a[88:91], v[236:239]
    v_mfma_f32_16x16x32_bf16 v[236:239], a[12:15], a[84:87], v[236:239]
    v_mfma_f32_16x16x32_bf16 v[236:239], a[8:11], a[80:83], v[236:239]
    s_waitcnt lgkmcnt(4)
    v_mfma_f32_16x16x32_bf16 v[224:227], a[0:3], a[78:81], v[224:227]
    v_mfma_f32_16x16x32_bf16 v[228:231], a[0:3], a[76:79], v[228:231]
    v_add_u32 v12, s69, v12
    v_mfma_f32_16x16x32_bf16 v[232:235], a[4:7], a[78:81], v[232:235]
    s_waitcnt vmcnt(3)
    ds_write_b128 v12, v[64:67] offset:0
    v_mfma_f32_16x16x32_bf16 v[232:235], a[0:3], a[74:77], v[232:235]
    s_waitcnt vmcnt(2)
    ds_write_b128 v12, v[68:71] offset:1024
    v_mfma_f32_16x16x32_bf16 v[236:239], a[4:7], a[76:79], v[236:239]
    s_waitcnt vmcnt(1)
    ds_write_b128 v12, v[72:75] offset:2048
    s_waitcnt lgkmcnt(4)
    v_mfma_f32_16x16x32_bf16 v[236:239], a[0:3], a[72:75], v[236:239]
    s_waitcnt vmcnt(0)
    ds_write_b128 v12, v[76:79] offset:3072
    v_mfma_f32_16x16x32_bf16 v[240:243], a[56:59], a[126:129], 0
    v_lshlrev_b32 v80, 16, v80
    v_lshlrev_b32 v81, 16, v81
    v_mfma_f32_16x16x32_bf16 v[240:243], a[52:55], a[122:125], v[240:243]
    v_add_f32 v80, v80, v81
    v_cvt_pk_bf16_f32 v80, v80, v80
    v_mfma_f32_16x16x32_bf16 v[240:243], a[48:51], a[118:121], v[240:243]
    v_mov_b32 v81, s64
    v_add_f32_dpp v96, v223, v226 wave_ror:1 row_mask:0xf bank_mask:0xf
    v_mfma_f32_16x16x32_bf16 v[240:243], a[44:47], a[114:117], v[240:243]
    ds_write_b16 v81, v80
    v_mfma_f32_16x16x32_bf16 v[240:243], a[40:43], a[110:113], v[240:243]
    v_add_f32_dpp v97, v102, v225 wave_ror:1 row_mask:0xf bank_mask:0xf
    v_add_f32_dpp v96, v227, v226 wave_shr:1 row_mask:0xf bank_mask:0xf
    v_mfma_f32_16x16x32_bf16 v[240:243], a[36:39], a[106:109], v[240:243]
    ds_read_b64_tr_b16 a[68:69], v11 offset:3712
    v_add_f32_dpp v104, v103, v224 wave_ror:1 row_mask:0xf bank_mask:0xf
    v_mfma_f32_16x16x32_bf16 v[240:243], a[32:35], a[102:105], v[240:243]
    ds_read_b64_tr_b16 a[60:61], v10 offset:3840
    v_add_f32_dpp v97, v96, v225 wave_shr:1 row_mask:0xf bank_mask:0xf
    v_mfma_f32_16x16x32_bf16 v[240:243], a[28:31], a[98:101], v[240:243]
    ds_read_b64_tr_b16 a[62:63], v10 offset:3968
    v_cvt_pk_bf16_f32 v112, v106, v107
    v_mfma_f32_16x16x32_bf16 v[240:243], a[24:27], a[94:97], v[240:243]
    ds_write_b32 v13, v112 offset:11264
    v_mfma_f32_16x16x32_bf16 v[240:243], a[20:23], a[90:93], v[240:243]
    v_add_f32_dpp v104, v97, v224 wave_shr:1 row_mask:0xf bank_mask:0xf
    v_add_f32_dpp v98, v227, v230 wave_ror:1 row_mask:0xf bank_mask:0xf
    v_mfma_f32_16x16x32_bf16 v[240:243], a[16:19], a[86:89], v[240:243]
    v_add_f32_dpp v99, v96, v229 wave_ror:1 row_mask:0xf bank_mask:0xf
    v_add_f32_dpp v98, v231, v230 wave_shr:1 row_mask:0xf bank_mask:0xf
    v_mfma_f32_16x16x32_bf16 v[240:243], a[12:15], a[82:85], v[240:243]
    v_add_f32_dpp v105, v97, v228 wave_ror:1 row_mask:0xf bank_mask:0xf
    v_add_f32_dpp v99, v98, v229 wave_shr:1 row_mask:0xf bank_mask:0xf
    v_mfma_f32_16x16x32_bf16 v[240:243], a[8:11], a[78:81], v[240:243]
    v_mfma_f32_16x16x32_bf16 v[240:243], a[4:7], a[74:77], v[240:243]
    v_add_f32_dpp v105, v99, v228 wave_shr:1 row_mask:0xf bank_mask:0xf
    s_waitcnt lgkmcnt(5)
    v_mfma_f32_16x16x32_bf16 v[240:243], a[0:3], a[70:73], v[240:243]
    v_add_f32_dpp v100, v231, v234 wave_ror:1 row_mask:0xf bank_mask:0xf
    v_add_f32_dpp v101, v98, v233 wave_ror:1 row_mask:0xf bank_mask:0xf
    v_mfma_f32_16x16x32_bf16 v[244:247], a[56:59], a[124:127], 0
    v_add_f32_dpp v100, v235, v234 wave_shr:1 row_mask:0xf bank_mask:0xf
    v_add_f32_dpp v106, v99, v232 wave_ror:1 row_mask:0xf bank_mask:0xf
    v_mfma_f32_16x16x32_bf16 v[244:247], a[52:55], a[120:123], v[244:247]
    v_add_f32_dpp v101, v100, v233 wave_shr:1 row_mask:0xf bank_mask:0xf
    v_cvt_pk_bf16_f32 v113, v104, v105
    v_mfma_f32_16x16x32_bf16 v[244:247], a[48:51], a[116:119], v[244:247]
    ds_write_b32 v13, v113 offset:12288
    v_mfma_f32_16x16x32_bf16 v[244:247], a[44:47], a[112:115], v[244:247]
    v_add_f32_dpp v106, v101, v232 wave_shr:1 row_mask:0xf bank_mask:0xf
    v_add_f32_dpp v102, v235, v238 wave_ror:1 row_mask:0xf bank_mask:0xf
    v_mfma_f32_16x16x32_bf16 v[244:247], a[40:43], a[108:111], v[244:247]
    v_add_f32_dpp v103, v100, v237 wave_ror:1 row_mask:0xf bank_mask:0xf
    v_add_f32_dpp v102, v239, v238 wave_shr:1 row_mask:0xf bank_mask:0xf
    v_mfma_f32_16x16x32_bf16 v[244:247], a[36:39], a[104:107], v[244:247]
    v_add_f32_dpp v107, v101, v236 wave_ror:1 row_mask:0xf bank_mask:0xf
    v_add_f32_dpp v103, v102, v237 wave_shr:1 row_mask:0xf bank_mask:0xf
    v_mfma_f32_16x16x32_bf16 v[244:247], a[32:35], a[100:103], v[244:247]
    ds_read_b64_tr_b16 a[66:67], v11 offset:3840
    v_add_f32_dpp v107, v103, v236 wave_shr:1 row_mask:0xf bank_mask:0xf
    v_mfma_f32_16x16x32_bf16 v[244:247], a[28:31], a[96:99], v[244:247]
    v_add_f32_dpp v96, v239, v242 wave_ror:1 row_mask:0xf bank_mask:0xf
    v_add_f32_dpp v97, v102, v241 wave_ror:1 row_mask:0xf bank_mask:0xf
    v_mfma_f32_16x16x32_bf16 v[244:247], a[24:27], a[92:95], v[244:247]
    v_add_f32_dpp v96, v243, v242 wave_shr:1 row_mask:0xf bank_mask:0xf
    v_add_f32_dpp v104, v103, v240 wave_ror:1 row_mask:0xf bank_mask:0xf
    v_mfma_f32_16x16x32_bf16 v[244:247], a[20:23], a[88:91], v[244:247]
    v_add_f32_dpp v97, v96, v241 wave_shr:1 row_mask:0xf bank_mask:0xf
    v_cvt_pk_bf16_f32 v114, v106, v107
    v_mfma_f32_16x16x32_bf16 v[244:247], a[16:19], a[84:87], v[244:247]
    ds_write_b32 v13, v114 offset:13312
    v_mfma_f32_16x16x32_bf16 v[244:247], a[12:15], a[80:83], v[244:247]
    v_mov_b32 v23, v14
    v_mov_b32 v24, v9
    v_mfma_f32_16x16x32_bf16 v[244:247], a[8:11], a[76:79], v[244:247]
    v_subrev_u32 v22, s71, v22
    s_lshl_b32 s66, s62, 14
    v_mfma_f32_16x16x32_bf16 v[244:247], a[4:7], a[72:75], v[244:247]
    s_add_u32 s79, s66, 2621440
    s_waitcnt lgkmcnt(3)
    v_mfma_f32_16x16x32_bf16 v[244:247], a[0:3], a[68:71], v[244:247]
    s_lshl_b32 s66, s30, 14
    s_lshl_b32 s67, s62, 6
    v_mfma_f32_16x16x32_bf16 v[248:251], a[60:63], a[126:129], 0
    s_add_u32 s66, s66, s67
    s_add_u32 s70, s66, 12976128
    v_mfma_f32_16x16x32_bf16 v[248:251], a[56:59], a[122:125], v[248:251]
    s_mov_b32 s62, s65
    v_readfirstlane_b32 s66, v29
    v_mfma_f32_16x16x32_bf16 v[248:251], a[52:55], a[118:121], v[248:251]
    s_nop 0
    s_add_u32 s67, s66, 56
    v_mfma_f32_16x16x32_bf16 v[248:251], a[48:51], a[114:117], v[248:251]
    s_and_b32 s68, s67, 1
    s_lshr_b32 s67, s67, 1
    v_mfma_f32_16x16x32_bf16 v[248:251], a[44:47], a[110:113], v[248:251]
    s_lshl_b32 s67, s67, 2
    s_add_u32 s68, s68, s67
    v_mfma_f32_16x16x32_bf16 v[248:251], a[40:43], a[106:109], v[248:251]
    s_add_u32 s68, s68, 2
    v_add_f32_dpp v104, v97, v240 wave_shr:1 row_mask:0xf bank_mask:0xf
    v_mfma_f32_16x16x32_bf16 v[248:251], a[36:39], a[102:105], v[248:251]
    s_cmp_lt_u32 s66, 24
    s_cselect_b32 s65, s68, s65
    s_cselect_b32 s63, 2, 1
    v_mfma_f32_16x16x32_bf16 v[248:251], a[32:35], a[98:101], v[248:251]
    s_lshr_b32 s66, s65, 4
    s_lshl_b32 s66, s66, 12
    v_mfma_f32_16x16x32_bf16 v[248:251], a[28:31], a[94:97], v[248:251]
    s_add_u32 s66, s66, 12648448
    ds_read_b64_tr_b16 a[64:65], v11 offset:3968
    v_mfma_f32_16x16x32_bf16 v[248:251], a[24:27], a[90:93], v[248:251]
    v_lshlrev_b32 v30, 6, v0
    v_add_u32 v17, s66, v30
    v_mfma_f32_16x16x32_bf16 v[248:251], a[20:23], a[86:89], v[248:251]
    v_add_f32_dpp v98, v243, v246 wave_ror:1 row_mask:0xf bank_mask:0xf
    v_add_f32_dpp v99, v96, v245 wave_ror:1 row_mask:0xf bank_mask:0xf
    v_mfma_f32_16x16x32_bf16 v[248:251], a[16:19], a[82:85], v[248:251]
    v_add_f32_dpp v98, v247, v246 wave_shr:1 row_mask:0xf bank_mask:0xf
    v_add_f32_dpp v105, v97, v244 wave_ror:1 row_mask:0xf bank_mask:0xf
    v_mfma_f32_16x16x32_bf16 v[248:251], a[12:15], a[78:81], v[248:251]
    v_add_f32_dpp v99, v98, v245 wave_shr:1 row_mask:0xf bank_mask:0xf
    v_mfma_f32_16x16x32_bf16 v[248:251], a[8:11], a[74:77], v[248:251]
    v_mfma_f32_16x16x32_bf16 v[248:251], a[4:7], a[70:73], v[248:251]
    v_add_f32_dpp v105, v99, v244 wave_shr:1 row_mask:0xf bank_mask:0xf
    s_waitcnt lgkmcnt(1)
    v_mfma_f32_16x16x32_bf16 v[248:251], a[0:3], a[66:69], v[248:251]
    v_mfma_f32_16x16x32_bf16 v[252:255], a[60:63], a[124:127], 0
    v_mfma_f32_16x16x32_bf16 v[252:255], a[56:59], a[120:123], v[252:255]
    v_mfma_f32_16x16x32_bf16 v[252:255], a[52:55], a[116:119], v[252:255]
    v_mfma_f32_16x16x32_bf16 v[252:255], a[48:51], a[112:115], v[252:255]
    v_mfma_f32_16x16x32_bf16 v[252:255], a[44:47], a[108:111], v[252:255]
    v_mfma_f32_16x16x32_bf16 v[252:255], a[40:43], a[104:107], v[252:255]
    v_mfma_f32_16x16x32_bf16 v[252:255], a[36:39], a[100:103], v[252:255]
    v_mfma_f32_16x16x32_bf16 v[252:255], a[32:35], a[96:99], v[252:255]
    v_add_f32_dpp v100, v247, v250 wave_ror:1 row_mask:0xf bank_mask:0xf
    v_add_f32_dpp v101, v98, v249 wave_ror:1 row_mask:0xf bank_mask:0xf
    v_mfma_f32_16x16x32_bf16 v[252:255], a[28:31], a[92:95], v[252:255]
    v_add_f32_dpp v100, v251, v250 wave_shr:1 row_mask:0xf bank_mask:0xf
    v_add_f32_dpp v106, v99, v248 wave_ror:1 row_mask:0xf bank_mask:0xf
    v_mfma_f32_16x16x32_bf16 v[252:255], a[24:27], a[88:91], v[252:255]
    v_add_f32_dpp v101, v100, v249 wave_shr:1 row_mask:0xf bank_mask:0xf
    v_cvt_pk_bf16_f32 v115, v104, v105
    v_mfma_f32_16x16x32_bf16 v[252:255], a[20:23], a[84:87], v[252:255]
    ds_write_b32 v13, v115 offset:14336
    v_mfma_f32_16x16x32_bf16 v[252:255], a[16:19], a[80:83], v[252:255]
    v_add_u32 v10, s69, v10
    v_add_u32 v11, s69, v11
    v_mfma_f32_16x16x32_bf16 v[252:255], a[12:15], a[76:79], v[252:255]
    s_sub_u32 s69, 0, s69
    v_add_f32_dpp v106, v101, v248 wave_shr:1 row_mask:0xf bank_mask:0xf
    v_mfma_f32_16x16x32_bf16 v[252:255], a[8:11], a[72:75], v[252:255]
    v_mfma_f32_16x16x32_bf16 v[252:255], a[4:7], a[68:71], v[252:255]
    s_waitcnt lgkmcnt(1)
    v_mfma_f32_16x16x32_bf16 v[252:255], a[0:3], a[64:67], v[252:255]
    s_nop 7
    v_add_f32_dpp v102, v251, v254 wave_ror:1 row_mask:0xf bank_mask:0xf
    v_add_f32_dpp v103, v100, v253 wave_ror:1 row_mask:0xf bank_mask:0xf
    s_nop 0
    v_add_f32_dpp v102, v255, v254 wave_shr:1 row_mask:0xf bank_mask:0xf
    v_add_f32_dpp v107, v101, v252 wave_ror:1 row_mask:0xf bank_mask:0xf
    s_nop 0
    v_add_f32_dpp v103, v102, v253 wave_shr:1 row_mask:0xf bank_mask:0xf
    s_nop 1
    v_add_f32_dpp v107, v103, v252 wave_shr:1 row_mask:0xf bank_mask:0xf
    v_cvt_pk_bf16_f32 v108, v106, v107
    ds_write_b32 v13, v108 offset:15360
    v_add_u32 v13, s71, v13
    s_sub_u32 s71, 0, s71
    s_cmp_eq_u32 s63, 1
    s_waitcnt lgkmcnt(0)
    s_barrier
    s_cbranch_scc1 CONV_LAST
    ds_read_b64_tr_b16 a[0:1], v10 offset:0
    ds_read_b64_tr_b16 a[2:3], v10 offset:128
    ds_read_b64_tr_b16 a[126:127], v11 offset:0
    ds_read_b64_tr_b16 a[124:125], v11 offset:128
    ds_read_b64_tr_b16 a[4:5], v10 offset:256
    ds_read_b64_tr_b16 a[6:7], v10 offset:384
    ds_read_b64_tr_b16 a[122:123], v11 offset:256
    ds_read_b64_tr_b16 a[120:121], v11 offset:384
    s_waitcnt lgkmcnt(5)
    v_mfma_f32_16x16x32_bf16 v[128:131], a[0:3], a[126:129], 0
    ds_read_b64_tr_b16 a[8:9], v10 offset:512
    s_waitcnt lgkmcnt(5)
    v_mfma_f32_16x16x32_bf16 v[132:135], a[0:3], a[124:127], 0
    ds_read_b64_tr_b16 a[10:11], v10 offset:640
    s_waitcnt lgkmcnt(4)
    v_mfma_f32_16x16x32_bf16 v[136:139], a[4:7], a[126:129], 0
    ds_read_b64_tr_b16 a[118:119], v11 offset:512
    s_waitcnt lgkmcnt(4)
    v_mfma_f32_16x16x32_bf16 v[136:139], a[0:3], a[122:125], v[136:139]
    ds_read_b64_tr_b16 a[116:117], v11 offset:640
    v_add_f32_dpp v96, v131, v130 wave_shr:1 row_mask:0xf bank_mask:0xf bound_ctrl:0
    v_mfma_f32_16x16x32_bf16 v[140:143], a[4:7], a[124:127], 0
    buffer_load_dword v94, v17, s[44:47], 0 offen sc1
    s_waitcnt lgkmcnt(4)
    v_mfma_f32_16x16x32_bf16 v[140:143], a[0:3], a[120:123], v[140:143]
    ds_read_b64_tr_b16 a[12:13], v10 offset:768
    ds_read_b64_tr_b16 a[14:15], v10 offset:896
    s_waitcnt lgkmcnt(4)
    v_mfma_f32_16x16x32_bf16 v[144:147], a[8:11], a[126:129], 0
    ds_read_b64_tr_b16 a[114:115], v11 offset:768
    v_add_f32_dpp v97, v96, v129 wave_shr:1 row_mask:0xf bank_mask:0xf bound_ctrl:0
    v_mfma_f32_16x16x32_bf16 v[144:147], a[4:7], a[122:125], v[144:147]
    ds_read_b64_tr_b16 a[112:113], v11 offset:896
    s_waitcnt lgkmcnt(5)
    v_mfma_f32_16x16x32_bf16 v[144:147], a[0:3], a[118:121], v[144:147]
    ds_read_b64_tr_b16 a[16:17], v10 offset:1024
    v_add_f32_dpp v104, v97, v128 wave_shr:1 row_mask:0xf bank_mask:0xf bound_ctrl:0
    v_mfma_f32_16x16x32_bf16 v[148:151], a[8:11], a[124:127], 0
    ds_read_b64_tr_b16 a[18:19], v10 offset:1152
    v_add_f32_dpp v98, v131, v134 wave_ror:1 row_mask:0xf bank_mask:0xf
    v_mfma_f32_16x16x32_bf16 v[148:151], a[4:7], a[120:123], v[148:151]
    ds_read_b64_tr_b16 a[110:111], v11 offset:1024
    s_waitcnt lgkmcnt(7)
    v_mfma_f32_16x16x32_bf16 v[148:151], a[0:3], a[116:119], v[148:151]
    ds_read_b64_tr_b16 a[108:109], v11 offset:1152
    s_waitcnt lgkmcnt(6)
    v_mfma_f32_16x16x32_bf16 v[152:155], a[12:15], a[126:129], 0
    ds_read_b64_tr_b16 a[20:21], v10 offset:1280
    v_add_f32_dpp v99, v96, v133 wave_ror:1 row_mask:0xf bank_mask:0xf
    v_mfma_f32_16x16x32_bf16 v[152:155], a[8:11], a[122:125], v[152:155]
    ds_read_b64_tr_b16 a[22:23], v10 offset:1408
    v_add_f32_dpp v98, v135, v134 wave_shr:1 row_mask:0xf bank_mask:0xf
    v_mfma_f32_16x16x32_bf16 v[152:155], a[4:7], a[118:121], v[152:155]
    ds_read_b64_tr_b16 a[106:107], v11 offset:1280
    s_waitcnt lgkmcnt(8)
    v_mfma_f32_16x16x32_bf16 v[152:155], a[0:3], a[114:117], v[152:155]
    v_add_f32_dpp v105, v97, v132 wave_ror:1 row_mask:0xf bank_mask:0xf
    v_add_f32_dpp v99, v98, v133 wave_shr:1 row_mask:0xf bank_mask:0xf
    v_mfma_f32_16x16x32_bf16 v[156:159], a[12:15], a[124:127], 0
    v_mfma_f32_16x16x32_bf16 v[156:159], a[8:11], a[120:123], v[156:159]
    ds_read_b64_tr_b16 a[104:105], v11 offset:1408
    v_add_f32_dpp v105, v99, v132 wave_shr:1 row_mask:0xf bank_mask:0xf
    v_mfma_f32_16x16x32_bf16 v[156:159], a[4:7], a[116:119], v[156:159]
    ds_read_b64_tr_b16 a[24:25], v10 offset:1536
    s_waitcnt lgkmcnt(9)
    v_mfma_f32_16x16x32_bf16 v[156:159], a[0:3], a[112:115], v[156:159]
    ds_read_b64_tr_b16 a[26:27], v10 offset:1664
    s_waitcnt lgkmcnt(8)
    v_mfma_f32_16x16x32_bf16 v[160:163], a[16:19], a[126:129], 0
    v_add_f32_dpp v100, v135, v138 wave_ror:1 row_mask:0xf bank_mask:0xf
    v_add_f32_dpp v101, v98, v137 wave_ror:1 row_mask:0xf bank_mask:0xf
    v_mfma_f32_16x16x32_bf16 v[160:163], a[12:15], a[122:125], v[160:163]
    v_add_f32_dpp v100, v139, v138 wave_shr:1 row_mask:0xf bank_mask:0xf
    v_add_f32_dpp v106, v99, v136 wave_ror:1 row_mask:0xf bank_mask:0xf
    v_mfma_f32_16x16x32_bf16 v[160:163], a[8:11], a[118:121], v[160:163]
    v_add_f32_dpp v101, v100, v137 wave_shr:1 row_mask:0xf bank_mask:0xf
    v_cvt_pk_bf16_f32 v109, v104, v105
    v_mfma_f32_16x16x32_bf16 v[160:163], a[4:7], a[114:117], v[160:163]
PAD8:
    s_cbranch_execz WRETX
    ds_write_b32 v13, v109 offset:0
    s_waitcnt lgkmcnt(7)
    v_mfma_f32_16x16x32_bf16 v[160:163], a[0:3], a[110:113], v[160:163]
    ds_read_b64_tr_b16 a[102:103], v11 offset:1536
    v_add_f32_dpp v106, v101, v136 wave_shr:1 row_mask:0xf bank_mask:0xf
    v_mfma_f32_16x16x32_bf16 v[164:167], a[16:19], a[124:127], 0
    v_add_f32_dpp v102, v139, v142 wave_ror:1 row_mask:0xf bank_mask:0xf
    v_add_f32_dpp v103, v100, v141 wave_ror:1 row_mask:0xf bank_mask:0xf
    v_mfma_f32_16x16x32_bf16 v[164:167], a[12:15], a[120:123], v[164:167]
    v_add_f32_dpp v102, v143, v142 wave_shr:1 row_mask:0xf bank_mask:0xf
    v_add_f32_dpp v107, v101, v140 wave_ror:1 row_mask:0xf bank_mask:0xf
    v_mfma_f32_16x16x32_bf16 v[164:167], a[8:11], a[116:119], v[164:167]
    v_add_f32_dpp v103, v102, v141 wave_shr:1 row_mask:0xf bank_mask:0xf
    v_mfma_f32_16x16x32_bf16 v[164:167], a[4:7], a[112:115], v[164:167]
    v_mfma_f32_16x16x32_bf16 v[164:167], a[0:3], a[108:111], v[164:167]
    v_add_f32_dpp v107, v103, v140 wave_shr:1 row_mask:0xf bank_mask:0xf
    s_waitcnt lgkmcnt(4)
    v_mfma_f32_16x16x32_bf16 v[168:171], a[20:23], a[126:129], 0
    ds_read_b128 v[48:51], v22 offset:0
    ds_read_b128 v[52:55], v22 offset:1024
    v_mfma_f32_16x16x32_bf16 v[168:171], a[16:19], a[122:125], v[168:171]
    ds_read_b128 v[56:59], v22 offset:2048
    ds_read_b128 v[60:63], v22 offset:3072
    v_mfma_f32_16x16x32_bf16 v[168:171], a[12:15], a[118:121], v[168:171]
    ds_read_b64_tr_b16 a[100:101], v11 offset:1664
    v_add_f32_dpp v96, v143, v146 wave_ror:1 row_mask:0xf bank_mask:0xf
    v_mfma_f32_16x16x32_bf16 v[168:171], a[8:11], a[114:117], v[168:171]
    ds_read_b64_tr_b16 a[28:29], v10 offset:1792
    v_add_f32_dpp v97, v102, v145 wave_ror:1 row_mask:0xf bank_mask:0xf
    v_mfma_f32_16x16x32_bf16 v[168:171], a[4:7], a[110:113], v[168:171]
    ds_read_b64_tr_b16 a[30:31], v10 offset:1920
    v_add_f32_dpp v96, v147, v146 wave_shr:1 row_mask:0xf bank_mask:0xf
    v_mfma_f32_16x16x32_bf16 v[168:171], a[0:3], a[106:109], v[168:171]
    v_add_f32_dpp v104, v103, v144 wave_ror:1 row_mask:0xf bank_mask:0xf
    v_add_f32_dpp v97, v96, v145 wave_shr:1 row_mask:0xf bank_mask:0xf
    v_mfma_f32_16x16x32_bf16 v[172:175], a[20:23], a[124:127], 0
    v_cvt_pk_bf16_f32 v110, v106, v107
    v_add_f32_dpp v104, v97, v144 wave_shr:1 row_mask:0xf bank_mask:0xf
    v_mfma_f32_16x16x32_bf16 v[172:175], a[16:19], a[120:123], v[172:175]
    ds_write_b32 v13, v110 offset:1024
    v_mfma_f32_16x16x32_bf16 v[172:175], a[12:15], a[116:119], v[172:175]
    v_add_f32_dpp v98, v147, v150 wave_ror:1 row_mask:0xf bank_mask:0xf
    v_add_f32_dpp v99, v96, v149 wave_ror:1 row_mask:0xf bank_mask:0xf
    v_mfma_f32_16x16x32_bf16 v[172:175], a[8:11], a[112:115], v[172:175]
    ds_read_b64_tr_b16 a[98:99], v11 offset:1792
    v_add_f32_dpp v98, v151, v150 wave_shr:1 row_mask:0xf bank_mask:0xf
    v_mfma_f32_16x16x32_bf16 v[172:175], a[4:7], a[108:111], v[172:175]
    v_add_f32_dpp v105, v97, v148 wave_ror:1 row_mask:0xf bank_mask:0xf
    v_add_f32_dpp v99, v98, v149 wave_shr:1 row_mask:0xf bank_mask:0xf
    v_mfma_f32_16x16x32_bf16 v[172:175], a[0:3], a[104:107], v[172:175]
    s_waitcnt lgkmcnt(9)
    v_mfma_f32_16x16x32_bf16 v[176:179], a[24:27], a[126:129], 0
    v_add_f32_dpp v105, v99, v148 wave_shr:1 row_mask:0xf bank_mask:0xf
    v_add_f32_dpp v100, v151, v154 wave_ror:1 row_mask:0xf bank_mask:0xf
    v_mfma_f32_16x16x32_bf16 v[176:179], a[20:23], a[122:125], v[176:179]
    v_add_f32_dpp v101, v98, v153 wave_ror:1 row_mask:0xf bank_mask:0xf
    v_add_f32_dpp v100, v155, v154 wave_shr:1 row_mask:0xf bank_mask:0xf
    v_mfma_f32_16x16x32_bf16 v[176:179], a[16:19], a[118:121], v[176:179]
    s_waitcnt lgkmcnt(4)
    buffer_store_dwordx4 v[48:51], v23, s[44:47], s79 offen offset:0 sc1
    v_mfma_f32_16x16x32_bf16 v[176:179], a[12:15], a[114:117], v[176:179]
    buffer_store_dwordx4 v[52:55], v23, s[44:47], s79 offen offset:1024 sc1
    v_mfma_f32_16x16x32_bf16 v[176:179], a[8:11], a[110:113], v[176:179]
    buffer_store_dwordx4 v[56:59], v23, s[44:47], s79 offen offset:2048 sc1
    v_mfma_f32_16x16x32_bf16 v[176:179], a[4:7], a[106:109], v[176:179]
    buffer_store_dwordx4 v[60:63], v23, s[44:47], s79 offen offset:3072 sc1
    v_mfma_f32_16x16x32_bf16 v[176:179], a[0:3], a[102:105], v[176:179]
    ds_read_b64_tr_b16 a[96:97], v11 offset:1920
    v_add_f32_dpp v106, v99, v152 wave_ror:1 row_mask:0xf bank_mask:0xf
    v_mfma_f32_16x16x32_bf16 v[180:183], a[24:27], a[124:127], 0
    ds_read_b64_tr_b16 a[32:33], v10 offset:2048
    v_add_f32_dpp v101, v100, v153 wave_shr:1 row_mask:0xf bank_mask:0xf
    v_mfma_f32_16x16x32_bf16 v[180:183], a[20:23], a[120:123], v[180:183]
    ds_read_b64_tr_b16 a[34:35], v10 offset:2176
    v_cvt_pk_bf16_f32 v111, v104, v105
    v_mfma_f32_16x16x32_bf16 v[180:183], a[16:19], a[116:119], v[180:183]
    ds_write_b32 v13, v111 offset:2048
    v_mfma_f32_16x16x32_bf16 v[180:183], a[12:15], a[112:115], v[180:183]
    v_add_f32_dpp v106, v101, v152 wave_shr:1 row_mask:0xf bank_mask:0xf
    v_add_f32_dpp v102, v155, v158 wave_ror:1 row_mask:0xf bank_mask:0xf
    v_mfma_f32_16x16x32_bf16 v[180:183], a[8:11], a[108:111], v[180:183]
    v_add_f32_dpp v103, v100, v157 wave_ror:1 row_mask:0xf bank_mask:0xf
    v_add_f32_dpp v102, v159, v158 wave_shr:1 row_mask:0xf bank_mask:0xf
    v_mfma_f32_16x16x32_bf16 v[180:183], a[4:7], a[104:107], v[180:183]
    v_add_f32_dpp v107, v101, v156 wave_ror:1 row_mask:0xf bank_mask:0xf
    v_add_f32_dpp v103, v102, v157 wave_shr:1 row_mask:0xf bank_mask:0xf
    v_mfma_f32_16x16x32_bf16 v[180:183], a[0:3], a[100:103], v[180:183]
    s_waitcnt lgkmcnt(4)
    v_mfma_f32_16x16x32_bf16 v[184:187], a[28:31], a[126:129], 0
    ds_read_b64_tr_b16 a[94:95], v11 offset:2048
    v_add_f32_dpp v107, v103, v156 wave_shr:1 row_mask:0xf bank_mask:0xf
    v_mfma_f32_16x16x32_bf16 v[184:187], a[24:27], a[122:125], v[184:187]
    v_add_f32_dpp v96, v159, v162 wave_ror:1 row_mask:0xf bank_mask:0xf
    v_add_f32_dpp v97, v102, v161 wave_ror:1 row_mask:0xf bank_mask:0xf
    v_mfma_f32_16x16x32_bf16 v[184:187], a[20:23], a[118:121], v[184:187]
    v_add_f32_dpp v96, v163, v162 wave_shr:1 row_mask:0xf bank_mask:0xf
    v_add_f32_dpp v104, v103, v160 wave_ror:1 row_mask:0xf bank_mask:0xf
    v_mfma_f32_16x16x32_bf16 v[184:187], a[16:19], a[114:117], v[184:187]
    v_add_f32_dpp v97, v96, v161 wave_shr:1 row_mask:0xf bank_mask:0xf
    v_cvt_pk_bf16_f32 v112, v106, v107
    v_mfma_f32_16x16x32_bf16 v[184:187], a[12:15], a[110:113], v[184:187]
    s_add_u32 s64, s64, s69
    s_lshl_b32 s66, s65, 2
    v_mfma_f32_16x16x32_bf16 v[184:187], a[8:11], a[106:109], v[184:187]
    s_add_u32 s66, s66, s30
    s_lshl_b32 s67, s66, 12
    v_mfma_f32_16x16x32_bf16 v[184:187], a[4:7], a[102:105], v[184:187]
    s_mov_b32 m0, s64
    v_add_f32_dpp v104, v97, v160 wave_shr:1 row_mask:0xf bank_mask:0xf
    v_mfma_f32_16x16x32_bf16 v[184:187], a[0:3], a[98:101], v[184:187]
    buffer_load_dwordx4 v16, s[48:51], s67 offen offset:0 nt lds
    v_mfma_f32_16x16x32_bf16 v[188:191], a[28:31], a[124:127], 0
    buffer_load_dwordx4 v16, s[48:51], s67 offen offset:1024 nt lds
    v_mfma_f32_16x16x32_bf16 v[188:191], a[24:27], a[120:123], v[188:191]
    buffer_load_dwordx4 v16, s[48:51], s67 offen offset:2048 nt lds
    v_mfma_f32_16x16x32_bf16 v[188:191], a[20:23], a[116:119], v[188:191]
    buffer_load_dwordx4 v16, s[48:51], s67 offen offset:3072 nt lds
    v_mfma_f32_16x16x32_bf16 v[188:191], a[16:19], a[112:115], v[188:191]
    ds_read_b64_tr_b16 a[92:93], v11 offset:2176
    v_mov_b32 v80, s67
    v_mfma_f32_16x16x32_bf16 v[188:191], a[12:15], a[108:111], v[188:191]
    s_lshl_b32 s66, s66, 1
    ds_read_b64_tr_b16 a[36:37], v10 offset:2304
    v_mfma_f32_16x16x32_bf16 v[188:191], a[8:11], a[104:107], v[188:191]
    ds_read_b64_tr_b16 a[38:39], v10 offset:2432
    v_mov_b32 v81, s66
    v_mfma_f32_16x16x32_bf16 v[188:191], a[4:7], a[100:103], v[188:191]
    global_load_ushort v80, v80, s[12:13]
    s_waitcnt lgkmcnt(3)
    v_mfma_f32_16x16x32_bf16 v[188:191], a[0:3], a[96:99], v[188:191]
    global_load_ushort v81, v81, s[14:15]
    v_add_f32_dpp v98, v163, v166 wave_ror:1 row_mask:0xf bank_mask:0xf
    v_mfma_f32_16x16x32_bf16 v[192:195], a[32:35], a[126:129], 0
    ds_write_b32 v13, v112 offset:3072
    v_mfma_f32_16x16x32_bf16 v[192:195], a[28:31], a[122:125], v[192:195]
    s_waitcnt vmcnt(10)
    v_cmp_ne_u32 vcc, s3, v94
    s_nop 0
    s_cbranch_vccnz SLOW12
BACK12:
    v_mfma_f32_16x16x32_bf16 v[192:195], a[24:27], a[118:121], v[192:195]
    s_lshl_b32 s68, s65, 14
    s_add_u32 s67, s68, 0
    v_mfma_f32_16x16x32_bf16 v[192:195], a[20:23], a[114:117], v[192:195]
    buffer_load_dwordx4 v[64:67], v15, s[44:47], s67 offen sc1
    v_mfma_f32_16x16x32_bf16 v[192:195], a[16:19], a[110:113], v[192:195]
    s_add_u32 s67, s68, 4096
    ds_read_b64_tr_b16 a[90:91], v11 offset:2304
    v_mfma_f32_16x16x32_bf16 v[192:195], a[12:15], a[106:109], v[192:195]
    buffer_load_dwordx4 v[68:71], v15, s[44:47], s67 offen sc1
    v_mfma_f32_16x16x32_bf16 v[192:195], a[8:11], a[102:105], v[192:195]
    s_add_u32 s67, s68, 8192
    v_add_f32_dpp v99, v96, v165 wave_ror:1 row_mask:0xf bank_mask:0xf
    v_mfma_f32_16x16x32_bf16 v[192:195], a[4:7], a[98:101], v[192:195]
    buffer_load_dwordx4 v[72:75], v15, s[44:47], s67 offen sc1
    v_mfma_f32_16x16x32_bf16 v[192:195], a[0:3], a[94:97], v[192:195]
    s_add_u32 s67, s68, 12288
    v_add_f32_dpp v98, v167, v166 wave_shr:1 row_mask:0xf bank_mask:0xf
    v_mfma_f32_16x16x32_bf16 v[196:199], a[32:35], a[124:127], 0
    buffer_load_dwordx4 v[76:79], v15, s[44:47], s67 offen sc1
    v_mfma_f32_16x16x32_bf16 v[196:199], a[28:31], a[120:123], v[196:199]
    v_add_f32_dpp v105, v97, v164 wave_ror:1 row_mask:0xf bank_mask:0xf
    v_add_f32_dpp v99, v98, v165 wave_shr:1 row_mask:0xf bank_mask:0xf
    v_mfma_f32_16x16x32_bf16 v[196:199], a[24:27], a[116:119], v[196:199]
    v_mfma_f32_16x16x32_bf16 v[196:199], a[20:23], a[112:115], v[196:199]
    v_add_f32_dpp v105, v99, v164 wave_shr:1 row_mask:0xf bank_mask:0xf
    v_add_f32_dpp v100, v167, v170 wave_ror:1 row_mask:0xf bank_mask:0xf
    v_mfma_f32_16x16x32_bf16 v[196:199], a[16:19], a[108:111], v[196:199]
    ds_read_b64_tr_b16 a[88:89], v11 offset:2432
    v_add_f32_dpp v101, v98, v169 wave_ror:1 row_mask:0xf bank_mask:0xf
    v_mfma_f32_16x16x32_bf16 v[196:199], a[12:15], a[104:107], v[196:199]
    ds_read_b64_tr_b16 a[40:41], v10 offset:2560
    v_add_f32_dpp v100, v171, v170 wave_shr:1 row_mask:0xf bank_mask:0xf
    v_mfma_f32_16x16x32_bf16 v[196:199], a[8:11], a[100:103], v[196:199]
    ds_read_b64_tr_b16 a[42:43], v10 offset:2688
    v_add_f32_dpp v106, v99, v168 wave_ror:1 row_mask:0xf bank_mask:0xf
    v_mfma_f32_16x16x32_bf16 v[196:199], a[4:7], a[96:99], v[196:199]
    v_add_f32_dpp v101, v100, v169 wave_shr:1 row_mask:0xf bank_mask:0xf
    s_waitcnt lgkmcnt(3)
    v_mfma_f32_16x16x32_bf16 v[196:199], a[0:3], a[92:95], v[196:199]
    v_cvt_pk_bf16_f32 v113, v104, v105
    v_add_f32_dpp v106, v101, v168 wave_shr:1 row_mask:0xf bank_mask:0xf
    v_mfma_f32_16x16x32_bf16 v[200:203], a[36:39], a[126:129], 0
    ds_write_b32 v13, v113 offset:4096
    v_mfma_f32_16x16x32_bf16 v[200:203], a[32:35], a[122:125], v[200:203]
    v_add_f32_dpp v102, v171, v174 wave_ror:1 row_mask:0xf bank_mask:0xf
    v_add_f32_dpp v103, v100, v173 wave_ror:1 row_mask:0xf bank_mask:0xf
    v_mfma_f32_16x16x32_bf16 v[200:203], a[28:31], a[118:121], v[200:203]
    v_add_f32_dpp v102, v175, v174 wave_shr:1 row_mask:0xf bank_mask:0xf
    v_add_f32_dpp v107, v101, v172 wave_ror:1 row_mask:0xf bank_mask:0xf
    v_mfma_f32_16x16x32_bf16 v[200:203], a[24:27], a[114:117], v[200:203]
    v_add_f32_dpp v103, v102, v173 wave_shr:1 row_mask:0xf bank_mask:0xf
    v_mfma_f32_16x16x32_bf16 v[200:203], a[20:23], a[110:113], v[200:203]
    v_mfma_f32_16x16x32_bf16 v[200:203], a[16:19], a[106:109], v[200:203]
    s_waitcnt vmcnt(10)
    buffer_store_dword v8, v24, s[44:47], s70 offen offset:0 sc1
    v_mfma_f32_16x16x32_bf16 v[200:203], a[12:15], a[102:105], v[200:203]
    ds_read_b64_tr_b16 a[86:87], v11 offset:2560
    v_add_f32_dpp v107, v103, v172 wave_shr:1 row_mask:0xf bank_mask:0xf
    v_mfma_f32_16x16x32_bf16 v[200:203], a[8:11], a[98:101], v[200:203]
    v_add_f32_dpp v96, v175, v178 wave_ror:1 row_mask:0xf bank_mask:0xf
    v_add_f32_dpp v97, v102, v177 wave_ror:1 row_mask:0xf bank_mask:0xf
    v_mfma_f32_16x16x32_bf16 v[200:203], a[4:7], a[94:97], v[200:203]
    v_add_f32_dpp v96, v179, v178 wave_shr:1 row_mask:0xf bank_mask:0xf
    v_add_f32_dpp v104, v103, v176 wave_ror:1 row_mask:0xf bank_mask:0xf
    v_mfma_f32_16x16x32_bf16 v[200:203], a[0:3], a[90:93], v[200:203]
    v_add_f32_dpp v97, v96, v177 wave_shr:1 row_mask:0xf bank_mask:0xf
    v_cvt_pk_bf16_f32 v114, v106, v107
    v_mfma_f32_16x16x32_bf16 v[204:207], a[36:39], a[124:127], 0
    ds_write_b32 v13, v114 offset:5120
    v_mfma_f32_16x16x32_bf16 v[204:207], a[32:35], a[120:123], v[204:207]
    v_add_f32_dpp v104, v97, v176 wave_shr:1 row_mask:0xf bank_mask:0xf
    v_add_f32_dpp v98, v179, v182 wave_ror:1 row_mask:0xf bank_mask:0xf
    v_mfma_f32_16x16x32_bf16 v[204:207], a[28:31], a[116:119], v[204:207]
    v_add_f32_dpp v99, v96, v181 wave_ror:1 row_mask:0xf bank_mask:0xf
    v_add_f32_dpp v98, v183, v182 wave_shr:1 row_mask:0xf bank_mask:0xf
    v_mfma_f32_16x16x32_bf16 v[204:207], a[24:27], a[112:115], v[204:207]
    v_add_f32_dpp v105, v97, v180 wave_ror:1 row_mask:0xf bank_mask:0xf
    v_add_f32_dpp v99, v98, v181 wave_shr:1 row_mask:0xf bank_mask:0xf
    v_mfma_f32_16x16x32_bf16 v[204:207], a[20:23], a[108:111], v[204:207]
    v_mfma_f32_16x16x32_bf16 v[204:207], a[16:19], a[104:107], v[204:207]
    v_add_f32_dpp v105, v99, v180 wave_shr:1 row_mask:0xf bank_mask:0xf
    v_add_f32_dpp v100, v183, v186 wave_ror:1 row_mask:0xf bank_mask:0xf
    v_mfma_f32_16x16x32_bf16 v[204:207], a[12:15], a[100:103], v[204:207]
    v_add_f32_dpp v101, v98, v185 wave_ror:1 row_mask:0xf bank_mask:0xf
    v_add_f32_dpp v100, v187, v186 wave_shr:1 row_mask:0xf bank_mask:0xf
    v_mfma_f32_16x16x32_bf16 v[204:207], a[8:11], a[96:99], v[204:207]
    ds_read_b64_tr_b16 a[84:85], v11 offset:2688
    v_add_f32_dpp v106, v99, v184 wave_ror:1 row_mask:0xf bank_mask:0xf
    v_mfma_f32_16x16x32_bf16 v[204:207], a[4:7], a[92:95], v[204:207]
    ds_read_b64_tr_b16 a[44:45], v10 offset:2816
    s_waitcnt lgkmcnt(3)
    v_mfma_f32_16x16x32_bf16 v[204:207], a[0:3], a[88:91], v[204:207]
    ds_read_b64_tr_b16 a[46:47], v10 offset:2944
    v_add_f32_dpp v101, v100, v185 wave_shr:1 row_mask:0xf bank_mask:0xf
    v_mfma_f32_16x16x32_bf16 v[208:211], a[40:43], a[126:129], 0
    v_cvt_pk_bf16_f32 v115, v104, v105
    v_add_f32_dpp v106, v101, v184 wave_shr:1 row_mask:0xf bank_mask:0xf
    v_mfma_f32_16x16x32_bf16 v[208:211], a[36:39], a[122:125], v[208:211]
    ds_write_b32 v13, v115 offset:6144
    v_mfma_f32_16x16x32_bf16 v[208:211], a[32:35], a[118:121], v[208:211]
    v_add_f32_dpp v102, v187, v190 wave_ror:1 row_mask:0xf bank_mask:0xf
    v_add_f32_dpp v103, v100, v189 wave_ror:1 row_mask:0xf bank_mask:0xf
    v_mfma_f32_16x16x32_bf16 v[208:211], a[28:31], a[114:117], v[208:211]
    v_add_f32_dpp v102, v191, v190 wave_shr:1 row_mask:0xf bank_mask:0xf
    v_add_f32_dpp v107, v101, v188 wave_ror:1 row_mask:0xf bank_mask:0xf
    v_mfma_f32_16x16x32_bf16 v[208:211], a[24:27], a[110:113], v[208:211]
    v_add_f32_dpp v103, v102, v189 wave_shr:1 row_mask:0xf bank_mask:0xf
    v_mfma_f32_16x16x32_bf16 v[208:211], a[20:23], a[106:109], v[208:211]
    v_mfma_f32_16x16x32_bf16 v[208:211], a[16:19], a[102:105], v[208:211]
    v_add_f32_dpp v107, v103, v188 wave_shr:1 row_mask:0xf bank_mask:0xf
    v_add_f32_dpp v96, v191, v194 wave_ror:1 row_mask:0xf bank_mask:0xf
    v_mfma_f32_16x16x32_bf16 v[208:211], a[12:15], a[98:101], v[208:211]
    v_add_f32_dpp v97, v102, v193 wave_ror:1 row_mask:0xf bank_mask:0xf
    v_add_f32_dpp v96, v195, v194 wave_shr:1 row_mask:0xf bank_mask:0xf
    v_mfma_f32_16x16x32_bf16 v[208:211], a[8:11], a[94:97], v[208:211]
    v_add_f32_dpp v104, v103, v192 wave_ror:1 row_mask:0xf bank_mask:0xf
    v_add_f32_dpp v97, v96, v193 wave_shr:1 row_mask:0xf bank_mask:0xf
    v_mfma_f32_16x16x32_bf16 v[208:211], a[4:7], a[90:93], v[208:211]
    ds_read_b64_tr_b16 a[82:83], v11 offset:2816
    v_cvt_pk_bf16_f32 v108, v106, v107
    v_mfma_f32_16x16x32_bf16 v[208:211], a[0:3], a[86:89], v[208:211]
    ds_write_b32 v13, v108 offset:7168
    v_mfma_f32_16x16x32_bf16 v[212:215], a[40:43], a[124:127], 0
    v_add_f32_dpp v104, v97, v192 wave_shr:1 row_mask:0xf bank_mask:0xf
    v_add_f32_dpp v98, v195, v198 wave_ror:1 row_mask:0xf bank_mask:0xf
    v_mfma_f32_16x16x32_bf16 v[212:215], a[36:39], a[120:123], v[212:215]
    v_add_f32_dpp v99, v96, v197 wave_ror:1 row_mask:0xf bank_mask:0xf
    v_add_f32_dpp v98, v199, v198 wave_shr:1 row_mask:0xf bank_mask:0xf
    v_mfma_f32_16x16x32_bf16 v[212:215], a[32:35], a[116:119], v[212:215]
    v_add_f32_dpp v105, v97, v196 wave_ror:1 row_mask:0xf bank_mask:0xf
    v_add_f32_dpp v99, v98, v197 wave_shr:1 row_mask:0xf bank_mask:0xf
    v_mfma_f32_16x16x32_bf16 v[212:215], a[28:31], a[112:115], v[212:215]
    v_mfma_f32_16x16x32_bf16 v[212:215], a[24:27], a[108:111], v[212:215]
    v_add_f32_dpp v105, v99, v196 wave_shr:1 row_mask:0xf bank_mask:0xf
    v_add_f32_dpp v100, v199, v202 wave_ror:1 row_mask:0xf bank_mask:0xf
    v_mfma_f32_16x16x32_bf16 v[212:215], a[20:23], a[104:107], v[212:215]
    v_add_f32_dpp v101, v98, v201 wave_ror:1 row_mask:0xf bank_mask:0xf
    v_add_f32_dpp v100, v203, v202 wave_shr:1 row_mask:0xf bank_mask:0xf
    v_mfma_f32_16x16x32_bf16 v[212:215], a[16:19], a[100:103], v[212:215]
    v_add_f32_dpp v106, v99, v200 wave_ror:1 row_mask:0xf bank_mask:0xf
    v_add_f32_dpp v101, v100, v201 wave_shr:1 row_mask:0xf bank_mask:0xf
    v_mfma_f32_16x16x32_bf16 v[212:215], a[12:15], a[96:99], v[212:215]
    v_cvt_pk_bf16_f32 v109, v104, v105
    v_add_f32_dpp v106, v101, v200 wave_shr:1 row_mask:0xf bank_mask:0xf
    v_mfma_f32_16x16x32_bf16 v[212:215], a[8:11], a[92:95], v[212:215]
    ds_write_b32 v13, v109 offset:8192
    v_mfma_f32_16x16x32_bf16 v[212:215], a[4:7], a[88:91], v[212:215]
    v_add_f32_dpp v102, v203, v206 wave_ror:1 row_mask:0xf bank_mask:0xf
    s_waitcnt lgkmcnt(3)
    v_mfma_f32_16x16x32_bf16 v[212:215], a[0:3], a[84:87], v[212:215]
    ds_read_b64_tr_b16 a[80:81], v11 offset:2944
    v_add_f32_dpp v103, v100, v205 wave_ror:1 row_mask:0xf bank_mask:0xf
    v_mfma_f32_16x16x32_bf16 v[216:219], a[44:47], a[126:129], 0
    ds_read_b64_tr_b16 a[48:49], v10 offset:3072
    v_add_f32_dpp v102, v207, v206 wave_shr:1 row_mask:0xf bank_mask:0xf
    v_mfma_f32_16x16x32_bf16 v[216:219], a[40:43], a[122:125], v[216:219]
    ds_read_b64_tr_b16 a[50:51], v10 offset:3200
    v_add_f32_dpp v107, v101, v204 wave_ror:1 row_mask:0xf bank_mask:0xf
    v_mfma_f32_16x16x32_bf16 v[216:219], a[36:39], a[118:121], v[216:219]
    v_add_f32_dpp v103, v102, v205 wave_shr:1 row_mask:0xf bank_mask:0xf
    v_mfma_f32_16x16x32_bf16 v[216:219], a[32:35], a[114:117], v[216:219]
    v_mfma_f32_16x16x32_bf16 v[216:219], a[28:31], a[110:113], v[216:219]
    v_add_f32_dpp v107, v103, v204 wave_shr:1 row_mask:0xf bank_mask:0xf
    v_add_f32_dpp v96, v207, v210 wave_ror:1 row_mask:0xf bank_mask:0xf
    v_mfma_f32_16x16x32_bf16 v[216:219], a[24:27], a[106:109], v[216:219]
    v_add_f32_dpp v97, v102, v209 wave_ror:1 row_mask:0xf bank_mask:0xf
    v_add_f32_dpp v96, v211, v210 wave_shr:1 row_mask:0xf bank_mask:0xf
    v_mfma_f32_16x16x32_bf16 v[216:219], a[20:23], a[102:105], v[216:219]
    v_add_f32_dpp v104, v103, v208 wave_ror:1 row_mask:0xf bank_mask:0xf
    v_add_f32_dpp v97, v96, v209 wave_shr:1 row_mask:0xf bank_mask:0xf
    v_mfma_f32_16x16x32_bf16 v[216:219], a[16:19], a[98:101], v[216:219]
    v_cvt_pk_bf16_f32 v110, v106, v107
    v_add_f32_dpp v104, v97, v208 wave_shr:1 row_mask:0xf bank_mask:0xf
    v_mfma_f32_16x16x32_bf16 v[216:219], a[12:15], a[94:97], v[216:219]
    ds_write_b32 v13, v110 offset:9216
    v_mfma_f32_16x16x32_bf16 v[216:219], a[8:11], a[90:93], v[216:219]
    v_add_f32_dpp v98, v211, v214 wave_ror:1 row_mask:0xf bank_mask:0xf
    v_add_f32_dpp v99, v96, v213 wave_ror:1 row_mask:0xf bank_mask:0xf
    v_mfma_f32_16x16x32_bf16 v[216:219], a[4:7], a[86:89], v[216:219]
    v_add_f32_dpp v98, v215, v214 wave_shr:1 row_mask:0xf bank_mask:0xf
    s_waitcnt lgkmcnt(4)
    v_mfma_f32_16x16x32_bf16 v[216:219], a[0:3], a[82:85], v[216:219]
    v_add_f32_dpp v105, v97, v212 wave_ror:1 row_mask:0xf bank_mask:0xf
    v_add_f32_dpp v99, v98, v213 wave_shr:1 row_mask:0xf bank_mask:0xf
    v_mfma_f32_16x16x32_bf16 v[220:223], a[44:47], a[124:127], 0
    ds_read_b64_tr_b16 a[78:79], v11 offset:3072
    v_add_f32_dpp v105, v99, v212 wave_shr:1 row_mask:0xf bank_mask:0xf
    v_mfma_f32_16x16x32_bf16 v[220:223], a[40:43], a[120:123], v[220:223]
    v_mfma_f32_16x16x32_bf16 v[220:223], a[36:39], a[116:119], v[220:223]
    v_mfma_f32_16x16x32_bf16 v[220:223], a[32:35], a[112:115], v[220:223]
    v_add_f32_dpp v100, v215, v218 wave_ror:1 row_mask:0xf bank_mask:0xf
    v_add_f32_dpp v101, v98, v217 wave_ror:1 row_mask:0xf bank_mask:0xf
    v_mfma_f32_16x16x32_bf16 v[220:223], a[28:31], a[108:111], v[220:223]
    v_add_f32_dpp v100, v219, v218 wave_shr:1 row_mask:0xf bank_mask:0xf
    v_add_f32_dpp v106, v99, v216 wave_ror:1 row_mask:0xf bank_mask:0xf
    v_mfma_f32_16x16x32_bf16 v[220:223], a[24:27], a[104:107], v[220:223]
    v_add_f32_dpp v101, v100, v217 wave_shr:1 row_mask:0xf bank_mask:0xf
    v_cvt_pk_bf16_f32 v111, v104, v105
    v_mfma_f32_16x16x32_bf16 v[220:223], a[20:23], a[100:103], v[220:223]
    ds_write_b32 v13, v111 offset:10240
    v_mfma_f32_16x16x32_bf16 v[220:223], a[16:19], a[96:99], v[220:223]
    v_add_f32_dpp v106, v101, v216 wave_shr:1 row_mask:0xf bank_mask:0xf
    v_mfma_f32_16x16x32_bf16 v[220:223], a[12:15], a[92:95], v[220:223]
    v_mfma_f32_16x16x32_bf16 v[220:223], a[8:11], a[88:91], v[220:223]
    v_mfma_f32_16x16x32_bf16 v[220:223], a[4:7], a[84:87], v[220:223]
    s_waitcnt lgkmcnt(2)
    v_mfma_f32_16x16x32_bf16 v[220:223], a[0:3], a[80:83], v[220:223]
    v_mfma_f32_16x16x32_bf16 v[224:227], a[48:51], a[126:129], 0
    v_mfma_f32_16x16x32_bf16 v[224:227], a[44:47], a[122:125], v[224:227]
    ds_read_b64_tr_b16 a[76:77], v11 offset:3200
    v_mfma_f32_16x16x32_bf16 v[224:227], a[40:43], a[118:121], v[224:227]
    ds_read_b64_tr_b16 a[52:53], v10 offset:3328
    v_mfma_f32_16x16x32_bf16 v[224:227], a[36:39], a[114:117], v[224:227]
    ds_read_b64_tr_b16 a[54:55], v10 offset:3456
    v_mfma_f32_16x16x32_bf16 v[224:227], a[32:35], a[110:113], v[224:227]
    v_add_f32_dpp v102, v219, v222 wave_ror:1 row_mask:0xf bank_mask:0xf
    v_add_f32_dpp v103, v100, v221 wave_ror:1 row_mask:0xf bank_mask:0xf
    v_mfma_f32_16x16x32_bf16 v[224:227], a[28:31], a[106:109], v[224:227]
    v_add_f32_dpp v102, v223, v222 wave_shr:1 row_mask:0xf bank_mask:0xf
    v_add_f32_dpp v107, v101, v220 wave_ror:1 row_mask:0xf bank_mask:0xf
    v_mfma_f32_16x16x32_bf16 v[224:227], a[24:27], a[102:105], v[224:227]
    v_add_f32_dpp v103, v102, v221 wave_shr:1 row_mask:0xf bank_mask:0xf
    v_mfma_f32_16x16x32_bf16 v[224:227], a[20:23], a[98:101], v[224:227]
    v_mfma_f32_16x16x32_bf16 v[224:227], a[16:19], a[94:97], v[224:227]
    v_add_f32_dpp v107, v103, v220 wave_shr:1 row_mask:0xf bank_mask:0xf
    v_mfma_f32_16x16x32_bf16 v[224:227], a[12:15], a[90:93], v[224:227]
    v_mfma_f32_16x16x32_bf16 v[224:227], a[8:11], a[86:89], v[224:227]
    v_mfma_f32_16x16x32_bf16 v[224:227], a[4:7], a[82:85], v[224:227]
    s_waitcnt lgkmcnt(3)
    v_mfma_f32_16x16x32_bf16 v[224:227], a[0:3], a[78:81], v[224:227]
    v_mfma_f32_16x16x32_bf16 v[228:231], a[48:51], a[124:127], 0
    v_mfma_f32_16x16x32_bf16 v[228:231], a[44:47], a[120:123], v[228:231]
    v_mfma_f32_16x16x32_bf16 v[228:231], a[40:43], a[116:119], v[228:231]
    ds_read_b64_tr_b16 a[74:75], v11 offset:3328
    v_mfma_f32_16x16x32_bf16 v[228:231], a[36:39], a[112:115], v[228:231]
    v_mfma_f32_16x16x32_bf16 v[228:231], a[32:35], a[108:111], v[228:231]
    v_mfma_f32_16x16x32_bf16 v[228:231], a[28:31], a[104:107], v[228:231]
    v_mfma_f32_16x16x32_bf16 v[228:231], a[24:27], a[100:103], v[228:231]
    v_add_f32_dpp v96, v223, v226 wave_ror:1 row_mask:0xf bank_mask:0xf
    v_add_f32_dpp v97, v102, v225 wave_ror:1 row_mask:0xf bank_mask:0xf
    v_mfma_f32_16x16x32_bf16 v[228:231], a[20:23], a[96:99], v[228:231]
    v_add_f32_dpp v96, v227, v226 wave_shr:1 row_mask:0xf bank_mask:0xf
    v_add_f32_dpp v104, v103, v224 wave_ror:1 row_mask:0xf bank_mask:0xf
    v_mfma_f32_16x16x32_bf16 v[228:231], a[16:19], a[92:95], v[228:231]
    v_add_f32_dpp v97, v96, v225 wave_shr:1 row_mask:0xf bank_mask:0xf
    v_cvt_pk_bf16_f32 v112, v106, v107
    v_mfma_f32_16x16x32_bf16 v[228:231], a[12:15], a[88:91], v[228:231]
    ds_write_b32 v13, v112 offset:11264
    v_mfma_f32_16x16x32_bf16 v[228:231], a[8:11], a[84:87], v[228:231]
    v_add_f32_dpp v104, v97, v224 wave_shr:1 row_mask:0xf bank_mask:0xf
    v_mfma_f32_16x16x32_bf16 v[228:231], a[4:7], a[80:83], v[228:231]
    s_waitcnt lgkmcnt(2)
    v_mfma_f32_16x16x32_bf16 v[228:231], a[0:3], a[76:79], v[228:231]
    v_mfma_f32_16x16x32_bf16 v[232:235], a[52:55], a[126:129], 0
    v_mfma_f32_16x16x32_bf16 v[232:235], a[48:51], a[122:125], v[232:235]
    v_mfma_f32_16x16x32_bf16 v[232:235], a[44:47], a[118:121], v[232:235]
    v_mfma_f32_16x16x32_bf16 v[232:235], a[40:43], a[114:117], v[232:235]
    ds_read_b64_tr_b16 a[72:73], v11 offset:3456
    v_mfma_f32_16x16x32_bf16 v[232:235], a[36:39], a[110:113], v[232:235]
    ds_read_b64_tr_b16 a[56:57], v10 offset:3584
    v_mfma_f32_16x16x32_bf16 v[232:235], a[32:35], a[106:109], v[232:235]
    ds_read_b64_tr_b16 a[58:59], v10 offset:3712
    v_add_f32_dpp v98, v227, v230 wave_ror:1 row_mask:0xf bank_mask:0xf
    v_mfma_f32_16x16x32_bf16 v[232:235], a[28:31], a[102:105], v[232:235]
    v_add_f32_dpp v99, v96, v229 wave_ror:1 row_mask:0xf bank_mask:0xf
    v_add_f32_dpp v98, v231, v230 wave_shr:1 row_mask:0xf bank_mask:0xf
    v_mfma_f32_16x16x32_bf16 v[232:235], a[24:27], a[98:101], v[232:235]
    v_add_f32_dpp v105, v97, v228 wave_ror:1 row_mask:0xf bank_mask:0xf
    v_add_f32_dpp v99, v98, v229 wave_shr:1 row_mask:0xf bank_mask:0xf
    v_mfma_f32_16x16x32_bf16 v[232:235], a[20:23], a[94:97], v[232:235]
    v_mfma_f32_16x16x32_bf16 v[232:235], a[16:19], a[90:93], v[232:235]
    v_add_f32_dpp v105, v99, v228 wave_shr:1 row_mask:0xf bank_mask:0xf
    v_mfma_f32_16x16x32_bf16 v[232:235], a[12:15], a[86:89], v[232:235]
    v_mfma_f32_16x16x32_bf16 v[232:235], a[8:11], a[82:85], v[232:235]
    v_mfma_f32_16x16x32_bf16 v[232:235], a[4:7], a[78:81], v[232:235]
    s_waitcnt lgkmcnt(3)
    v_mfma_f32_16x16x32_bf16 v[232:235], a[0:3], a[74:77], v[232:235]
    v_mfma_f32_16x16x32_bf16 v[236:239], a[52:55], a[124:127], 0
    v_mfma_f32_16x16x32_bf16 v[236:239], a[48:51], a[120:123], v[236:239]
    v_mfma_f32_16x16x32_bf16 v[236:239], a[44:47], a[116:119], v[236:239]
    v_mfma_f32_16x16x32_bf16 v[236:239], a[40:43], a[112:115], v[236:239]
    v_mfma_f32_16x16x32_bf16 v[236:239], a[36:39], a[108:111], v[236:239]
    ds_read_b64_tr_b16 a[70:71], v11 offset:3584
    v_mfma_f32_16x16x32_bf16 v[236:239], a[32:35], a[104:107], v[236:239]
    v_mfma_f32_16x16x32_bf16 v[236:239], a[28:31], a[100:103], v[236:239]
    v_add_f32_dpp v100, v231, v234 wave_ror:1 row_mask:0xf bank_mask:0xf
    v_add_f32_dpp v101, v98, v233 wave_ror:1 row_mask:0xf bank_mask:0xf
    v_mfma_f32_16x16x32_bf16 v[236:239], a[24:27], a[96:99], v[236:239]
    v_add_f32_dpp v100, v235, v234 wave_shr:1 row_mask:0xf bank_mask:0xf
    v_add_f32_dpp v106, v99, v232 wave_ror:1 row_mask:0xf bank_mask:0xf
    v_mfma_f32_16x16x32_bf16 v[236:239], a[20:23], a[92:95], v[236:239]
    v_add_f32_dpp v101, v100, v233 wave_shr:1 row_mask:0xf bank_mask:0xf
    v_cvt_pk_bf16_f32 v113, v104, v105
    v_mfma_f32_16x16x32_bf16 v[236:239], a[16:19], a[88:91], v[236:239]
    ds_write_b32 v13, v113 offset:12288
    v_mfma_f32_16x16x32_bf16 v[236:239], a[12:15], a[84:87], v[236:239]
    v_add_u32 v12, s69, v12
    v_add_f32_dpp v106, v101, v232 wave_shr:1 row_mask:0xf bank_mask:0xf
    v_mfma_f32_16x16x32_bf16 v[236:239], a[8:11], a[80:83], v[236:239]
    s_waitcnt vmcnt(4)
    ds_write_b128 v12, v[64:67] offset:0
    v_mfma_f32_16x16x32_bf16 v[236:239], a[4:7], a[76:79], v[236:239]
    s_waitcnt vmcnt(3)
    ds_write_b128 v12, v[68:71] offset:1024
    s_waitcnt lgkmcnt(4)
    v_mfma_f32_16x16x32_bf16 v[236:239], a[0:3], a[72:75], v[236:239]
    s_waitcnt vmcnt(2)
    ds_write_b128 v12, v[72:75] offset:2048
    v_mfma_f32_16x16x32_bf16 v[240:243], a[56:59], a[126:129], 0
    s_waitcnt vmcnt(1)
    ds_write_b128 v12, v[76:79] offset:3072
    v_mfma_f32_16x16x32_bf16 v[240:243], a[52:55], a[122:125], v[240:243]
    v_lshlrev_b32 v80, 16, v80
    v_lshlrev_b32 v81, 16, v81
    v_mfma_f32_16x16x32_bf16 v[240:243], a[48:51], a[118:121], v[240:243]
    v_add_f32 v80, v80, v81
    v_cvt_pk_bf16_f32 v80, v80, v80
    v_mfma_f32_16x16x32_bf16 v[240:243], a[44:47], a[114:117], v[240:243]
    v_mov_b32 v81, s64
    v_add_f32_dpp v102, v235, v238 wave_ror:1 row_mask:0xf bank_mask:0xf
    v_mfma_f32_16x16x32_bf16 v[240:243], a[40:43], a[110:113], v[240:243]
    ds_write_b16 v81, v80
    v_mfma_f32_16x16x32_bf16 v[240:243], a[36:39], a[106:109], v[240:243]
    ds_read_b64_tr_b16 a[68:69], v11 offset:3712
    v_add_f32_dpp v103, v100, v237 wave_ror:1 row_mask:0xf bank_mask:0xf
    v_mfma_f32_16x16x32_bf16 v[240:243], a[32:35], a[102:105], v[240:243]
    ds_read_b64_tr_b16 a[60:61], v10 offset:3840
    v_add_f32_dpp v102, v239, v238 wave_shr:1 row_mask:0xf bank_mask:0xf
    v_mfma_f32_16x16x32_bf16 v[240:243], a[28:31], a[98:101], v[240:243]
    ds_read_b64_tr_b16 a[62:63], v10 offset:3968
    v_add_f32_dpp v107, v101, v236 wave_ror:1 row_mask:0xf bank_mask:0xf
    v_mfma_f32_16x16x32_bf16 v[240:243], a[24:27], a[94:97], v[240:243]
    v_add_f32_dpp v103, v102, v237 wave_shr:1 row_mask:0xf bank_mask:0xf
    v_mfma_f32_16x16x32_bf16 v[240:243], a[20:23], a[90:93], v[240:243]
    v_mfma_f32_16x16x32_bf16 v[240:243], a[16:19], a[86:89], v[240:243]
    v_add_f32_dpp v107, v103, v236 wave_shr:1 row_mask:0xf bank_mask:0xf
    v_mfma_f32_16x16x32_bf16 v[240:243], a[12:15], a[82:85], v[240:243]
    v_mfma_f32_16x16x32_bf16 v[240:243], a[8:11], a[78:81], v[240:243]
    v_mfma_f32_16x16x32_bf16 v[240:243], a[4:7], a[74:77], v[240:243]
    s_waitcnt lgkmcnt(4)
    v_mfma_f32_16x16x32_bf16 v[240:243], a[0:3], a[70:73], v[240:243]
    v_mfma_f32_16x16x32_bf16 v[244:247], a[56:59], a[124:127], 0
    v_mfma_f32_16x16x32_bf16 v[244:247], a[52:55], a[120:123], v[244:247]
    v_mfma_f32_16x16x32_bf16 v[244:247], a[48:51], a[116:119], v[244:247]
    v_mfma_f32_16x16x32_bf16 v[244:247], a[44:47], a[112:115], v[244:247]
    v_mfma_f32_16x16x32_bf16 v[244:247], a[40:43], a[108:111], v[244:247]
    v_mfma_f32_16x16x32_bf16 v[244:247], a[36:39], a[104:107], v[244:247]
    v_mfma_f32_16x16x32_bf16 v[244:247], a[32:35], a[100:103], v[244:247]
    ds_read_b64_tr_b16 a[66:67], v11 offset:3840
    v_add_f32_dpp v96, v239, v242 wave_ror:1 row_mask:0xf bank_mask:0xf
    v_mfma_f32_16x16x32_bf16 v[244:247], a[28:31], a[96:99], v[244:247]
    v_add_f32_dpp v97, v102, v241 wave_ror:1 row_mask:0xf bank_mask:0xf
    v_add_f32_dpp v96, v243, v242 wave_shr:1 row_mask:0xf bank_mask:0xf
    v_mfma_f32_16x16x32_bf16 v[244:247], a[24:27], a[92:95], v[244:247]
    v_add_f32_dpp v104, v103, v240 wave_ror:1 row_mask:0xf bank_mask:0xf
    v_add_f32_dpp v97, v96, v241 wave_shr:1 row_mask:0xf bank_mask:0xf
    v_mfma_f32_16x16x32_bf16 v[244:247], a[20:23], a[88:91], v[244:247]
    v_cvt_pk_bf16_f32 v114, v106, v107
    v_add_f32_dpp v104, v97, v240 wave_shr:1 row_mask:0xf bank_mask:0xf
    v_mfma_f32_16x16x32_bf16 v[244:247], a[16:19], a[84:87], v[244:247]
    ds_write_b32 v13, v114 offset:13312
    v_mfma_f32_16x16x32_bf16 v[244:247], a[12:15], a[80:83], v[244:247]
    v_mov_b32 v23, v14
    v_mov_b32 v24, v9
    v_mfma_f32_16x16x32_bf16 v[244:247], a[8:11], a[76:79], v[244:247]
    v_subrev_u32 v22, s71, v22
    s_lshl_b32 s66, s62, 14
    v_mfma_f32_16x16x32_bf16 v[244:247], a[4:7], a[72:75], v[244:247]
    s_add_u32 s79, s66, 2621440
    s_waitcnt lgkmcnt(2)
    v_mfma_f32_16x16x32_bf16 v[244:247], a[0:3], a[68:71], v[244:247]
    s_lshl_b32 s66, s30, 14
    s_lshl_b32 s67, s62, 6
    v_mfma_f32_16x16x32_bf16 v[248:251], a[60:63], a[126:129], 0
    s_add_u32 s66, s66, s67
    s_add_u32 s70, s66, 12976128
    v_mfma_f32_16x16x32_bf16 v[248:251], a[56:59], a[122:125], v[248:251]
    s_mov_b32 s62, s65
    v_mfma_f32_16x16x32_bf16 v[248:251], a[52:55], a[118:121], v[248:251]
    v_add_f32_dpp v98, v243, v246 wave_ror:1 row_mask:0xf bank_mask:0xf
    v_add_f32_dpp v99, v96, v245 wave_ror:1 row_mask:0xf bank_mask:0xf
    v_mfma_f32_16x16x32_bf16 v[248:251], a[48:51], a[114:117], v[248:251]
    v_add_f32_dpp v98, v247, v246 wave_shr:1 row_mask:0xf bank_mask:0xf
    v_add_f32_dpp v105, v97, v244 wave_ror:1 row_mask:0xf bank_mask:0xf
    v_mfma_f32_16x16x32_bf16 v[248:251], a[44:47], a[110:113], v[248:251]
    v_add_f32_dpp v99, v98, v245 wave_shr:1 row_mask:0xf bank_mask:0xf
    v_mfma_f32_16x16x32_bf16 v[248:251], a[40:43], a[106:109], v[248:251]
    v_mfma_f32_16x16x32_bf16 v[248:251], a[36:39], a[102:105], v[248:251]
    v_add_f32_dpp v105, v99, v244 wave_shr:1 row_mask:0xf bank_mask:0xf
    v_mfma_f32_16x16x32_bf16 v[248:251], a[32:35], a[98:101], v[248:251]
    ds_read_b64_tr_b16 a[64:65], v11 offset:3968
    v_mfma_f32_16x16x32_bf16 v[248:251], a[28:31], a[94:97], v[248:251]
    v_mfma_f32_16x16x32_bf16 v[248:251], a[24:27], a[90:93], v[248:251]
    v_mfma_f32_16x16x32_bf16 v[248:251], a[20:23], a[86:89], v[248:251]
    v_mfma_f32_16x16x32_bf16 v[248:251], a[16:19], a[82:85], v[248:251]
    v_mfma_f32_16x16x32_bf16 v[248:251], a[12:15], a[78:81], v[248:251]
CHX2:
PAD9:
    s_cbranch_execz WRETX
    v_mfma_f32_16x16x32_bf16 v[248:251], a[8:11], a[74:77], v[248:251]
    v_mfma_f32_16x16x32_bf16 v[248:251], a[4:7], a[70:73], v[248:251]
    s_waitcnt lgkmcnt(1)
    v_mfma_f32_16x16x32_bf16 v[248:251], a[0:3], a[66:69], v[248:251]
    v_mfma_f32_16x16x32_bf16 v[252:255], a[60:63], a[124:127], 0
    v_mfma_f32_16x16x32_bf16 v[252:255], a[56:59], a[120:123], v[252:255]
    v_mfma_f32_16x16x32_bf16 v[252:255], a[52:55], a[116:119], v[252:255]
    v_mfma_f32_16x16x32_bf16 v[252:255], a[48:51], a[112:115], v[252:255]
    v_mfma_f32_16x16x32_bf16 v[252:255], a[44:47], a[108:111], v[252:255]
    v_mfma_f32_16x16x32_bf16 v[252:255], a[40:43], a[104:107], v[252:255]
    v_mfma_f32_16x16x32_bf16 v[252:255], a[36:39], a[100:103], v[252:255]
    v_mfma_f32_16x16x32_bf16 v[252:255], a[32:35], a[96:99], v[252:255]
    v_add_f32_dpp v100, v247, v250 wave_ror:1 row_mask:0xf bank_mask:0xf
    v_add_f32_dpp v101, v98, v249 wave_ror:1 row_mask:0xf bank_mask:0xf
    v_mfma_f32_16x16x32_bf16 v[252:255], a[28:31], a[92:95], v[252:255]
    v_add_f32_dpp v100, v251, v250 wave_shr:1 row_mask:0xf bank_mask:0xf
    v_add_f32_dpp v106, v99, v248 wave_ror:1 row_mask:0xf bank_mask:0xf
    v_mfma_f32_16x16x32_bf16 v[252:255], a[24:27], a[88:91], v[252:255]
    v_add_f32_dpp v101, v100, v249 wave_shr:1 row_mask:0xf bank_mask:0xf
    v_cvt_pk_bf16_f32 v115, v104, v105
    v_mfma_f32_16x16x32_bf16 v[252:255], a[20:23], a[84:87], v[252:255]
    ds_write_b32 v13, v115 offset:14336
    v_mfma_f32_16x16x32_bf16 v[252:255], a[16:19], a[80:83], v[252:255]
    v_add_u32 v10, s69, v10
    v_add_u32 v11, s69, v11
    v_mfma_f32_16x16x32_bf16 v[252:255], a[12:15], a[76:79], v[252:255]
    s_sub_u32 s69, 0, s69
    v_add_f32_dpp v106, v101, v248 wave_shr:1 row_mask:0xf bank_mask:0xf
    v_mfma_f32_16x16x32_bf16 v[252:255], a[8:11], a[72:75], v[252:255]
    v_mfma_f32_16x16x32_bf16 v[252:255], a[4:7], a[68:71], v[252:255]
    s_waitcnt lgkmcnt(1)
    v_mfma_f32_16x16x32_bf16 v[252:255], a[0:3], a[64:67], v[252:255]
    s_nop 7
    v_add_f32_dpp v102, v251, v254 wave_ror:1 row_mask:0xf bank_mask:0xf
    v_add_f32_dpp v103, v100, v253 wave_ror:1 row_mask:0xf bank_mask:0xf
    s_nop 0
    v_add_f32_dpp v102, v255, v254 wave_shr:1 row_mask:0xf bank_mask:0xf
    v_add_f32_dpp v107, v101, v252 wave_ror:1 row_mask:0xf bank_mask:0xf
    s_nop 0
    v_add_f32_dpp v103, v102, v253 wave_shr:1 row_mask:0xf bank_mask:0xf
    s_nop 1
    v_add_f32_dpp v107, v103, v252 wave_shr:1 row_mask:0xf bank_mask:0xf
    v_cvt_pk_bf16_f32 v108, v106, v107
    ds_write_b32 v13, v108 offset:15360
    v_add_u32 v13, s71, v13
    s_sub_u32 s71, 0, s71
    s_waitcnt lgkmcnt(0)
    s_barrier
CONV_LAST:
CHG3:
PAD10:
    s_cbranch_execz PAD12
CHX3:
PAD11:
    s_cbranch_execz PAD13
    ds_read_b64_tr_b16 a[0:1], v10 offset:0
    ds_read_b64_tr_b16 a[2:3], v10 offset:128
    ds_read_b64_tr_b16 a[126:127], v11 offset:0
    ds_read_b64_tr_b16 a[124:125], v11 offset:128
    ds_read_b64_tr_b16 a[4:5], v10 offset:256
    ds_read_b64_tr_b16 a[6:7], v10 offset:384
    ds_read_b64_tr_b16 a[122:123], v11 offset:256
    ds_read_b64_tr_b16 a[120:121], v11 offset:384
    s_waitcnt lgkmcnt(5)
    v_mfma_f32_16x16x32_bf16 v[128:131], a[0:3], a[126:129], 0
    ds_read_b64_tr_b16 a[8:9], v10 offset:512
    s_waitcnt lgkmcnt(5)
    v_mfma_f32_16x16x32_bf16 v[132:135], a[0:3], a[124:127], 0
    ds_read_b64_tr_b16 a[10:11], v10 offset:640
    s_waitcnt lgkmcnt(4)
    v_mfma_f32_16x16x32_bf16 v[136:139], a[4:7], a[126:129], 0
    ds_read_b64_tr_b16 a[118:119], v11 offset:512
    s_waitcnt lgkmcnt(4)
    v_mfma_f32_16x16x32_bf16 v[136:139], a[0:3], a[122:125], v[136:139]
    ds_read_b64_tr_b16 a[116:117], v11 offset:640
    v_add_f32_dpp v96, v131, v130 wave_shr:1 row_mask:0xf bank_mask:0xf bound_ctrl:0
    v_mfma_f32_16x16x32_bf16 v[140:143], a[4:7], a[124:127], 0
    ds_read_b64_tr_b16 a[12:13], v10 offset:768
    s_waitcnt lgkmcnt(5)
    v_mfma_f32_16x16x32_bf16 v[140:143], a[0:3], a[120:123], v[140:143]
    ds_read_b64_tr_b16 a[14:15], v10 offset:896
    s_waitcnt lgkmcnt(4)
    v_mfma_f32_16x16x32_bf16 v[144:147], a[8:11], a[126:129], 0
    ds_read_b64_tr_b16 a[114:115], v11 offset:768
    v_add_f32_dpp v97, v96, v129 wave_shr:1 row_mask:0xf bank_mask:0xf bound_ctrl:0
    v_mfma_f32_16x16x32_bf16 v[144:147], a[4:7], a[122:125], v[144:147]
    ds_read_b64_tr_b16 a[112:113], v11 offset:896
    s_waitcnt lgkmcnt(5)
    v_mfma_f32_16x16x32_bf16 v[144:147], a[0:3], a[118:121], v[144:147]
    ds_read_b64_tr_b16 a[16:17], v10 offset:1024
    v_add_f32_dpp v104, v97, v128 wave_shr:1 row_mask:0xf bank_mask:0xf bound_ctrl:0
    v_mfma_f32_16x16x32_bf16 v[148:151], a[8:11], a[124:127], 0
    ds_read_b64_tr_b16 a[18:19], v10 offset:1152
    v_add_f32_dpp v98, v131, v134 wave_ror:1 row_mask:0xf bank_mask:0xf
    v_mfma_f32_16x16x32_bf16 v[148:151], a[4:7], a[120:123], v[148:151]
    ds_read_b64_tr_b16 a[110:111], v11 offset:1024
    s_waitcnt lgkmcnt(7)
    v_mfma_f32_16x16x32_bf16 v[148:151], a[0:3], a[116:119], v[148:151]
    ds_read_b64_tr_b16 a[108:109], v11 offset:1152
    s_waitcnt lgkmcnt(6)
    v_mfma_f32_16x16x32_bf16 v[152:155], a[12:15], a[126:129], 0
    ds_read_b64_tr_b16 a[20:21], v10 offset:1280
    v_add_f32_dpp v99, v96, v133 wave_ror:1 row_mask:0xf bank_mask:0xf
    v_mfma_f32_16x16x32_bf16 v[152:155], a[8:11], a[122:125], v[152:155]
    ds_read_b64_tr_b16 a[22:23], v10 offset:1408
    v_add_f32_dpp v98, v135, v134 wave_shr:1 row_mask:0xf bank_mask:0xf
    v_mfma_f32_16x16x32_bf16 v[152:155], a[4:7], a[118:121], v[152:155]
    ds_read_b64_tr_b16 a[106:107], v11 offset:1280
    s_waitcnt lgkmcnt(8)
    v_mfma_f32_16x16x32_bf16 v[152:155], a[0:3], a[114:117], v[152:155]
    v_add_f32_dpp v105, v97, v132 wave_ror:1 row_mask:0xf bank_mask:0xf
    v_add_f32_dpp v99, v98, v133 wave_shr:1 row_mask:0xf bank_mask:0xf
    v_mfma_f32_16x16x32_bf16 v[156:159], a[12:15], a[124:127], 0
    v_mfma_f32_16x16x32_bf16 v[156:159], a[8:11], a[120:123], v[156:159]
    ds_read_b64_tr_b16 a[104:105], v11 offset:1408
    v_add_f32_dpp v105, v99, v132 wave_shr:1 row_mask:0xf bank_mask:0xf
    v_mfma_f32_16x16x32_bf16 v[156:159], a[4:7], a[116:119], v[156:159]
    ds_read_b64_tr_b16 a[24:25], v10 offset:1536
    s_waitcnt lgkmcnt(9)
    v_mfma_f32_16x16x32_bf16 v[156:159], a[0:3], a[112:115], v[156:159]
    ds_read_b64_tr_b16 a[26:27], v10 offset:1664
    s_waitcnt lgkmcnt(8)
    v_mfma_f32_16x16x32_bf16 v[160:163], a[16:19], a[126:129], 0
    v_add_f32_dpp v100, v135, v138 wave_ror:1 row_mask:0xf bank_mask:0xf
    v_add_f32_dpp v101, v98, v137 wave_ror:1 row_mask:0xf bank_mask:0xf
    v_mfma_f32_16x16x32_bf16 v[160:163], a[12:15], a[122:125], v[160:163]
    v_add_f32_dpp v100, v139, v138 wave_shr:1 row_mask:0xf bank_mask:0xf
    v_add_f32_dpp v106, v99, v136 wave_ror:1 row_mask:0xf bank_mask:0xf
    v_mfma_f32_16x16x32_bf16 v[160:163], a[8:11], a[118:121], v[160:163]
    v_add_f32_dpp v101, v100, v137 wave_shr:1 row_mask:0xf bank_mask:0xf
    v_cvt_pk_bf16_f32 v109, v104, v105
    v_mfma_f32_16x16x32_bf16 v[160:163], a[4:7], a[114:117], v[160:163]
    ds_write_b32 v13, v109 offset:0
    s_waitcnt lgkmcnt(7)
    v_mfma_f32_16x16x32_bf16 v[160:163], a[0:3], a[110:113], v[160:163]
    ds_read_b64_tr_b16 a[102:103], v11 offset:1536
    v_add_f32_dpp v106, v101, v136 wave_shr:1 row_mask:0xf bank_mask:0xf
    v_mfma_f32_16x16x32_bf16 v[164:167], a[16:19], a[124:127], 0
    v_add_f32_dpp v102, v139, v142 wave_ror:1 row_mask:0xf bank_mask:0xf
    v_add_f32_dpp v103, v100, v141 wave_ror:1 row_mask:0xf bank_mask:0xf
    v_mfma_f32_16x16x32_bf16 v[164:167], a[12:15], a[120:123], v[164:167]
    v_add_f32_dpp v102, v143, v142 wave_shr:1 row_mask:0xf bank_mask:0xf
    v_add_f32_dpp v107, v101, v140 wave_ror:1 row_mask:0xf bank_mask:0xf
    v_mfma_f32_16x16x32_bf16 v[164:167], a[8:11], a[116:119], v[164:167]
    v_add_f32_dpp v103, v102, v141 wave_shr:1 row_mask:0xf bank_mask:0xf
    v_mfma_f32_16x16x32_bf16 v[164:167], a[4:7], a[112:115], v[164:167]
    v_mfma_f32_16x16x32_bf16 v[164:167], a[0:3], a[108:111], v[164:167]
    v_add_f32_dpp v107, v103, v140 wave_shr:1 row_mask:0xf bank_mask:0xf
    s_waitcnt lgkmcnt(4)
    v_mfma_f32_16x16x32_bf16 v[168:171], a[20:23], a[126:129], 0
    ds_read_b128 v[48:51], v22 offset:0
    ds_read_b128 v[52:55], v22 offset:1024
    v_mfma_f32_16x16x32_bf16 v[168:171], a[16:19], a[122:125], v[168:171]
    ds_read_b128 v[56:59], v22 offset:2048
    ds_read_b128 v[60:63], v22 offset:3072
    v_mfma_f32_16x16x32_bf16 v[168:171], a[12:15], a[118:121], v[168:171]
    ds_read_b64_tr_b16 a[100:101], v11 offset:1664
    v_add_f32_dpp v96, v143, v146 wave_ror:1 row_mask:0xf bank_mask:0xf
    v_mfma_f32_16x16x32_bf16 v[168:171], a[8:11], a[114:117], v[168:171]
    ds_read_b64_tr_b16 a[28:29], v10 offset:1792
    v_add_f32_dpp v97, v102, v145 wave_ror:1 row_mask:0xf bank_mask:0xf
    v_mfma_f32_16x16x32_bf16 v[168:171], a[4:7], a[110:113], v[168:171]
    ds_read_b64_tr_b16 a[30:31], v10 offset:1920
    v_add_f32_dpp v96, v147, v146 wave_shr:1 row_mask:0xf bank_mask:0xf
    v_mfma_f32_16x16x32_bf16 v[168:171], a[0:3], a[106:109], v[168:171]
    v_add_f32_dpp v104, v103, v144 wave_ror:1 row_mask:0xf bank_mask:0xf
    v_add_f32_dpp v97, v96, v145 wave_shr:1 row_mask:0xf bank_mask:0xf
    v_mfma_f32_16x16x32_bf16 v[172:175], a[20:23], a[124:127], 0
    v_cvt_pk_bf16_f32 v110, v106, v107
    v_add_f32_dpp v104, v97, v144 wave_shr:1 row_mask:0xf bank_mask:0xf
    v_mfma_f32_16x16x32_bf16 v[172:175], a[16:19], a[120:123], v[172:175]
    ds_write_b32 v13, v110 offset:1024
    v_mfma_f32_16x16x32_bf16 v[172:175], a[12:15], a[116:119], v[172:175]
    v_add_f32_dpp v98, v147, v150 wave_ror:1 row_mask:0xf bank_mask:0xf
    v_add_f32_dpp v99, v96, v149 wave_ror:1 row_mask:0xf bank_mask:0xf
    v_mfma_f32_16x16x32_bf16 v[172:175], a[8:11], a[112:115], v[172:175]
    ds_read_b64_tr_b16 a[98:99], v11 offset:1792
    v_add_f32_dpp v98, v151, v150 wave_shr:1 row_mask:0xf bank_mask:0xf
    v_mfma_f32_16x16x32_bf16 v[172:175], a[4:7], a[108:111], v[172:175]
    v_add_f32_dpp v105, v97, v148 wave_ror:1 row_mask:0xf bank_mask:0xf
    v_add_f32_dpp v99, v98, v149 wave_shr:1 row_mask:0xf bank_mask:0xf
    v_mfma_f32_16x16x32_bf16 v[172:175], a[0:3], a[104:107], v[172:175]
    s_waitcnt lgkmcnt(9)
    v_mfma_f32_16x16x32_bf16 v[176:179], a[24:27], a[126:129], 0
    v_add_f32_dpp v105, v99, v148 wave_shr:1 row_mask:0xf bank_mask:0xf
    v_add_f32_dpp v100, v151, v154 wave_ror:1 row_mask:0xf bank_mask:0xf
    v_mfma_f32_16x16x32_bf16 v[176:179], a[20:23], a[122:125], v[176:179]
    v_add_f32_dpp v101, v98, v153 wave_ror:1 row_mask:0xf bank_mask:0xf
    v_add_f32_dpp v100, v155, v154 wave_shr:1 row_mask:0xf bank_mask:0xf
    v_mfma_f32_16x16x32_bf16 v[176:179], a[16:19], a[118:121], v[176:179]
    s_waitcnt lgkmcnt(4)
    buffer_store_dwordx4 v[48:51], v23, s[44:47], s79 offen offset:0 sc1
    v_mfma_f32_16x16x32_bf16 v[176:179], a[12:15], a[114:117], v[176:179]
    buffer_store_dwordx4 v[52:55], v23, s[44:47], s79 offen offset:1024 sc1
    v_mfma_f32_16x16x32_bf16 v[176:179], a[8:11], a[110:113], v[176:179]
    buffer_store_dwordx4 v[56:59], v23, s[44:47], s79 offen offset:2048 sc1
    v_mfma_f32_16x16x32_bf16 v[176:179], a[4:7], a[106:109], v[176:179]
    buffer_store_dwordx4 v[60:63], v23, s[44:47], s79 offen offset:3072 sc1
    v_mfma_f32_16x16x32_bf16 v[176:179], a[0:3], a[102:105], v[176:179]
    ds_read_b64_tr_b16 a[96:97], v11 offset:1920
    v_add_f32_dpp v106, v99, v152 wave_ror:1 row_mask:0xf bank_mask:0xf
    v_mfma_f32_16x16x32_bf16 v[180:183], a[24:27], a[124:127], 0
    ds_read_b64_tr_b16 a[32:33], v10 offset:2048
    v_add_f32_dpp v101, v100, v153 wave_shr:1 row_mask:0xf bank_mask:0xf
    v_mfma_f32_16x16x32_bf16 v[180:183], a[20:23], a[120:123], v[180:183]
    ds_read_b64_tr_b16 a[34:35], v10 offset:2176
    v_cvt_pk_bf16_f32 v111, v104, v105
    v_mfma_f32_16x16x32_bf16 v[180:183], a[16:19], a[116:119], v[180:183]
    ds_write_b32 v13, v111 offset:2048
    v_mfma_f32_16x16x32_bf16 v[180:183], a[12:15], a[112:115], v[180:183]
    v_add_f32_dpp v106, v101, v152 wave_shr:1 row_mask:0xf bank_mask:0xf
    v_add_f32_dpp v102, v155, v158 wave_ror:1 row_mask:0xf bank_mask:0xf
    v_mfma_f32_16x16x32_bf16 v[180:183], a[8:11], a[108:111], v[180:183]
    v_add_f32_dpp v103, v100, v157 wave_ror:1 row_mask:0xf bank_mask:0xf
    v_add_f32_dpp v102, v159, v158 wave_shr:1 row_mask:0xf bank_mask:0xf
    v_mfma_f32_16x16x32_bf16 v[180:183], a[4:7], a[104:107], v[180:183]
    v_add_f32_dpp v107, v101, v156 wave_ror:1 row_mask:0xf bank_mask:0xf
    v_add_f32_dpp v103, v102, v157 wave_shr:1 row_mask:0xf bank_mask:0xf
    v_mfma_f32_16x16x32_bf16 v[180:183], a[0:3], a[100:103], v[180:183]
    s_waitcnt lgkmcnt(4)
    v_mfma_f32_16x16x32_bf16 v[184:187], a[28:31], a[126:129], 0
    ds_read_b64_tr_b16 a[94:95], v11 offset:2048
    v_add_f32_dpp v107, v103, v156 wave_shr:1 row_mask:0xf bank_mask:0xf
    v_mfma_f32_16x16x32_bf16 v[184:187], a[24:27], a[122:125], v[184:187]
    v_add_f32_dpp v96, v159, v162 wave_ror:1 row_mask:0xf bank_mask:0xf
    v_add_f32_dpp v97, v102, v161 wave_ror:1 row_mask:0xf bank_mask:0xf
    v_mfma_f32_16x16x32_bf16 v[184:187], a[20:23], a[118:121], v[184:187]
    v_add_f32_dpp v96, v163, v162 wave_shr:1 row_mask:0xf bank_mask:0xf
    v_add_f32_dpp v104, v103, v160 wave_ror:1 row_mask:0xf bank_mask:0xf
    v_mfma_f32_16x16x32_bf16 v[184:187], a[16:19], a[114:117], v[184:187]
    v_add_f32_dpp v97, v96, v161 wave_shr:1 row_mask:0xf bank_mask:0xf
    v_cvt_pk_bf16_f32 v112, v106, v107
    v_mfma_f32_16x16x32_bf16 v[184:187], a[12:15], a[110:113], v[184:187]
    ds_write_b32 v13, v112 offset:3072
    v_mfma_f32_16x16x32_bf16 v[184:187], a[8:11], a[106:109], v[184:187]
    v_add_f32_dpp v104, v97, v160 wave_shr:1 row_mask:0xf bank_mask:0xf
    v_add_f32_dpp v98, v163, v166 wave_ror:1 row_mask:0xf bank_mask:0xf
    v_mfma_f32_16x16x32_bf16 v[184:187], a[4:7], a[102:105], v[184:187]
    v_add_f32_dpp v99, v96, v165 wave_ror:1 row_mask:0xf bank_mask:0xf
    v_add_f32_dpp v98, v167, v166 wave_shr:1 row_mask:0xf bank_mask:0xf
    v_mfma_f32_16x16x32_bf16 v[184:187], a[0:3], a[98:101], v[184:187]
    v_add_f32_dpp v105, v97, v164 wave_ror:1 row_mask:0xf bank_mask:0xf
    v_add_f32_dpp v99, v98, v165 wave_shr:1 row_mask:0xf bank_mask:0xf
    v_mfma_f32_16x16x32_bf16 v[188:191], a[28:31], a[124:127], 0
    v_mfma_f32_16x16x32_bf16 v[188:191], a[24:27], a[120:123], v[188:191]
    ds_read_b64_tr_b16 a[92:93], v11 offset:2176
    v_add_f32_dpp v105, v99, v164 wave_shr:1 row_mask:0xf bank_mask:0xf
    v_mfma_f32_16x16x32_bf16 v[188:191], a[20:23], a[116:119], v[188:191]
    ds_read_b64_tr_b16 a[36:37], v10 offset:2304
    v_add_f32_dpp v100, v167, v170 wave_ror:1 row_mask:0xf bank_mask:0xf
    v_mfma_f32_16x16x32_bf16 v[188:191], a[16:19], a[112:115], v[188:191]
    ds_read_b64_tr_b16 a[38:39], v10 offset:2432
    v_add_f32_dpp v101, v98, v169 wave_ror:1 row_mask:0xf bank_mask:0xf
    v_mfma_f32_16x16x32_bf16 v[188:191], a[12:15], a[108:111], v[188:191]
    v_add_f32_dpp v100, v171, v170 wave_shr:1 row_mask:0xf bank_mask:0xf
    v_add_f32_dpp v106, v99, v168 wave_ror:1 row_mask:0xf bank_mask:0xf
    v_mfma_f32_16x16x32_bf16 v[188:191], a[8:11], a[104:107], v[188:191]
    v_add_f32_dpp v101, v100, v169 wave_shr:1 row_mask:0xf bank_mask:0xf
    v_cvt_pk_bf16_f32 v113, v104, v105
    v_mfma_f32_16x16x32_bf16 v[188:191], a[4:7], a[100:103], v[188:191]
    ds_write_b32 v13, v113 offset:4096
    s_waitcnt lgkmcnt(5)
    v_mfma_f32_16x16x32_bf16 v[188:191], a[0:3], a[96:99], v[188:191]
    v_add_f32_dpp v106, v101, v168 wave_shr:1 row_mask:0xf bank_mask:0xf
    v_add_f32_dpp v102, v171, v174 wave_ror:1 row_mask:0xf bank_mask:0xf
    v_mfma_f32_16x16x32_bf16 v[192:195], a[32:35], a[126:129], 0
    v_add_f32_dpp v103, v100, v173 wave_ror:1 row_mask:0xf bank_mask:0xf
    v_add_f32_dpp v102, v175, v174 wave_shr:1 row_mask:0xf bank_mask:0xf
    v_mfma_f32_16x16x32_bf16 v[192:195], a[28:31], a[122:125], v[192:195]
    v_add_f32_dpp v107, v101, v172 wave_ror:1 row_mask:0xf bank_mask:0xf
    v_add_f32_dpp v103, v102, v173 wave_shr:1 row_mask:0xf bank_mask:0xf
    v_mfma_f32_16x16x32_bf16 v[192:195], a[24:27], a[118:121], v[192:195]
    v_mfma_f32_16x16x32_bf16 v[192:195], a[20:23], a[114:117], v[192:195]
    ds_read_b64_tr_b16 a[90:91], v11 offset:2304
    v_add_f32_dpp v107, v103, v172 wave_shr:1 row_mask:0xf bank_mask:0xf
    v_mfma_f32_16x16x32_bf16 v[192:195], a[16:19], a[110:113], v[192:195]
    v_add_f32_dpp v96, v175, v178 wave_ror:1 row_mask:0xf bank_mask:0xf
    v_add_f32_dpp v97, v102, v177 wave_ror:1 row_mask:0xf bank_mask:0xf
    v_mfma_f32_16x16x32_bf16 v[192:195], a[12:15], a[106:109], v[192:195]
    v_add_f32_dpp v96, v179, v178 wave_shr:1 row_mask:0xf bank_mask:0xf
    v_add_f32_dpp v104, v103, v176 wave_ror:1 row_mask:0xf bank_mask:0xf
    v_mfma_f32_16x16x32_bf16 v[192:195], a[8:11], a[102:105], v[192:195]
    v_add_f32_dpp v97, v96, v177 wave_shr:1 row_mask:0xf bank_mask:0xf
    v_cvt_pk_bf16_f32 v114, v106, v107
    v_mfma_f32_16x16x32_bf16 v[192:195], a[4:7], a[98:101], v[192:195]
    ds_write_b32 v13, v114 offset:5120
    v_mfma_f32_16x16x32_bf16 v[192:195], a[0:3], a[94:97], v[192:195]
    v_add_f32_dpp v104, v97, v176 wave_shr:1 row_mask:0xf bank_mask:0xf
    v_add_f32_dpp v98, v179, v182 wave_ror:1 row_mask:0xf bank_mask:0xf
    v_mfma_f32_16x16x32_bf16 v[196:199], a[32:35], a[124:127], 0
    v_add_f32_dpp v99, v96, v181 wave_ror:1 row_mask:0xf bank_mask:0xf
    v_add_f32_dpp v98, v183, v182 wave_shr:1 row_mask:0xf bank_mask:0xf
    v_mfma_f32_16x16x32_bf16 v[196:199], a[28:31], a[120:123], v[196:199]
    v_add_f32_dpp v105, v97, v180 wave_ror:1 row_mask:0xf bank_mask:0xf
    v_add_f32_dpp v99, v98, v181 wave_shr:1 row_mask:0xf bank_mask:0xf
    v_mfma_f32_16x16x32_bf16 v[196:199], a[24:27], a[116:119], v[196:199]
    v_mfma_f32_16x16x32_bf16 v[196:199], a[20:23], a[112:115], v[196:199]
    v_add_f32_dpp v105, v99, v180 wave_shr:1 row_mask:0xf bank_mask:0xf
    v_add_f32_dpp v100, v183, v186 wave_ror:1 row_mask:0xf bank_mask:0xf
    v_mfma_f32_16x16x32_bf16 v[196:199], a[16:19], a[108:111], v[196:199]
    ds_read_b64_tr_b16 a[88:89], v11 offset:2432
    v_add_f32_dpp v101, v98, v185 wave_ror:1 row_mask:0xf bank_mask:0xf
    v_mfma_f32_16x16x32_bf16 v[196:199], a[12:15], a[104:107], v[196:199]
    ds_read_b64_tr_b16 a[40:41], v10 offset:2560
    v_add_f32_dpp v100, v187, v186 wave_shr:1 row_mask:0xf bank_mask:0xf
    v_mfma_f32_16x16x32_bf16 v[196:199], a[8:11], a[100:103], v[196:199]
    ds_read_b64_tr_b16 a[42:43], v10 offset:2688
    v_add_f32_dpp v106, v99, v184 wave_ror:1 row_mask:0xf bank_mask:0xf
    v_mfma_f32_16x16x32_bf16 v[196:199], a[4:7], a[96:99], v[196:199]
    v_add_f32_dpp v101, v100, v185 wave_shr:1 row_mask:0xf bank_mask:0xf
    s_waitcnt lgkmcnt(4)
    v_mfma_f32_16x16x32_bf16 v[196:199], a[0:3], a[92:95], v[196:199]
    v_cvt_pk_bf16_f32 v115, v104, v105
    v_add_f32_dpp v106, v101, v184 wave_shr:1 row_mask:0xf bank_mask:0xf
    v_mfma_f32_16x16x32_bf16 v[200:203], a[36:39], a[126:129], 0
    ds_write_b32 v13, v115 offset:6144
    v_mfma_f32_16x16x32_bf16 v[200:203], a[32:35], a[122:125], v[200:203]
    v_add_f32_dpp v102, v187, v190 wave_ror:1 row_mask:0xf bank_mask:0xf
    v_add_f32_dpp v103, v100, v189 wave_ror:1 row_mask:0xf bank_mask:0xf
    v_mfma_f32_16x16x32_bf16 v[200:203], a[28:31], a[118:121], v[200:203]
    v_add_f32_dpp v102, v191, v190 wave_shr:1 row_mask:0xf bank_mask:0xf
    v_add_f32_dpp v107, v101, v188 wave_ror:1 row_mask:0xf bank_mask:0xf
    v_mfma_f32_16x16x32_bf16 v[200:203], a[24:27], a[114:117], v[200:203]
    v_add_f32_dpp v103, v102, v189 wave_shr:1 row_mask:0xf bank_mask:0xf
    v_mfma_f32_16x16x32_bf16 v[200:203], a[20:23], a[110:113], v[200:203]
    v_mfma_f32_16x16x32_bf16 v[200:203], a[16:19], a[106:109], v[200:203]
    s_waitcnt vmcnt(0)
    buffer_store_dword v8, v24, s[44:47], s70 offen offset:0 sc1
    v_mfma_f32_16x16x32_bf16 v[200:203], a[12:15], a[102:105], v[200:203]
    ds_read_b64_tr_b16 a[86:87], v11 offset:2560
    v_add_f32_dpp v107, v103, v188 wave_shr:1 row_mask:0xf bank_mask:0xf
    v_mfma_f32_16x16x32_bf16 v[200:203], a[8:11], a[98:101], v[200:203]
    v_add_f32_dpp v96, v191, v194 wave_ror:1 row_mask:0xf bank_mask:0xf
    v_add_f32_dpp v97, v102, v193 wave_ror:1 row_mask:0xf bank_mask:0xf
    v_mfma_f32_16x16x32_bf16 v[200:203], a[4:7], a[94:97], v[200:203]
    v_add_f32_dpp v96, v195, v194 wave_shr:1 row_mask:0xf bank_mask:0xf
    v_add_f32_dpp v104, v103, v192 wave_ror:1 row_mask:0xf bank_mask:0xf
    v_mfma_f32_16x16x32_bf16 v[200:203], a[0:3], a[90:93], v[200:203]
    v_add_f32_dpp v97, v96, v193 wave_shr:1 row_mask:0xf bank_mask:0xf
    v_cvt_pk_bf16_f32 v108, v106, v107
    v_mfma_f32_16x16x32_bf16 v[204:207], a[36:39], a[124:127], 0
    ds_write_b32 v13, v108 offset:7168
    v_mfma_f32_16x16x32_bf16 v[204:207], a[32:35], a[120:123], v[204:207]
    v_add_f32_dpp v104, v97, v192 wave_shr:1 row_mask:0xf bank_mask:0xf
    v_add_f32_dpp v98, v195, v198 wave_ror:1 row_mask:0xf bank_mask:0xf
    v_mfma_f32_16x16x32_bf16 v[204:207], a[28:31], a[116:119], v[204:207]
    v_add_f32_dpp v99, v96, v197 wave_ror:1 row_mask:0xf bank_mask:0xf
    v_add_f32_dpp v98, v199, v198 wave_shr:1 row_mask:0xf bank_mask:0xf
    v_mfma_f32_16x16x32_bf16 v[204:207], a[24:27], a[112:115], v[204:207]
    v_add_f32_dpp v105, v97, v196 wave_ror:1 row_mask:0xf bank_mask:0xf
    v_add_f32_dpp v99, v98, v197 wave_shr:1 row_mask:0xf bank_mask:0xf
    v_mfma_f32_16x16x32_bf16 v[204:207], a[20:23], a[108:111], v[204:207]
    v_mfma_f32_16x16x32_bf16 v[204:207], a[16:19], a[104:107], v[204:207]
    v_add_f32_dpp v105, v99, v196 wave_shr:1 row_mask:0xf bank_mask:0xf
    v_add_f32_dpp v100, v199, v202 wave_ror:1 row_mask:0xf bank_mask:0xf
    v_mfma_f32_16x16x32_bf16 v[204:207], a[12:15], a[100:103], v[204:207]
    v_add_f32_dpp v101, v98, v201 wave_ror:1 row_mask:0xf bank_mask:0xf
    v_add_f32_dpp v100, v203, v202 wave_shr:1 row_mask:0xf bank_mask:0xf
    v_mfma_f32_16x16x32_bf16 v[204:207], a[8:11], a[96:99], v[204:207]
    ds_read_b64_tr_b16 a[84:85], v11 offset:2688
    v_add_f32_dpp v106, v99, v200 wave_ror:1 row_mask:0xf bank_mask:0xf
    v_mfma_f32_16x16x32_bf16 v[204:207], a[4:7], a[92:95], v[204:207]
    ds_read_b64_tr_b16 a[44:45], v10 offset:2816
    s_waitcnt lgkmcnt(3)
    v_mfma_f32_16x16x32_bf16 v[204:207], a[0:3], a[88:91], v[204:207]
    ds_read_b64_tr_b16 a[46:47], v10 offset:2944
    v_add_f32_dpp v101, v100, v201 wave_shr:1 row_mask:0xf bank_mask:0xf
    v_mfma_f32_16x16x32_bf16 v[208:211], a[40:43], a[126:129], 0
    v_cvt_pk_bf16_f32 v109, v104, v105
    v_add_f32_dpp v106, v101, v200 wave_shr:1 row_mask:0xf bank_mask:0xf
    v_mfma_f32_16x16x32_bf16 v[208:211], a[36:39], a[122:125], v[208:211]
    ds_write_b32 v13, v109 offset:8192
    v_mfma_f32_16x16x32_bf16 v[208:211], a[32:35], a[118:121], v[208:211]
    v_add_f32_dpp v102, v203, v206 wave_ror:1 row_mask:0xf bank_mask:0xf
    v_add_f32_dpp v103, v100, v205 wave_ror:1 row_mask:0xf bank_mask:0xf
    v_mfma_f32_16x16x32_bf16 v[208:211], a[28:31], a[114:117], v[208:211]
    v_add_f32_dpp v102, v207, v206 wave_shr:1 row_mask:0xf bank_mask:0xf
    v_add_f32_dpp v107, v101, v204 wave_ror:1 row_mask:0xf bank_mask:0xf
    v_mfma_f32_16x16x32_bf16 v[208:211], a[24:27], a[110:113], v[208:211]
    v_add_f32_dpp v103, v102, v205 wave_shr:1 row_mask:0xf bank_mask:0xf
    v_mfma_f32_16x16x32_bf16 v[208:211], a[20:23], a[106:109], v[208:211]
    v_mfma_f32_16x16x32_bf16 v[208:211], a[16:19], a[102:105], v[208:211]
    v_add_f32_dpp v107, v103, v204 wave_shr:1 row_mask:0xf bank_mask:0xf
    v_mfma_f32_16x16x32_bf16 v[208:211], a[12:15], a[98:101], v[208:211]
    v_mfma_f32_16x16x32_bf16 v[208:211], a[8:11], a[94:97], v[208:211]
    v_mfma_f32_16x16x32_bf16 v[208:211], a[4:7], a[90:93], v[208:211]
    ds_read_b64_tr_b16 a[82:83], v11 offset:2816
    v_mfma_f32_16x16x32_bf16 v[208:211], a[0:3], a[86:89], v[208:211]
    v_mfma_f32_16x16x32_bf16 v[212:215], a[40:43], a[124:127], 0
    v_mfma_f32_16x16x32_bf16 v[212:215], a[36:39], a[120:123], v[212:215]
    v_mfma_f32_16x16x32_bf16 v[212:215], a[32:35], a[116:119], v[212:215]
    v_mfma_f32_16x16x32_bf16 v[212:215], a[28:31], a[112:115], v[212:215]
    v_mfma_f32_16x16x32_bf16 v[212:215], a[24:27], a[108:111], v[212:215]
    v_mfma_f32_16x16x32_bf16 v[212:215], a[20:23], a[104:107], v[212:215]
    v_mfma_f32_16x16x32_bf16 v[212:215], a[16:19], a[100:103], v[212:215]
    v_mfma_f32_16x16x32_bf16 v[212:215], a[12:15], a[96:99], v[212:215]
    v_add_f32_dpp v96, v207, v210 wave_ror:1 row_mask:0xf bank_mask:0xf
    v_add_f32_dpp v97, v102, v209 wave_ror:1 row_mask:0xf bank_mask:0xf
    v_mfma_f32_16x16x32_bf16 v[212:215], a[8:11], a[92:95], v[212:215]
    v_add_f32_dpp v96, v211, v210 wave_shr:1 row_mask:0xf bank_mask:0xf
    v_add_f32_dpp v104, v103, v208 wave_ror:1 row_mask:0xf bank_mask:0xf
    v_mfma_f32_16x16x32_bf16 v[212:215], a[4:7], a[88:91], v[212:215]
    v_add_f32_dpp v97, v96, v209 wave_shr:1 row_mask:0xf bank_mask:0xf
    s_waitcnt lgkmcnt(1)
    v_mfma_f32_16x16x32_bf16 v[212:215], a[0:3], a[84:87], v[212:215]
    ds_read_b64_tr_b16 a[80:81], v11 offset:2944
    v_cvt_pk_bf16_f32 v110, v106, v107
    v_mfma_f32_16x16x32_bf16 v[216:219], a[44:47], a[126:129], 0
    ds_read_b64_tr_b16 a[48:49], v10 offset:3072
    v_add_f32_dpp v104, v97, v208 wave_shr:1 row_mask:0xf bank_mask:0xf
    v_mfma_f32_16x16x32_bf16 v[216:219], a[40:43], a[122:125], v[216:219]
    ds_read_b64_tr_b16 a[50:51], v10 offset:3200
    v_mfma_f32_16x16x32_bf16 v[216:219], a[36:39], a[118:121], v[216:219]
    ds_write_b32 v13, v110 offset:9216
    v_mfma_f32_16x16x32_bf16 v[216:219], a[32:35], a[114:117], v[216:219]
    v_add_f32_dpp v98, v211, v214 wave_ror:1 row_mask:0xf bank_mask:0xf
    v_add_f32_dpp v99, v96, v213 wave_ror:1 row_mask:0xf bank_mask:0xf
    v_mfma_f32_16x16x32_bf16 v[216:219], a[28:31], a[110:113], v[216:219]
    v_add_f32_dpp v98, v215, v214 wave_shr:1 row_mask:0xf bank_mask:0xf
    v_add_f32_dpp v105, v97, v212 wave_ror:1 row_mask:0xf bank_mask:0xf
    v_mfma_f32_16x16x32_bf16 v[216:219], a[24:27], a[106:109], v[216:219]
    v_add_f32_dpp v99, v98, v213 wave_shr:1 row_mask:0xf bank_mask:0xf
    v_mfma_f32_16x16x32_bf16 v[216:219], a[20:23], a[102:105], v[216:219]
    v_mfma_f32_16x16x32_bf16 v[216:219], a[16:19], a[98:101], v[216:219]
    v_add_f32_dpp v105, v99, v212 wave_shr:1 row_mask:0xf bank_mask:0xf
    v_mfma_f32_16x16x32_bf16 v[216:219], a[12:15], a[94:97], v[216:219]
    v_mfma_f32_16x16x32_bf16 v[216:219], a[8:11], a[90:93], v[216:219]
    v_mfma_f32_16x16x32_bf16 v[216:219], a[4:7], a[86:89], v[216:219]
    s_waitcnt lgkmcnt(4)
    v_mfma_f32_16x16x32_bf16 v[216:219], a[0:3], a[82:85], v[216:219]
    v_mfma_f32_16x16x32_bf16 v[220:223], a[44:47], a[124:127], 0
    ds_read_b64_tr_b16 a[78:79], v11 offset:3072
    v_mfma_f32_16x16x32_bf16 v[220:223], a[40:43], a[120:123], v[220:223]
    v_mfma_f32_16x16x32_bf16 v[220:223], a[36:39], a[116:119], v[220:223]
    v_mfma_f32_16x16x32_bf16 v[220:223], a[32:35], a[112:115], v[220:223]
    v_mfma_f32_16x16x32_bf16 v[220:223], a[28:31], a[108:111], v[220:223]
    v_mfma_f32_16x16x32_bf16 v[220:223], a[24:27], a[104:107], v[220:223]
    v_mfma_f32_16x16x32_bf16 v[220:223], a[20:23], a[100:103], v[220:223]
    v_add_f32_dpp v100, v215, v218 wave_ror:1 row_mask:0xf bank_mask:0xf
    v_add_f32_dpp v101, v98, v217 wave_ror:1 row_mask:0xf bank_mask:0xf
    v_mfma_f32_16x16x32_bf16 v[220:223], a[16:19], a[96:99], v[220:223]
    v_add_f32_dpp v100, v219, v218 wave_shr:1 row_mask:0xf bank_mask:0xf
    v_add_f32_dpp v106, v99, v216 wave_ror:1 row_mask:0xf bank_mask:0xf
    v_mfma_f32_16x16x32_bf16 v[220:223], a[12:15], a[92:95], v[220:223]
    v_add_f32_dpp v101, v100, v217 wave_shr:1 row_mask:0xf bank_mask:0xf
    v_cvt_pk_bf16_f32 v111, v104, v105
    v_mfma_f32_16x16x32_bf16 v[220:223], a[8:11], a[88:91], v[220:223]
    ds_write_b32 v13, v111 offset:10240
    v_mfma_f32_16x16x32_bf16 v[220:223], a[4:7], a[84:87], v[220:223]
    v_add_f32_dpp v106, v101, v216 wave_shr:1 row_mask:0xf bank_mask:0xf
    s_waitcnt lgkmcnt(2)
    v_mfma_f32_16x16x32_bf16 v[220:223], a[0:3], a[80:83], v[220:223]
    v_mfma_f32_16x16x32_bf16 v[224:227], a[48:51], a[126:129], 0
    v_mfma_f32_16x16x32_bf16 v[224:227], a[44:47], a[122:125], v[224:227]
    ds_read_b64_tr_b16 a[76:77], v11 offset:3200
    v_mfma_f32_16x16x32_bf16 v[224:227], a[40:43], a[118:121], v[224:227]
    ds_read_b64_tr_b16 a[52:53], v10 offset:3328
    v_mfma_f32_16x16x32_bf16 v[224:227], a[36:39], a[114:117], v[224:227]
    ds_read_b64_tr_b16 a[54:55], v10 offset:3456
    v_mfma_f32_16x16x32_bf16 v[224:227], a[32:35], a[110:113], v[224:227]
    v_add_f32_dpp v102, v219, v222 wave_ror:1 row_mask:0xf bank_mask:0xf
    v_add_f32_dpp v103, v100, v221 wave_ror:1 row_mask:0xf bank_mask:0xf
    v_mfma_f32_16x16x32_bf16 v[224:227], a[28:31], a[106:109], v[224:227]
    v_add_f32_dpp v102, v223, v222 wave_shr:1 row_mask:0xf bank_mask:0xf
    v_add_f32_dpp v107, v101, v220 wave_ror:1 row_mask:0xf bank_mask:0xf
    v_mfma_f32_16x16x32_bf16 v[224:227], a[24:27], a[102:105], v[224:227]
    v_add_f32_dpp v103, v102, v221 wave_shr:1 row_mask:0xf bank_mask:0xf
    v_mfma_f32_16x16x32_bf16 v[224:227], a[20:23], a[98:101], v[224:227]
    v_mfma_f32_16x16x32_bf16 v[224:227], a[16:19], a[94:97], v[224:227]
    v_add_f32_dpp v107, v103, v220 wave_shr:1 row_mask:0xf bank_mask:0xf
    v_mfma_f32_16x16x32_bf16 v[224:227], a[12:15], a[90:93], v[224:227]
    v_mfma_f32_16x16x32_bf16 v[224:227], a[8:11], a[86:89], v[224:227]
    v_mfma_f32_16x16x32_bf16 v[224:227], a[4:7], a[82:85], v[224:227]
    s_waitcnt lgkmcnt(3)
    v_mfma_f32_16x16x32_bf16 v[224:227], a[0:3], a[78:81], v[224:227]
    v_mfma_f32_16x16x32_bf16 v[228:231], a[48:51], a[124:127], 0
    v_mfma_f32_16x16x32_bf16 v[228:231], a[44:47], a[120:123], v[228:231]
    v_mfma_f32_16x16x32_bf16 v[228:231], a[40:43], a[116:119], v[228:231]
    ds_read_b64_tr_b16 a[74:75], v11 offset:3328
    v_mfma_f32_16x16x32_bf16 v[228:231], a[36:39], a[112:115], v[228:231]
    v_mfma_f32_16x16x32_bf16 v[228:231], a[32:35], a[108:111], v[228:231]
    v_mfma_f32_16x16x32_bf16 v[228:231], a[28:31], a[104:107], v[228:231]
    v_mfma_f32_16x16x32_bf16 v[228:231], a[24:27], a[100:103], v[228:231]
    v_add_f32_dpp v96, v223, v226 wave_ror:1 row_mask:0xf bank_mask:0xf
    v_add_f32_dpp v97, v102, v225 wave_ror:1 row_mask:0xf bank_mask:0xf
    v_mfma_f32_16x16x32_bf16 v[228:231], a[20:23], a[96:99], v[228:231]
    v_add_f32_dpp v96, v227, v226 wave_shr:1 row_mask:0xf bank_mask:0xf
    v_add_f32_dpp v104, v103, v224 wave_ror:1 row_mask:0xf bank_mask:0xf
    v_mfma_f32_16x16x32_bf16 v[228:231], a[16:19], a[92:95], v[228:231]
    v_add_f32_dpp v97, v96, v225 wave_shr:1 row_mask:0xf bank_mask:0xf
    v_cvt_pk_bf16_f32 v112, v106, v107
    v_mfma_f32_16x16x32_bf16 v[228:231], a[12:15], a[88:91], v[228:231]
    ds_write_b32 v13, v112 offset:11264
    v_mfma_f32_16x16x32_bf16 v[228:231], a[8:11], a[84:87], v[228:231]
    v_add_f32_dpp v104, v97, v224 wave_shr:1 row_mask:0xf bank_mask:0xf
    v_mfma_f32_16x16x32_bf16 v[228:231], a[4:7], a[80:83], v[228:231]
    s_waitcnt lgkmcnt(2)
    v_mfma_f32_16x16x32_bf16 v[228:231], a[0:3], a[76:79], v[228:231]
    v_mfma_f32_16x16x32_bf16 v[232:235], a[52:55], a[126:129], 0
    v_mfma_f32_16x16x32_bf16 v[232:235], a[48:51], a[122:125], v[232:235]
    v_mfma_f32_16x16x32_bf16 v[232:235], a[44:47], a[118:121], v[232:235]
    v_mfma_f32_16x16x32_bf16 v[232:235], a[40:43], a[114:117], v[232:235]
    ds_read_b64_tr_b16 a[72:73], v11 offset:3456
    v_mfma_f32_16x16x32_bf16 v[232:235], a[36:39], a[110:113], v[232:235]
    ds_read_b64_tr_b16 a[56:57], v10 offset:3584
    v_mfma_f32_16x16x32_bf16 v[232:235], a[32:35], a[106:109], v[232:235]
    ds_read_b64_tr_b16 a[58:59], v10 offset:3712
    v_add_f32_dpp v98, v227, v230 wave_ror:1 row_mask:0xf bank_mask:0xf
    v_mfma_f32_16x16x32_bf16 v[232:235], a[28:31], a[102:105], v[232:235]
    v_add_f32_dpp v99, v96, v229 wave_ror:1 row_mask:0xf bank_mask:0xf
    v_add_f32_dpp v98, v231, v230 wave_shr:1 row_mask:0xf bank_mask:0xf
    v_mfma_f32_16x16x32_bf16 v[232:235], a[24:27], a[98:101], v[232:235]
    v_add_f32_dpp v105, v97, v228 wave_ror:1 row_mask:0xf bank_mask:0xf
    v_add_f32_dpp v99, v98, v229 wave_shr:1 row_mask:0xf bank_mask:0xf
    v_mfma_f32_16x16x32_bf16 v[232:235], a[20:23], a[94:97], v[232:235]
    v_mfma_f32_16x16x32_bf16 v[232:235], a[16:19], a[90:93], v[232:235]
    v_add_f32_dpp v105, v99, v228 wave_shr:1 row_mask:0xf bank_mask:0xf
    v_mfma_f32_16x16x32_bf16 v[232:235], a[12:15], a[86:89], v[232:235]
    v_mfma_f32_16x16x32_bf16 v[232:235], a[8:11], a[82:85], v[232:235]
    v_mfma_f32_16x16x32_bf16 v[232:235], a[4:7], a[78:81], v[232:235]
    s_waitcnt lgkmcnt(3)
    v_mfma_f32_16x16x32_bf16 v[232:235], a[0:3], a[74:77], v[232:235]
    v_mfma_f32_16x16x32_bf16 v[236:239], a[52:55], a[124:127], 0
    v_mfma_f32_16x16x32_bf16 v[236:239], a[48:51], a[120:123], v[236:239]
    v_mfma_f32_16x16x32_bf16 v[236:239], a[44:47], a[116:119], v[236:239]
    v_mfma_f32_16x16x32_bf16 v[236:239], a[40:43], a[112:115], v[236:239]
    v_mfma_f32_16x16x32_bf16 v[236:239], a[36:39], a[108:111], v[236:239]
    ds_read_b64_tr_b16 a[70:71], v11 offset:3584
    v_mfma_f32_16x16x32_bf16 v[236:239], a[32:35], a[104:107], v[236:239]
    v_mfma_f32_16x16x32_bf16 v[236:239], a[28:31], a[100:103], v[236:239]
    v_add_f32_dpp v100, v231, v234 wave_ror:1 row_mask:0xf bank_mask:0xf
    v_add_f32_dpp v101, v98, v233 wave_ror:1 row_mask:0xf bank_mask:0xf
    v_mfma_f32_16x16x32_bf16 v[236:239], a[24:27], a[96:99], v[236:239]
    v_add_f32_dpp v100, v235, v234 wave_shr:1 row_mask:0xf bank_mask:0xf
    v_add_f32_dpp v106, v99, v232 wave_ror:1 row_mask:0xf bank_mask:0xf
    v_mfma_f32_16x16x32_bf16 v[236:239], a[20:23], a[92:95], v[236:239]
    v_add_f32_dpp v101, v100, v233 wave_shr:1 row_mask:0xf bank_mask:0xf
PAD12:
    s_cbranch_execz WRETG
PAD13:
    s_cbranch_execz WRETX
    v_cvt_pk_bf16_f32 v113, v104, v105
    v_mfma_f32_16x16x32_bf16 v[236:239], a[16:19], a[88:91], v[236:239]
    ds_write_b32 v13, v113 offset:12288
    v_mfma_f32_16x16x32_bf16 v[236:239], a[12:15], a[84:87], v[236:239]
    v_add_f32_dpp v106, v101, v232 wave_shr:1 row_mask:0xf bank_mask:0xf
    v_mfma_f32_16x16x32_bf16 v[236:239], a[8:11], a[80:83], v[236:239]
    v_mfma_f32_16x16x32_bf16 v[236:239], a[4:7], a[76:79], v[236:239]
    s_waitcnt lgkmcnt(2)
    v_mfma_f32_16x16x32_bf16 v[236:239], a[0:3], a[72:75], v[236:239]
    v_mfma_f32_16x16x32_bf16 v[240:243], a[56:59], a[126:129], 0
    v_mfma_f32_16x16x32_bf16 v[240:243], a[52:55], a[122:125], v[240:243]
    v_mfma_f32_16x16x32_bf16 v[240:243], a[48:51], a[118:121], v[240:243]
    v_mfma_f32_16x16x32_bf16 v[240:243], a[44:47], a[114:117], v[240:243]
    v_mfma_f32_16x16x32_bf16 v[240:243], a[40:43], a[110:113], v[240:243]
    v_mfma_f32_16x16x32_bf16 v[240:243], a[36:39], a[106:109], v[240:243]
    ds_read_b64_tr_b16 a[68:69], v11 offset:3712
    v_mfma_f32_16x16x32_bf16 v[240:243], a[32:35], a[102:105], v[240:243]
    ds_read_b64_tr_b16 a[60:61], v10 offset:3840
    v_add_f32_dpp v102, v235, v238 wave_ror:1 row_mask:0xf bank_mask:0xf
    v_mfma_f32_16x16x32_bf16 v[240:243], a[28:31], a[98:101], v[240:243]
    ds_read_b64_tr_b16 a[62:63], v10 offset:3968
    v_add_f32_dpp v103, v100, v237 wave_ror:1 row_mask:0xf bank_mask:0xf
    v_mfma_f32_16x16x32_bf16 v[240:243], a[24:27], a[94:97], v[240:243]
    v_add_f32_dpp v102, v239, v238 wave_shr:1 row_mask:0xf bank_mask:0xf
    v_add_f32_dpp v107, v101, v236 wave_ror:1 row_mask:0xf bank_mask:0xf
    v_mfma_f32_16x16x32_bf16 v[240:243], a[20:23], a[90:93], v[240:243]
    v_add_f32_dpp v103, v102, v237 wave_shr:1 row_mask:0xf bank_mask:0xf
    v_mfma_f32_16x16x32_bf16 v[240:243], a[16:19], a[86:89], v[240:243]
    v_mfma_f32_16x16x32_bf16 v[240:243], a[12:15], a[82:85], v[240:243]
    v_add_f32_dpp v107, v103, v236 wave_shr:1 row_mask:0xf bank_mask:0xf
    v_mfma_f32_16x16x32_bf16 v[240:243], a[8:11], a[78:81], v[240:243]
    v_mfma_f32_16x16x32_bf16 v[240:243], a[4:7], a[74:77], v[240:243]
    s_waitcnt lgkmcnt(3)
    v_mfma_f32_16x16x32_bf16 v[240:243], a[0:3], a[70:73], v[240:243]
    v_mfma_f32_16x16x32_bf16 v[244:247], a[56:59], a[124:127], 0
    v_mfma_f32_16x16x32_bf16 v[244:247], a[52:55], a[120:123], v[244:247]
    v_mfma_f32_16x16x32_bf16 v[244:247], a[48:51], a[116:119], v[244:247]
    v_mfma_f32_16x16x32_bf16 v[244:247], a[44:47], a[112:115], v[244:247]
    v_mfma_f32_16x16x32_bf16 v[244:247], a[40:43], a[108:111], v[244:247]
    v_mfma_f32_16x16x32_bf16 v[244:247], a[36:39], a[104:107], v[244:247]
    v_mfma_f32_16x16x32_bf16 v[244:247], a[32:35], a[100:103], v[244:247]
    ds_read_b64_tr_b16 a[66:67], v11 offset:3840
    v_add_f32_dpp v96, v239, v242 wave_ror:1 row_mask:0xf bank_mask:0xf
    v_mfma_f32_16x16x32_bf16 v[244:247], a[28:31], a[96:99], v[244:247]
    v_add_f32_dpp v97, v102, v241 wave_ror:1 row_mask:0xf bank_mask:0xf
    v_add_f32_dpp v96, v243, v242 wave_shr:1 row_mask:0xf bank_mask:0xf
    v_mfma_f32_16x16x32_bf16 v[244:247], a[24:27], a[92:95], v[244:247]
    v_add_f32_dpp v104, v103, v240 wave_ror:1 row_mask:0xf bank_mask:0xf
    v_add_f32_dpp v97, v96, v241 wave_shr:1 row_mask:0xf bank_mask:0xf
    v_mfma_f32_16x16x32_bf16 v[244:247], a[20:23], a[88:91], v[244:247]
    v_cvt_pk_bf16_f32 v114, v106, v107
    v_add_f32_dpp v104, v97, v240 wave_shr:1 row_mask:0xf bank_mask:0xf
    v_mfma_f32_16x16x32_bf16 v[244:247], a[16:19], a[84:87], v[244:247]
    ds_write_b32 v13, v114 offset:13312
    v_mfma_f32_16x16x32_bf16 v[244:247], a[12:15], a[80:83], v[244:247]
    v_mov_b32 v23, v14
    v_mov_b32 v24, v9
    v_mfma_f32_16x16x32_bf16 v[244:247], a[8:11], a[76:79], v[244:247]
    v_subrev_u32 v22, s71, v22
    s_lshl_b32 s66, s62, 14
    v_mfma_f32_16x16x32_bf16 v[244:247], a[4:7], a[72:75], v[244:247]
    s_add_u32 s79, s66, 2621440
    s_waitcnt lgkmcnt(2)
    v_mfma_f32_16x16x32_bf16 v[244:247], a[0:3], a[68:71], v[244:247]
    s_lshl_b32 s66, s30, 14
    s_lshl_b32 s67, s62, 6
    v_mfma_f32_16x16x32_bf16 v[248:251], a[60:63], a[126:129], 0
    s_add_u32 s66, s66, s67
    s_add_u32 s70, s66, 12976128
    v_mfma_f32_16x16x32_bf16 v[248:251], a[56:59], a[122:125], v[248:251]
    s_mov_b32 s62, s65
    v_mfma_f32_16x16x32_bf16 v[248:251], a[52:55], a[118:121], v[248:251]
    v_add_f32_dpp v98, v243, v246 wave_ror:1 row_mask:0xf bank_mask:0xf
    v_add_f32_dpp v99, v96, v245 wave_ror:1 row_mask:0xf bank_mask:0xf
    v_mfma_f32_16x16x32_bf16 v[248:251], a[48:51], a[114:117], v[248:251]
    v_add_f32_dpp v98, v247, v246 wave_shr:1 row_mask:0xf bank_mask:0xf
    v_add_f32_dpp v105, v97, v244 wave_ror:1 row_mask:0xf bank_mask:0xf
    v_mfma_f32_16x16x32_bf16 v[248:251], a[44:47], a[110:113], v[248:251]
    v_add_f32_dpp v99, v98, v245 wave_shr:1 row_mask:0xf bank_mask:0xf
    v_mfma_f32_16x16x32_bf16 v[248:251], a[40:43], a[106:109], v[248:251]
    v_mfma_f32_16x16x32_bf16 v[248:251], a[36:39], a[102:105], v[248:251]
    v_add_f32_dpp v105, v99, v244 wave_shr:1 row_mask:0xf bank_mask:0xf
    v_mfma_f32_16x16x32_bf16 v[248:251], a[32:35], a[98:101], v[248:251]
    ds_read_b64_tr_b16 a[64:65], v11 offset:3968
    v_mfma_f32_16x16x32_bf16 v[248:251], a[28:31], a[94:97], v[248:251]
    v_mfma_f32_16x16x32_bf16 v[248:251], a[24:27], a[90:93], v[248:251]
    v_mfma_f32_16x16x32_bf16 v[248:251], a[20:23], a[86:89], v[248:251]
    v_mfma_f32_16x16x32_bf16 v[248:251], a[16:19], a[82:85], v[248:251]
    v_mfma_f32_16x16x32_bf16 v[248:251], a[12:15], a[78:81], v[248:251]
    v_mfma_f32_16x16x32_bf16 v[248:251], a[8:11], a[74:77], v[248:251]
    v_mfma_f32_16x16x32_bf16 v[248:251], a[4:7], a[70:73], v[248:251]
    s_waitcnt lgkmcnt(1)
    v_mfma_f32_16x16x32_bf16 v[248:251], a[0:3], a[66:69], v[248:251]
    v_mfma_f32_16x16x32_bf16 v[252:255], a[60:63], a[124:127], 0
    v_mfma_f32_16x16x32_bf16 v[252:255], a[56:59], a[120:123], v[252:255]
    v_mfma_f32_16x16x32_bf16 v[252:255], a[52:55], a[116:119], v[252:255]
    v_mfma_f32_16x16x32_bf16 v[252:255], a[48:51], a[112:115], v[252:255]
    v_mfma_f32_16x16x32_bf16 v[252:255], a[44:47], a[108:111], v[252:255]
    v_mfma_f32_16x16x32_bf16 v[252:255], a[40:43], a[104:107], v[252:255]
    v_mfma_f32_16x16x32_bf16 v[252:255], a[36:39], a[100:103], v[252:255]
    v_mfma_f32_16x16x32_bf16 v[252:255], a[32:35], a[96:99], v[252:255]
    v_add_f32_dpp v100, v247, v250 wave_ror:1 row_mask:0xf bank_mask:0xf
    v_add_f32_dpp v101, v98, v249 wave_ror:1 row_mask:0xf bank_mask:0xf
    v_mfma_f32_16x16x32_bf16 v[252:255], a[28:31], a[92:95], v[252:255]
    v_add_f32_dpp v100, v251, v250 wave_shr:1 row_mask:0xf bank_mask:0xf
    v_add_f32_dpp v106, v99, v248 wave_ror:1 row_mask:0xf bank_mask:0xf
    v_mfma_f32_16x16x32_bf16 v[252:255], a[24:27], a[88:91], v[252:255]
    v_add_f32_dpp v101, v100, v249 wave_shr:1 row_mask:0xf bank_mask:0xf
    v_cvt_pk_bf16_f32 v115, v104, v105
    v_mfma_f32_16x16x32_bf16 v[252:255], a[20:23], a[84:87], v[252:255]
    ds_write_b32 v13, v115 offset:14336
    v_mfma_f32_16x16x32_bf16 v[252:255], a[16:19], a[80:83], v[252:255]
    v_add_f32_dpp v106, v101, v248 wave_shr:1 row_mask:0xf bank_mask:0xf
    v_mfma_f32_16x16x32_bf16 v[252:255], a[12:15], a[76:79], v[252:255]
    v_mfma_f32_16x16x32_bf16 v[252:255], a[8:11], a[72:75], v[252:255]
    v_mfma_f32_16x16x32_bf16 v[252:255], a[4:7], a[68:71], v[252:255]
    s_waitcnt lgkmcnt(1)
    v_mfma_f32_16x16x32_bf16 v[252:255], a[0:3], a[64:67], v[252:255]
    s_nop 7
    v_add_f32_dpp v102, v251, v254 wave_ror:1 row_mask:0xf bank_mask:0xf
    v_add_f32_dpp v103, v100, v253 wave_ror:1 row_mask:0xf bank_mask:0xf
    s_nop 0
    v_add_f32_dpp v102, v255, v254 wave_shr:1 row_mask:0xf bank_mask:0xf
    v_add_f32_dpp v107, v101, v252 wave_ror:1 row_mask:0xf bank_mask:0xf
    s_nop 0
    v_add_f32_dpp v103, v102, v253 wave_shr:1 row_mask:0xf bank_mask:0xf
    s_nop 1
    v_add_f32_dpp v107, v103, v252 wave_shr:1 row_mask:0xf bank_mask:0xf
    v_cvt_pk_bf16_f32 v108, v106, v107
    ds_write_b32 v13, v108 offset:15360
    s_waitcnt lgkmcnt(0)
    s_barrier
    ds_read_b128 v[48:51], v22 offset:0
    ds_read_b128 v[52:55], v22 offset:1024
    ds_read_b128 v[56:59], v22 offset:2048
    ds_read_b128 v[60:63], v22 offset:3072
    s_waitcnt lgkmcnt(3)
    buffer_store_dwordx4 v[48:51], v23, s[44:47], s79 offen offset:0 sc1
    s_waitcnt lgkmcnt(2)
    buffer_store_dwordx4 v[52:55], v23, s[44:47], s79 offen offset:1024 sc1
    s_waitcnt lgkmcnt(1)
    buffer_store_dwordx4 v[56:59], v23, s[44:47], s79 offen offset:2048 sc1
    s_waitcnt lgkmcnt(0)
    buffer_store_dwordx4 v[60:63], v23, s[44:47], s79 offen offset:3072 sc1
    s_waitcnt vmcnt(0)
    buffer_store_dword v8, v9, s[44:47], s70 offen offset:0 sc1
FIN2:
    s_endpgm

SLOW0:
    s_add_u32 s0, s0, 1
    s_cmp_gt_u32 s0, 20000
    s_cbranch_scc1 BACK0
    s_sleep 1
    v_mov_b32 v8, 0
    global_load_dword v8, v8, s[26:27] sc1
    s_waitcnt vmcnt(0)
    v_readfirstlane_b32 s3, v8
    s_nop 1
    s_cmp_eq_u32 s3, 0
    s_cbranch_scc1 SLOW0
    s_nop 4
    s_branch BACK0
SLOW1:
    s_add_u32 s0, s0, 1
    s_cmp_gt_u32 s0, 20000
    s_cbranch_scc1 BACK1
    s_sleep 4
    buffer_load_dwordx2 v[60:61], v42, s[44:47], 0 offen offset:0 sc1
    buffer_load_dwordx2 v[64:65], v42, s[44:47], 0 offen offset:1024 sc1
    buffer_load_dwordx2 v[68:69], v42, s[44:47], 0 offen offset:2048 sc1
    buffer_load_dwordx2 v[72:73], v42, s[44:47], 0 offen offset:3072 sc1
    s_waitcnt vmcnt(0)
    v_xor_b32 v61, s3, v61
    v_xor_b32 v65, s3, v65
    v_xor_b32 v69, s3, v69
    v_xor_b32 v73, s3, v73
    v_or3_b32 v61, v61, v65, v69
    v_or_b32 v61, v61, v73
    v_cmp_ne_u32 vcc, 0, v61
    s_cbranch_vccnz SLOW1
    s_branch BACK1
SLOW2:
    s_add_u32 s0, s0, 1
    s_cmp_gt_u32 s0, 20000
    s_cbranch_scc1 BACK2
    s_sleep 2
    buffer_load_dword v94, v95, s[44:47], s64 offen sc1
    s_waitcnt vmcnt(0)
    v_cmp_ne_u32 vcc, s3, v94
    s_cbranch_vccnz SLOW2
    s_branch BACK2
SLOW3:
    s_add_u32 s0, s0, 1
    s_cmp_gt_u32 s0, 20000
    s_cbranch_scc1 BACK3
    s_sleep 2
    buffer_load_dword v32, v95, s[44:47], s65 offen sc1
    s_waitcnt vmcnt(0)
    v_cmp_ne_u32 vcc, s3, v32
    s_cbranch_vccnz SLOW3
    s_branch BACK3
SLOW4:
    s_add_u32 s0, s0, 1
    s_cmp_gt_u32 s0, 20000
    s_cbranch_scc1 BACK4
    s_sleep 2
    buffer_load_dword v41, v95, s[44:47], s64 offen sc1
    s_waitcnt vmcnt(0)
    v_cmp_ne_u32 vcc, s3, v41
    s_cbranch_vccnz SLOW4
    s_branch BACK4
SLOW5:
    s_add_u32 s0, s0, 1
    s_cmp_gt_u32 s0, 20000
    s_cbranch_scc1 BACK5
    s_sleep 2
    buffer_load_dword v32, v95, s[44:47], s65 offen sc1
    s_waitcnt vmcnt(0)
    v_cmp_ne_u32 vcc, s3, v32
    s_cbranch_vccnz SLOW5
    s_branch BACK5
SLOWY:
    buffer_load_dword v32, v92, s[44:47], 0 offen sc1
    s_add_u32 s0, s0, 1
    s_cmp_gt_u32 s0, 20000
    s_cbranch_scc1 BACKY
    s_waitcnt vmcnt(0)
    v_cmp_ne_u32 vcc, s3, v32
    s_cbranch_vccnz SLOWY
    buffer_load_dwordx4 v[72:75], v59, s[44:47], 0 offen offset:0 sc1
    buffer_load_dwordx4 v[76:79], v59, s[44:47], s68 offen offset:0 sc1
    buffer_load_dwordx4 v[80:83], v59, s[44:47], 0 offen offset:1024 sc1
    buffer_load_dwordx4 v[84:87], v59, s[44:47], s68 offen offset:1024 sc1
    s_branch BACKY
SLOW6:
    s_add_u32 s0, s0, 1
    s_cmp_gt_u32 s0, 20000
    s_cbranch_scc1 BACK6
    s_sleep 2
    buffer_load_dword v94, v17, s[44:47], 0 offen sc1
    s_waitcnt vmcnt(0)
    v_cmp_ne_u32 vcc, s3, v94
    s_cbranch_vccnz SLOW6
    s_branch BACK6
SLOW7:
    s_add_u32 s0, s0, 1
    s_cmp_gt_u32 s0, 20000
    s_cbranch_scc1 BACK7
    s_sleep 1
    v_mov_b32 v8, 0
    global_load_dword v8, v8, s[26:27] sc1
    s_waitcnt vmcnt(0)
    v_readfirstlane_b32 s3, v8
    s_nop 1
    s_cmp_eq_u32 s3, 0
    s_cbranch_scc1 SLOW7
    s_nop 4
    s_branch BACK7
SLOW8:
    s_add_u32 s0, s0, 1
    s_cmp_gt_u32 s0, 20000
    s_cbranch_scc1 BACK8
    s_sleep 2
    buffer_load_dword v94, v27, s[44:47], 0 offen sc1
    s_waitcnt vmcnt(0)
    v_cmp_ne_u32 vcc, s3, v94
    s_cbranch_vccnz SLOW8
    s_branch BACK8
SLOW9:
    s_add_u32 s0, s0, 1
    s_cmp_gt_u32 s0, 20000
    s_cbranch_scc1 BACK9
    s_sleep 2
    buffer_load_dword v94, v25, s[44:47], 0 offen sc1
    s_waitcnt vmcnt(0)
    v_cmp_ne_u32 vcc, s3, v94
    s_cbranch_vccnz SLOW9
    s_branch BACK9
SLOW10:
    s_add_u32 s0, s0, 1
    s_cmp_gt_u32 s0, 20000
    s_cbranch_scc1 BACK10
    s_sleep 2
    buffer_load_dword v94, v26, s[44:47], 0 offen sc1
    s_waitcnt vmcnt(0)
    v_cmp_ne_u32 vcc, s3, v94
    s_cbranch_vccnz SLOW10
    s_branch BACK10
SLOW11:
    s_add_u32 s0, s0, 1
    s_cmp_gt_u32 s0, 20000
    s_cbranch_scc1 BACK11
    s_sleep 2
    buffer_load_dword v94, v17, s[44:47], 0 offen sc1
    s_waitcnt vmcnt(0)
    v_cmp_ne_u32 vcc, s3, v94
    s_cbranch_vccnz SLOW11
    s_branch BACK11
SLOW12:
    s_add_u32 s0, s0, 1
    s_cmp_gt_u32 s0, 20000
    s_cbranch_scc1 BACK12
    s_sleep 2
    buffer_load_dword v94, v17, s[44:47], 0 offen sc1
    s_waitcnt vmcnt(0)
    v_cmp_ne_u32 vcc, s3, v94
    s_cbranch_vccnz SLOW12
    s_branch BACK12

CODE_END:
.set CODE_LINES, (CODE_END - parallel_sum__ssm_conv_h3__swiglu_ffn__prompt_kernel - 256) / 128

.section .rodata,"a"
.p2align 6
.amdhsa_kernel parallel_sum__ssm_conv_h3__swiglu_ffn__prompt_kernel
  .amdhsa_next_free_vgpr 512
  .amdhsa_next_free_sgpr 102
  .amdhsa_accum_offset 256
  .amdhsa_group_segment_fixed_size 0
  .amdhsa_kernarg_size 104
  .amdhsa_user_sgpr_count 2
  .amdhsa_user_sgpr_kernarg_segment_ptr 1
  .amdhsa_system_sgpr_workgroup_id_x 1
  .amdhsa_float_denorm_mode_32 3
.end_amdhsa_kernel
```
